```python
import torch

def _softmax(x, axis=-1):
    return torch.softmax(x, dim=axis)
def _gelu(x):
    return torch.nn.functional.gelu(x, approximate="tanh")
def _silu(x):
    return torch.nn.functional.silu(x)
def _sigmoid(x):
    return torch.sigmoid(x)
def _layernorm(x, axis=-1, eps=1e-5):
    m = x.mean(dim=axis, keepdim=True)
    v = x.var(dim=axis, keepdim=True, unbiased=False)
    return (x - m) / torch.sqrt(v + eps)
def _scatter_add(tgt, idx, src, axis=0):
    return tgt.clone().index_add_(axis, idx, src)
def _segment_sum(src, seg, n):
    out = torch.zeros((n,) + src.shape[1:], dtype=src.dtype)
    return out.index_add_(0, seg, src)
def _pad(x, pw):
    flat = tuple(v for pair in reversed(pw) for v in pair)
    return torch.nn.functional.pad(x, flat)

kernel_name = 'gated_mix__ssm_conv_s5__ssm_conv_s5__prompt'

def setup_inputs():

    _w = (lambda a: (lambda t: t.to(torch.bfloat16) if t.is_floating_point() else t)(torch.as_tensor(a)))
    def _A_setup():
        B, S, D = 1, 2048, 1024
        P = D
        Lambda_re = -0.5 * (lambda _x: torch.exp(torch.as_tensor(_x)))((lambda *s: torch.randn(*s, dtype=torch.bfloat16) * 0.2)(P))
        Lambda_im = (lambda *s: torch.randn(*s, dtype=torch.bfloat16) * 0.4)(P) * 1.0
        B_re = (lambda *s: torch.randn(*s, dtype=torch.bfloat16) * 0.2)(P, D) * (D ** -0.5)
        B_im = (lambda *s: torch.randn(*s, dtype=torch.bfloat16) * 0.2)(P, D) * (D ** -0.5)
        C_re = (lambda *s: torch.randn(*s, dtype=torch.bfloat16) * 0.2)(D, P) * (P ** -0.5)
        C_im = (lambda *s: torch.randn(*s, dtype=torch.bfloat16) * 0.2)(D, P) * (P ** -0.5)
        log_dt = (lambda *s: torch.randn(*s, dtype=torch.bfloat16) * 0.2)(P) * 0.3 - 2.0
        Dskip = (lambda *s: torch.randn(*s, dtype=torch.bfloat16) * 0.05)(D)
        return {
            "x": _w((lambda *s: torch.randn(*s, dtype=torch.bfloat16) * 0.05)(B, S, D)),
            "Lambda_re": _w(Lambda_re),
            "Lambda_im": _w(Lambda_im),
            "B_re": _w(B_re),
            "B_im": _w(B_im),
            "C_re": _w(C_re),
            "C_im": _w(C_im),
            "log_dt": _w(log_dt),
            "Dskip": _w(Dskip),
        }
    _A_in = _A_setup()

    def _B_setup():
        B, S, D = 1, 2048, 1024
        P = D
        Lambda_re = -0.5 * (lambda _x: torch.exp(torch.as_tensor(_x)))((lambda *s: torch.randn(*s, dtype=torch.bfloat16) * 0.2)(P))
        Lambda_im = (lambda *s: torch.randn(*s, dtype=torch.bfloat16) * 0.4)(P) * 1.0
        B_re = (lambda *s: torch.randn(*s, dtype=torch.bfloat16) * 0.2)(P, D) * (D ** -0.5)
        B_im = (lambda *s: torch.randn(*s, dtype=torch.bfloat16) * 0.2)(P, D) * (D ** -0.5)
        C_re = (lambda *s: torch.randn(*s, dtype=torch.bfloat16) * 0.2)(D, P) * (P ** -0.5)
        C_im = (lambda *s: torch.randn(*s, dtype=torch.bfloat16) * 0.2)(D, P) * (P ** -0.5)
        log_dt = (lambda *s: torch.randn(*s, dtype=torch.bfloat16) * 0.2)(P) * 0.3 - 2.0
        Dskip = (lambda *s: torch.randn(*s, dtype=torch.bfloat16) * 0.05)(D)
        return {
            "x": _w((lambda *s: torch.randn(*s, dtype=torch.bfloat16) * 0.05)(B, S, D)),
            "Lambda_re": _w(Lambda_re),
            "Lambda_im": _w(Lambda_im),
            "B_re": _w(B_re),
            "B_im": _w(B_im),
            "C_re": _w(C_re),
            "C_im": _w(C_im),
            "log_dt": _w(log_dt),
            "Dskip": _w(Dskip),
        }
    _B_in = _B_setup()

    return {
        "A_x": _A_in["x"],
        "A_Lambda_re": _A_in["Lambda_re"],
        "A_Lambda_im": _A_in["Lambda_im"],
        "A_B_re": _A_in["B_re"],
        "A_B_im": _A_in["B_im"],
        "A_C_re": _A_in["C_re"],
        "A_C_im": _A_in["C_im"],
        "A_log_dt": _A_in["log_dt"],
        "A_Dskip": _A_in["Dskip"],
        "B_x": _B_in["x"],
        "B_Lambda_re": _B_in["Lambda_re"],
        "B_Lambda_im": _B_in["Lambda_im"],
        "B_B_re": _B_in["B_re"],
        "B_B_im": _B_in["B_im"],
        "B_C_re": _B_in["C_re"],
        "B_C_im": _B_in["C_im"],
        "B_log_dt": _B_in["log_dt"],
        "B_Dskip": _B_in["Dskip"],
        "gate_w": _w((lambda *s: torch.randn(*s, dtype=torch.bfloat16) * 0.05)(1024) * 16.0),
    }

def reference(A_x, A_Lambda_re, A_Lambda_im, A_B_re, A_B_im, A_C_re, A_C_im, A_log_dt, A_Dskip, B_x, B_Lambda_re, B_Lambda_im, B_B_re, B_B_im, B_C_re, B_C_im, B_log_dt, B_Dskip, gate_w):
    def _A_ref(x, Lambda_re, Lambda_im, B_re, B_im, C_re, C_im, log_dt, Dskip):
        Bsz, L, H = x.shape
        Lam = Lambda_re + 1j * Lambda_im
        Bmat = B_re + 1j * B_im
        Cmat = C_re + 1j * C_im
        dt = torch.exp(log_dt)
        Lam_bar = torch.exp(dt * Lam)
        B_bar = ((Lam_bar - 1.0) / Lam)[:, None] * Bmat
        Bu = torch.einsum("bld,pd->blp", x + 0j, B_bar)
        h = torch.zeros_like(Bu[:, 0, :])
        hs = []
        for t in range(L):
            h = Lam_bar[None, :] * h + Bu[:, t, :]
            hs.append(h)
        hseq = torch.stack(hs, 1)
        y = 2.0 * torch.einsum("blp,dp->bld", hseq, Cmat).real + x * Dskip[None, None, :]
        return y

    def _B_ref(x, Lambda_re, Lambda_im, B_re, B_im, C_re, C_im, log_dt, Dskip):
        Bsz, L, H = x.shape
        Lam = Lambda_re + 1j * Lambda_im
        Bmat = B_re + 1j * B_im
        Cmat = C_re + 1j * C_im
        dt = torch.exp(log_dt)
        Lam_bar = torch.exp(dt * Lam)
        B_bar = ((Lam_bar - 1.0) / Lam)[:, None] * Bmat
        Bu = torch.einsum("bld,pd->blp", x + 0j, B_bar)
        h = torch.zeros_like(Bu[:, 0, :])
        hs = []
        for t in range(L):
            h = Lam_bar[None, :] * h + Bu[:, t, :]
            hs.append(h)
        hseq = torch.stack(hs, 1)
        y = 2.0 * torch.einsum("blp,dp->bld", hseq, Cmat).real + x * Dskip[None, None, :]
        return y

    x = A_x
    g = _sigmoid((x * gate_w).sum(-1, keepdims=True))
    a = _A_ref(x, A_Lambda_re, A_Lambda_im, A_B_re, A_B_im, A_C_re, A_C_im, A_log_dt, A_Dskip)
    b = _B_ref(x, B_Lambda_re, B_Lambda_im, B_B_re, B_B_im, B_C_re, B_C_im, B_log_dt, B_Dskip)
    return g * a + (1 - g) * b
```

```asm
; @launch grid=(256,1,1) block=(512,1,1) lds=152640
.amdgcn_target "amdgcn-amd-amdhsa--gfx950"
.text
.globl gated_mix__ssm_conv_s5__ssm_conv_s5__prompt_kernel
.p2align 8
.type gated_mix__ssm_conv_s5__ssm_conv_s5__prompt_kernel,@function
gated_mix__ssm_conv_s5__ssm_conv_s5__prompt_kernel:
    s_cmp_ge_u32 s2, 256
    s_cbranch_scc1 L_end
    s_load_dwordx2 s[4:5], s[0:1], 0
    s_load_dwordx4 s[24:27], s[0:1], 24
    s_load_dwordx4 s[28:31], s[0:1], 96
    s_load_dwordx4 s[32:35], s[0:1], 160
    v_lshrrev_b32 v1, 6, v0
    v_and_b32 v2, 63, v0
    s_and_b32 s16, s2, 7
    v_readfirstlane_b32 s3, v1
    s_lshr_b32 s17, s2, 3
    s_and_b32 s70, s16, 1
    s_lshr_b32 s18, s16, 1
    s_lshl_b32 s13, s70, 2
    s_and_b32 s20, s17, 3
    s_add_u32 s13, s13, s20
    s_lshl_b32 s14, s18, 3
    s_lshr_b32 s20, s17, 2
    s_add_u32 s14, s14, s20
    s_lshr_b32 s69, s14, 4
    s_mov_b32 s77, s69
    s_lshl_b32 s71, s18, 2
    s_and_b32 s20, s17, 3
    s_add_u32 s71, s71, s20
    s_lshr_b32 s72, s17, 2
    s_and_b32 s19, s3, 3
    s_lshl_b32 s15, s18, 9
    s_lshl_b32 s20, s70, 10
    s_add_u32 s15, s15, s20
    s_cmp_ge_u32 s3, 4
    s_cbranch_scc0 L_compute
    s_load_dwordx2 s[36:37], s[0:1], 144
    s_load_dwordx4 s[60:63], s[0:1], 40
    s_load_dwordx4 s[64:67], s[0:1], 112
    v_lshrrev_b32 v3, 3, v2
    v_and_b32 v4, 7, v2
    v_lshrrev_b32 v5, 1, v3
    v_xor_b32 v5, v5, v4
    v_lshlrev_b32 v5, 4, v5
    v_xor_b32 v6, 64, v5
    v_lshrrev_b32 v7, 2, v3
    v_lshlrev_b32 v7, 5, v7
    v_and_b32 v8, 1, v3
    v_lshlrev_b32 v8, 4, v8
    v_add_u32 v7, v7, v8
    v_bfe_u32 v8, v3, 1, 1
    v_add_u32 v7, v7, v8
    s_lshl_b32 s20, s13, 8
    s_lshr_b32 s21, s19, 1
    s_lshl_b32 s21, s21, 7
    s_add_u32 s20, s20, s21
    s_and_b32 s21, s19, 1
    s_lshl_b32 s21, s21, 3
    s_add_u32 s20, s20, s21
    v_add_u32 v7, s20, v7
    v_lshlrev_b32 v7, 11, v7
    v_add_u32 v40, 0, v7
    v_add_u32 v40, v40, v5
    v_add_u32 v41, 131072, v7
    v_add_u32 v41, v41, v6
    v_add_u32 v42, 4096, v7
    v_add_u32 v42, v42, v5
    v_add_u32 v43, 135168, v7
    v_add_u32 v43, v43, v6
    v_add_u32 v44, 8192, v7
    v_add_u32 v44, v44, v5
    v_add_u32 v45, 139264, v7
    v_add_u32 v45, v45, v6
    v_add_u32 v46, 12288, v7
    v_add_u32 v46, v46, v5
    v_add_u32 v47, 143360, v7
    v_add_u32 v47, v47, v6
    s_and_b32 s20, s14, 15
    s_lshl_b32 s20, s20, 6
    s_lshr_b32 s21, s19, 1
    s_lshl_b32 s21, s21, 5
    s_add_u32 s20, s20, s21
    v_add_u32 v7, s20, v3
    v_lshlrev_b32 v7, 11, v7
    v_add_u32 v48, 0, v7
    v_add_u32 v48, v48, v5
    v_add_u32 v49, 16384, v7
    v_add_u32 v49, v49, v6
    v_add_u32 v50, 32768, v7
    v_add_u32 v50, v50, v5
    v_add_u32 v51, 49152, v7
    v_add_u32 v51, v51, v6
    s_lshl_b32 s22, s19, 13
    s_lshl_b32 s23, s19, 12
    s_add_u32 s23, s23, 32768
    s_waitcnt lgkmcnt(0)
    s_mov_b32 s6, 0x400000
    s_mov_b32 s7, 0x00020000
    s_cmp_eq_u32 s77, 0
    s_cselect_b32 s24, s24, s28
    s_cselect_b32 s25, s25, s29
    s_cselect_b32 s26, s26, s30
    s_cselect_b32 s27, s27, s31
    s_bitcmp1_b32 s19, 0
    s_cselect_b32 s8, s26, s24
    s_cselect_b32 s9, s27, s25
    s_mov_b32 s10, 0x200000
    s_mov_b32 s11, 0x00020000
    s_add_u32 s12, s15, 0
    s_and_b32 s12, s12, 2047
    s_add_u32 m0, s22, 0
    s_nop 0
    buffer_load_dwordx4 v40, s[4:7], s12 offen  lds
    s_add_u32 m0, s22, 1024
    s_nop 0
    buffer_load_dwordx4 v41, s[4:7], s12 offen  lds
    s_add_u32 m0, s22, 2048
    s_nop 0
    buffer_load_dwordx4 v42, s[4:7], s12 offen  lds
    s_add_u32 m0, s22, 3072
    s_nop 0
    buffer_load_dwordx4 v43, s[4:7], s12 offen  lds
    s_add_u32 m0, s22, 4096
    s_nop 0
    buffer_load_dwordx4 v44, s[4:7], s12 offen  lds
    s_add_u32 m0, s22, 5120
    s_nop 0
    buffer_load_dwordx4 v45, s[4:7], s12 offen  lds
    s_add_u32 m0, s22, 6144
    s_nop 0
    buffer_load_dwordx4 v46, s[4:7], s12 offen  lds
    s_add_u32 m0, s22, 7168
    s_nop 0
    buffer_load_dwordx4 v47, s[4:7], s12 offen  lds
    s_add_u32 m0, s23, 0
    s_nop 0
    buffer_load_dwordx4 v48, s[8:11], s12 offen  lds
    s_add_u32 m0, s23, 1024
    s_nop 0
    buffer_load_dwordx4 v49, s[8:11], s12 offen  lds
    s_add_u32 m0, s23, 2048
    s_nop 0
    buffer_load_dwordx4 v50, s[8:11], s12 offen  lds
    s_add_u32 m0, s23, 3072
    s_nop 0
    buffer_load_dwordx4 v51, s[8:11], s12 offen  lds
    s_add_u32 s12, s15, 128
    s_and_b32 s12, s12, 2047
    s_add_u32 m0, s22, 49152
    s_nop 0
    buffer_load_dwordx4 v40, s[4:7], s12 offen  lds
    s_add_u32 m0, s22, 50176
    s_nop 0
    buffer_load_dwordx4 v41, s[4:7], s12 offen  lds
    s_add_u32 m0, s22, 51200
    s_nop 0
    buffer_load_dwordx4 v42, s[4:7], s12 offen  lds
    s_add_u32 m0, s22, 52224
    s_nop 0
    buffer_load_dwordx4 v43, s[4:7], s12 offen  lds
    s_add_u32 m0, s22, 53248
    s_nop 0
    buffer_load_dwordx4 v44, s[4:7], s12 offen  lds
    s_add_u32 m0, s22, 54272
    s_nop 0
    buffer_load_dwordx4 v45, s[4:7], s12 offen  lds
    s_add_u32 m0, s22, 55296
    s_nop 0
    buffer_load_dwordx4 v46, s[4:7], s12 offen  lds
    s_add_u32 m0, s22, 56320
    s_nop 0
    buffer_load_dwordx4 v47, s[4:7], s12 offen  lds
    s_add_u32 m0, s23, 49152
    s_nop 0
    buffer_load_dwordx4 v48, s[8:11], s12 offen  lds
    s_add_u32 m0, s23, 50176
    s_nop 0
    buffer_load_dwordx4 v49, s[8:11], s12 offen  lds
    s_add_u32 m0, s23, 51200
    s_nop 0
    buffer_load_dwordx4 v50, s[8:11], s12 offen  lds
    s_add_u32 m0, s23, 52224
    s_nop 0
    buffer_load_dwordx4 v51, s[8:11], s12 offen  lds
    s_mov_b32 s38, 2048
    s_mov_b32 s39, 0x00020000
    s_mov_b32 s44, s34
    s_mov_b32 s45, s35
    s_mov_b32 s46, 28311552
    s_mov_b32 s47, 0x00020000
    v_lshlrev_b32 v52, 5, v2
    v_lshlrev_b32 v53, 7, v2
    s_lshl_b32 s40, s2, 3
    s_lshl_b32 s41, s19, 1
    s_add_u32 s40, s40, s41
    s_lshl_b32 s41, s40, 11
    s_add_u32 s42, s41, 2048
    s_lshr_b32 s68, s2, 6
    s_mov_b32 s56, s60
    s_mov_b32 s57, s61
    s_cmp_eq_u32 s68, 1
    s_cselect_b32 s56, s62, s56
    s_cselect_b32 s57, s63, s57
    s_cmp_eq_u32 s68, 2
    s_cselect_b32 s56, s64, s56
    s_cselect_b32 s57, s65, s57
    s_cmp_eq_u32 s68, 3
    s_cselect_b32 s56, s66, s56
    s_cselect_b32 s57, s67, s57
    s_mov_b32 s58, 0x200000
    s_mov_b32 s59, 0x00020000
    s_and_b32 s68, s2, 63
    s_lshl_b32 s68, s68, 2
    s_add_u32 s68, s68, s19
    s_lshl_b32 s68, s68, 13
    s_add_u32 s30, s56, s68
    s_addc_u32 s31, s57, 0
    s_load_dword s69, s[30:31], 0
    s_load_dword s69, s[36:37], 0
    s_add_u32 s30, s4, s41
    s_addc_u32 s31, s5, 0
    s_load_dword s69, s[30:31], 0
    s_waitcnt vmcnt(12)
    s_barrier
    s_add_u32 s12, s15, 256
    s_and_b32 s12, s12, 2047
    s_add_u32 m0, s22, 98304
    s_nop 0
    buffer_load_dwordx4 v40, s[4:7], s12 offen  lds
    s_add_u32 m0, s22, 99328
    s_nop 0
    buffer_load_dwordx4 v41, s[4:7], s12 offen  lds
    s_add_u32 m0, s22, 100352
    s_nop 0
    buffer_load_dwordx4 v42, s[4:7], s12 offen  lds
    s_add_u32 m0, s22, 101376
    s_nop 0
    buffer_load_dwordx4 v43, s[4:7], s12 offen  lds
    s_add_u32 m0, s22, 102400
    s_nop 0
    buffer_load_dwordx4 v44, s[4:7], s12 offen  lds
    s_add_u32 m0, s22, 103424
    s_nop 0
    buffer_load_dwordx4 v45, s[4:7], s12 offen  lds
    s_add_u32 m0, s22, 104448
    s_nop 0
    buffer_load_dwordx4 v46, s[4:7], s12 offen  lds
    s_add_u32 m0, s22, 105472
    s_nop 0
    buffer_load_dwordx4 v47, s[4:7], s12 offen  lds
    s_add_u32 m0, s23, 98304
    s_nop 0
    buffer_load_dwordx4 v48, s[8:11], s12 offen  lds
    s_add_u32 m0, s23, 99328
    s_nop 0
    buffer_load_dwordx4 v49, s[8:11], s12 offen  lds
    s_add_u32 m0, s23, 100352
    s_nop 0
    buffer_load_dwordx4 v50, s[8:11], s12 offen  lds
    s_add_u32 m0, s23, 101376
    s_nop 0
    buffer_load_dwordx4 v51, s[8:11], s12 offen  lds
    s_waitcnt vmcnt(12)
    s_barrier
    s_add_u32 s12, s15, 384
    s_and_b32 s12, s12, 2047
    s_add_u32 m0, s22, 0
    s_nop 0
    buffer_load_dwordx4 v40, s[4:7], s12 offen  lds
    s_add_u32 m0, s22, 1024
    s_nop 0
    buffer_load_dwordx4 v41, s[4:7], s12 offen  lds
    s_add_u32 m0, s22, 2048
    s_nop 0
    buffer_load_dwordx4 v42, s[4:7], s12 offen  lds
    s_add_u32 m0, s22, 3072
    s_nop 0
    buffer_load_dwordx4 v43, s[4:7], s12 offen  lds
    s_add_u32 m0, s22, 4096
    s_nop 0
    buffer_load_dwordx4 v44, s[4:7], s12 offen  lds
    s_add_u32 m0, s22, 5120
    s_nop 0
    buffer_load_dwordx4 v45, s[4:7], s12 offen  lds
    s_add_u32 m0, s22, 6144
    s_nop 0
    buffer_load_dwordx4 v46, s[4:7], s12 offen  lds
    s_add_u32 m0, s22, 7168
    s_nop 0
    buffer_load_dwordx4 v47, s[4:7], s12 offen  lds
    s_add_u32 m0, s23, 0
    s_nop 0
    buffer_load_dwordx4 v48, s[8:11], s12 offen  lds
    s_add_u32 m0, s23, 1024
    s_nop 0
    buffer_load_dwordx4 v49, s[8:11], s12 offen  lds
    s_add_u32 m0, s23, 2048
    s_nop 0
    buffer_load_dwordx4 v50, s[8:11], s12 offen  lds
    s_add_u32 m0, s23, 3072
    s_nop 0
    buffer_load_dwordx4 v51, s[8:11], s12 offen  lds
    s_waitcnt vmcnt(12)
    s_barrier
    s_add_u32 s12, s15, 512
    s_and_b32 s12, s12, 2047
    s_add_u32 m0, s22, 49152
    s_nop 0
    buffer_load_dwordx4 v40, s[4:7], s12 offen  lds
    s_add_u32 m0, s22, 50176
    s_nop 0
    buffer_load_dwordx4 v41, s[4:7], s12 offen  lds
    s_add_u32 m0, s22, 51200
    s_nop 0
    buffer_load_dwordx4 v42, s[4:7], s12 offen  lds
    s_add_u32 m0, s22, 52224
    s_nop 0
    buffer_load_dwordx4 v43, s[4:7], s12 offen  lds
    s_add_u32 m0, s22, 53248
    s_nop 0
    buffer_load_dwordx4 v44, s[4:7], s12 offen  lds
    s_add_u32 m0, s22, 54272
    s_nop 0
    buffer_load_dwordx4 v45, s[4:7], s12 offen  lds
    s_add_u32 m0, s22, 55296
    s_nop 0
    buffer_load_dwordx4 v46, s[4:7], s12 offen  lds
    s_add_u32 m0, s22, 56320
    s_nop 0
    buffer_load_dwordx4 v47, s[4:7], s12 offen  lds
    s_add_u32 m0, s23, 49152
    s_nop 0
    buffer_load_dwordx4 v48, s[8:11], s12 offen  lds
    s_add_u32 m0, s23, 50176
    s_nop 0
    buffer_load_dwordx4 v49, s[8:11], s12 offen  lds
    s_add_u32 m0, s23, 51200
    s_nop 0
    buffer_load_dwordx4 v50, s[8:11], s12 offen  lds
    s_add_u32 m0, s23, 52224
    s_nop 0
    buffer_load_dwordx4 v51, s[8:11], s12 offen  lds
    s_waitcnt vmcnt(12)
    s_barrier
    s_add_u32 s12, s15, 640
    s_and_b32 s12, s12, 2047
    s_add_u32 m0, s22, 98304
    s_nop 0
    buffer_load_dwordx4 v40, s[4:7], s12 offen  lds
    s_add_u32 m0, s22, 99328
    s_nop 0
    buffer_load_dwordx4 v41, s[4:7], s12 offen  lds
    s_add_u32 m0, s22, 100352
    s_nop 0
    buffer_load_dwordx4 v42, s[4:7], s12 offen  lds
    s_add_u32 m0, s22, 101376
    s_nop 0
    buffer_load_dwordx4 v43, s[4:7], s12 offen  lds
    s_add_u32 m0, s22, 102400
    s_nop 0
    buffer_load_dwordx4 v44, s[4:7], s12 offen  lds
    s_add_u32 m0, s22, 103424
    s_nop 0
    buffer_load_dwordx4 v45, s[4:7], s12 offen  lds
    s_add_u32 m0, s22, 104448
    s_nop 0
    buffer_load_dwordx4 v46, s[4:7], s12 offen  lds
    s_add_u32 m0, s22, 105472
    s_nop 0
    buffer_load_dwordx4 v47, s[4:7], s12 offen  lds
    s_add_u32 m0, s23, 98304
    s_nop 0
    buffer_load_dwordx4 v48, s[8:11], s12 offen  lds
    s_add_u32 m0, s23, 99328
    s_nop 0
    buffer_load_dwordx4 v49, s[8:11], s12 offen  lds
    s_add_u32 m0, s23, 100352
    s_nop 0
    buffer_load_dwordx4 v50, s[8:11], s12 offen  lds
    s_add_u32 m0, s23, 101376
    s_nop 0
    buffer_load_dwordx4 v51, s[8:11], s12 offen  lds
    s_waitcnt vmcnt(12)
    s_barrier
    s_add_u32 s12, s15, 768
    s_and_b32 s12, s12, 2047
    s_add_u32 m0, s22, 0
    s_nop 0
    buffer_load_dwordx4 v40, s[4:7], s12 offen  lds
    s_add_u32 m0, s22, 1024
    s_nop 0
    buffer_load_dwordx4 v41, s[4:7], s12 offen  lds
    s_add_u32 m0, s22, 2048
    s_nop 0
    buffer_load_dwordx4 v42, s[4:7], s12 offen  lds
    s_add_u32 m0, s22, 3072
    s_nop 0
    buffer_load_dwordx4 v43, s[4:7], s12 offen  lds
    s_add_u32 m0, s22, 4096
    s_nop 0
    buffer_load_dwordx4 v44, s[4:7], s12 offen  lds
    s_add_u32 m0, s22, 5120
    s_nop 0
    buffer_load_dwordx4 v45, s[4:7], s12 offen  lds
    s_add_u32 m0, s22, 6144
    s_nop 0
    buffer_load_dwordx4 v46, s[4:7], s12 offen  lds
    s_add_u32 m0, s22, 7168
    s_nop 0
    buffer_load_dwordx4 v47, s[4:7], s12 offen  lds
    s_add_u32 m0, s23, 0
    s_nop 0
    buffer_load_dwordx4 v48, s[8:11], s12 offen  lds
    s_add_u32 m0, s23, 1024
    s_nop 0
    buffer_load_dwordx4 v49, s[8:11], s12 offen  lds
    s_add_u32 m0, s23, 2048
    s_nop 0
    buffer_load_dwordx4 v50, s[8:11], s12 offen  lds
    s_add_u32 m0, s23, 3072
    s_nop 0
    buffer_load_dwordx4 v51, s[8:11], s12 offen  lds
    s_waitcnt vmcnt(12)
    s_barrier
    s_add_u32 s12, s15, 896
    s_and_b32 s12, s12, 2047
    s_add_u32 m0, s22, 49152
    s_nop 0
    buffer_load_dwordx4 v40, s[4:7], s12 offen  lds
    s_add_u32 m0, s22, 50176
    s_nop 0
    buffer_load_dwordx4 v41, s[4:7], s12 offen  lds
    s_add_u32 m0, s22, 51200
    s_nop 0
    buffer_load_dwordx4 v42, s[4:7], s12 offen  lds
    s_add_u32 m0, s22, 52224
    s_nop 0
    buffer_load_dwordx4 v43, s[4:7], s12 offen  lds
    s_add_u32 m0, s22, 53248
    s_nop 0
    buffer_load_dwordx4 v44, s[4:7], s12 offen  lds
    s_add_u32 m0, s22, 54272
    s_nop 0
    buffer_load_dwordx4 v45, s[4:7], s12 offen  lds
    s_add_u32 m0, s22, 55296
    s_nop 0
    buffer_load_dwordx4 v46, s[4:7], s12 offen  lds
    s_add_u32 m0, s22, 56320
    s_nop 0
    buffer_load_dwordx4 v47, s[4:7], s12 offen  lds
    s_add_u32 m0, s23, 49152
    s_nop 0
    buffer_load_dwordx4 v48, s[8:11], s12 offen  lds
    s_add_u32 m0, s23, 50176
    s_nop 0
    buffer_load_dwordx4 v49, s[8:11], s12 offen  lds
    s_add_u32 m0, s23, 51200
    s_nop 0
    buffer_load_dwordx4 v50, s[8:11], s12 offen  lds
    s_add_u32 m0, s23, 52224
    s_nop 0
    buffer_load_dwordx4 v51, s[8:11], s12 offen  lds
    s_waitcnt vmcnt(12)
    s_barrier
    s_add_u32 s12, s15, 1024
    s_and_b32 s12, s12, 2047
    s_add_u32 m0, s22, 98304
    s_nop 0
    buffer_load_dwordx4 v40, s[4:7], s12 offen  lds
    s_add_u32 m0, s22, 99328
    s_nop 0
    buffer_load_dwordx4 v41, s[4:7], s12 offen  lds
    s_add_u32 m0, s22, 100352
    s_nop 0
    buffer_load_dwordx4 v42, s[4:7], s12 offen  lds
    s_add_u32 m0, s22, 101376
    s_nop 0
    buffer_load_dwordx4 v43, s[4:7], s12 offen  lds
    s_add_u32 m0, s22, 102400
    s_nop 0
    buffer_load_dwordx4 v44, s[4:7], s12 offen  lds
    s_add_u32 m0, s22, 103424
    s_nop 0
    buffer_load_dwordx4 v45, s[4:7], s12 offen  lds
    s_add_u32 m0, s22, 104448
    s_nop 0
    buffer_load_dwordx4 v46, s[4:7], s12 offen  lds
    s_add_u32 m0, s22, 105472
    s_nop 0
    buffer_load_dwordx4 v47, s[4:7], s12 offen  lds
    s_add_u32 m0, s23, 98304
    s_nop 0
    buffer_load_dwordx4 v48, s[8:11], s12 offen  lds
    s_add_u32 m0, s23, 99328
    s_nop 0
    buffer_load_dwordx4 v49, s[8:11], s12 offen  lds
    s_add_u32 m0, s23, 100352
    s_nop 0
    buffer_load_dwordx4 v50, s[8:11], s12 offen  lds
    s_add_u32 m0, s23, 101376
    s_nop 0
    buffer_load_dwordx4 v51, s[8:11], s12 offen  lds
    s_mov_b64 exec, 1
    s_cmp_eq_u32 s19, 0
    s_cbranch_scc0 LWa_1
    s_lshl_b32 s48, s13, 1
    s_add_u32 s48, s48, 0
    s_lshl_b32 s48, s48, 6
    s_lshl_b32 s49, s77, 5
    s_add_u32 s48, s48, s49
    s_and_b32 s49, s14, 15
    s_add_u32 s48, s48, s49
    s_add_u32 s48, s48, 0
    s_mul_i32 s48, s48, 16896
    s_add_u32 s48, s48, 16384
    v_mov_b32 v13, s48
    global_load_dword v54, v13, s[34:35]
    s_lshl_b32 s48, s13, 1
    s_add_u32 s48, s48, 0
    s_lshl_b32 s48, s48, 6
    s_lshl_b32 s49, s77, 5
    s_add_u32 s48, s48, s49
    s_and_b32 s49, s14, 15
    s_add_u32 s48, s48, s49
    s_add_u32 s48, s48, 16
    s_mul_i32 s48, s48, 16896
    s_add_u32 s48, s48, 16384
    v_mov_b32 v13, s48
    global_load_dword v54, v13, s[34:35]
    s_lshl_b32 s48, s13, 1
    s_add_u32 s48, s48, 1
    s_lshl_b32 s48, s48, 6
    s_lshl_b32 s49, s77, 5
    s_add_u32 s48, s48, s49
    s_and_b32 s49, s14, 15
    s_add_u32 s48, s48, s49
    s_add_u32 s48, s48, 0
    s_mul_i32 s48, s48, 16896
    s_add_u32 s48, s48, 16384
    v_mov_b32 v13, s48
    global_load_dword v54, v13, s[34:35]
    s_lshl_b32 s48, s13, 1
    s_add_u32 s48, s48, 1
    s_lshl_b32 s48, s48, 6
    s_lshl_b32 s49, s77, 5
    s_add_u32 s48, s48, s49
    s_and_b32 s49, s14, 15
    s_add_u32 s48, s48, s49
    s_add_u32 s48, s48, 16
    s_mul_i32 s48, s48, 16896
    s_add_u32 s48, s48, 16384
    v_mov_b32 v13, s48
    global_load_dword v54, v13, s[34:35]
    global_load_dword v54, v13, s[34:35]
    global_load_dword v54, v13, s[34:35]
    s_branch LWa_e
LWa_1:
    s_cmp_eq_u32 s19, 1
    s_cbranch_scc0 LWa_2
    s_lshl_b32 s48, s71, 6
    s_lshl_b32 s49, s70, 5
    s_add_u32 s48, s48, s49
    s_add_u32 s48, s48, 0
    s_mul_i32 s48, s48, 16896
    s_add_u32 s48, s48, 16384
    v_mov_b32 v13, s48
    global_load_dword v54, v13, s[34:35]
    s_lshl_b32 s48, s71, 6
    s_lshl_b32 s49, s70, 5
    s_add_u32 s48, s48, s49
    s_add_u32 s48, s48, 7
    s_mul_i32 s48, s48, 16896
    s_add_u32 s48, s48, 16384
    v_mov_b32 v13, s48
    global_load_dword v54, v13, s[34:35]
    s_lshl_b32 s48, s71, 6
    s_lshl_b32 s49, s70, 5
    s_add_u32 s48, s48, s49
    s_add_u32 s48, s48, 14
    s_mul_i32 s48, s48, 16896
    s_add_u32 s48, s48, 16384
    v_mov_b32 v13, s48
    global_load_dword v54, v13, s[34:35]
    s_lshl_b32 s48, s71, 6
    s_lshl_b32 s49, s70, 5
    s_add_u32 s48, s48, s49
    s_add_u32 s48, s48, 21
    s_mul_i32 s48, s48, 16896
    s_add_u32 s48, s48, 16384
    v_mov_b32 v13, s48
    global_load_dword v54, v13, s[34:35]
    s_lshl_b32 s48, s71, 6
    s_lshl_b32 s49, s70, 5
    s_add_u32 s48, s48, s49
    s_add_u32 s48, s48, 28
    s_mul_i32 s48, s48, 16896
    s_add_u32 s48, s48, 16384
    v_mov_b32 v13, s48
    global_load_dword v54, v13, s[34:35]
    s_lshl_b32 s48, s71, 6
    s_lshl_b32 s49, s70, 5
    s_add_u32 s48, s48, s49
    s_add_u32 s48, s48, 31
    s_mul_i32 s48, s48, 16896
    s_add_u32 s48, s48, 16384
    v_mov_b32 v13, s48
    global_load_dword v54, v13, s[34:35]
    s_branch LWa_e
LWa_2:
    s_cmp_eq_u32 s19, 2
    s_cbranch_scc0 LWa_3
    s_lshl_b32 s48, s2, 15
    s_add_u32 s48, s48, 18881536
    v_mov_b32 v13, s48
    global_load_dword v54, v13, s[34:35]
    s_mov_b32 s48, 17874944
    v_mov_b32 v13, s48
    global_load_dword v54, v13, s[34:35]
    s_mov_b32 s48, 18305024
    v_mov_b32 v13, s48
    global_load_dword v54, v13, s[34:35]
    global_load_dword v54, v13, s[34:35]
    global_load_dword v54, v13, s[34:35]
    global_load_dword v54, v13, s[34:35]
    s_branch LWa_e
LWa_3:
    s_load_dwordx2 s[52:53], s[0:1], 152
    s_waitcnt lgkmcnt(0)
    s_lshl_b32 s48, s71, 19
    s_add_u32 s48, s48, 0
    s_lshl_b32 s49, s72, 9
    s_add_u32 s48, s48, s49
    v_mov_b32 v13, s48
    global_load_dword v54, v13, s[52:53]
    s_lshl_b32 s48, s71, 19
    s_add_u32 s48, s48, 131072
    s_lshl_b32 s49, s72, 9
    s_add_u32 s48, s48, s49
    v_mov_b32 v13, s48
    global_load_dword v54, v13, s[52:53]
    s_lshl_b32 s48, s71, 19
    s_add_u32 s48, s48, 262144
    s_lshl_b32 s49, s72, 9
    s_add_u32 s48, s48, s49
    v_mov_b32 v13, s48
    global_load_dword v54, v13, s[52:53]
    s_lshl_b32 s48, s71, 19
    s_add_u32 s48, s48, 393216
    s_lshl_b32 s49, s72, 9
    s_add_u32 s48, s48, s49
    v_mov_b32 v13, s48
    global_load_dword v54, v13, s[52:53]
    global_load_dword v54, v13, s[52:53]
    global_load_dword v54, v13, s[52:53]
LWa_e:
    s_mov_b64 exec, -1
    s_waitcnt vmcnt(18)
    s_barrier
    s_add_u32 s12, s15, 1152
    s_and_b32 s12, s12, 2047
    s_add_u32 m0, s22, 0
    s_nop 0
    buffer_load_dwordx4 v40, s[4:7], s12 offen  lds
    s_add_u32 m0, s22, 1024
    s_nop 0
    buffer_load_dwordx4 v41, s[4:7], s12 offen  lds
    s_add_u32 m0, s22, 2048
    s_nop 0
    buffer_load_dwordx4 v42, s[4:7], s12 offen  lds
    s_add_u32 m0, s22, 3072
    s_nop 0
    buffer_load_dwordx4 v43, s[4:7], s12 offen  lds
    s_add_u32 m0, s22, 4096
    s_nop 0
    buffer_load_dwordx4 v44, s[4:7], s12 offen  lds
    s_add_u32 m0, s22, 5120
    s_nop 0
    buffer_load_dwordx4 v45, s[4:7], s12 offen  lds
    s_add_u32 m0, s22, 6144
    s_nop 0
    buffer_load_dwordx4 v46, s[4:7], s12 offen  lds
    s_add_u32 m0, s22, 7168
    s_nop 0
    buffer_load_dwordx4 v47, s[4:7], s12 offen  lds
    s_add_u32 m0, s23, 0
    s_nop 0
    buffer_load_dwordx4 v48, s[8:11], s12 offen  lds
    s_add_u32 m0, s23, 1024
    s_nop 0
    buffer_load_dwordx4 v49, s[8:11], s12 offen  lds
    s_add_u32 m0, s23, 2048
    s_nop 0
    buffer_load_dwordx4 v50, s[8:11], s12 offen  lds
    s_add_u32 m0, s23, 3072
    s_nop 0
    buffer_load_dwordx4 v51, s[8:11], s12 offen  lds
    s_waitcnt vmcnt(18)
    s_barrier
    s_add_u32 s12, s15, 1280
    s_and_b32 s12, s12, 2047
    s_add_u32 m0, s22, 49152
    s_nop 0
    buffer_load_dwordx4 v40, s[4:7], s12 offen  lds
    s_add_u32 m0, s22, 50176
    s_nop 0
    buffer_load_dwordx4 v41, s[4:7], s12 offen  lds
    s_add_u32 m0, s22, 51200
    s_nop 0
    buffer_load_dwordx4 v42, s[4:7], s12 offen  lds
    s_add_u32 m0, s22, 52224
    s_nop 0
    buffer_load_dwordx4 v43, s[4:7], s12 offen  lds
    s_add_u32 m0, s22, 53248
    s_nop 0
    buffer_load_dwordx4 v44, s[4:7], s12 offen  lds
    s_add_u32 m0, s22, 54272
    s_nop 0
    buffer_load_dwordx4 v45, s[4:7], s12 offen  lds
    s_add_u32 m0, s22, 55296
    s_nop 0
    buffer_load_dwordx4 v46, s[4:7], s12 offen  lds
    s_add_u32 m0, s22, 56320
    s_nop 0
    buffer_load_dwordx4 v47, s[4:7], s12 offen  lds
    s_add_u32 m0, s23, 49152
    s_nop 0
    buffer_load_dwordx4 v48, s[8:11], s12 offen  lds
    s_add_u32 m0, s23, 50176
    s_nop 0
    buffer_load_dwordx4 v49, s[8:11], s12 offen  lds
    s_add_u32 m0, s23, 51200
    s_nop 0
    buffer_load_dwordx4 v50, s[8:11], s12 offen  lds
    s_add_u32 m0, s23, 52224
    s_nop 0
    buffer_load_dwordx4 v51, s[8:11], s12 offen  lds
    s_add_u32 s69, s68, 0
    s_mov_b64 exec, 255
    buffer_load_dword v55, v53, s[56:59], s69 offen
    s_mov_b64 exec, -1
    s_waitcnt vmcnt(13)
    s_barrier
    s_add_u32 s12, s15, 1408
    s_and_b32 s12, s12, 2047
    s_add_u32 m0, s22, 98304
    s_nop 0
    buffer_load_dwordx4 v40, s[4:7], s12 offen  lds
    s_add_u32 m0, s22, 99328
    s_nop 0
    buffer_load_dwordx4 v41, s[4:7], s12 offen  lds
    s_add_u32 m0, s22, 100352
    s_nop 0
    buffer_load_dwordx4 v42, s[4:7], s12 offen  lds
    s_add_u32 m0, s22, 101376
    s_nop 0
    buffer_load_dwordx4 v43, s[4:7], s12 offen  lds
    s_add_u32 m0, s22, 102400
    s_nop 0
    buffer_load_dwordx4 v44, s[4:7], s12 offen  lds
    s_add_u32 m0, s22, 103424
    s_nop 0
    buffer_load_dwordx4 v45, s[4:7], s12 offen  lds
    s_add_u32 m0, s22, 104448
    s_nop 0
    buffer_load_dwordx4 v46, s[4:7], s12 offen  lds
    s_add_u32 m0, s22, 105472
    s_nop 0
    buffer_load_dwordx4 v47, s[4:7], s12 offen  lds
    s_add_u32 m0, s23, 98304
    s_nop 0
    buffer_load_dwordx4 v48, s[8:11], s12 offen  lds
    s_add_u32 m0, s23, 99328
    s_nop 0
    buffer_load_dwordx4 v49, s[8:11], s12 offen  lds
    s_add_u32 m0, s23, 100352
    s_nop 0
    buffer_load_dwordx4 v50, s[8:11], s12 offen  lds
    s_add_u32 m0, s23, 101376
    s_nop 0
    buffer_load_dwordx4 v51, s[8:11], s12 offen  lds
    s_add_u32 s69, s68, 1024
    s_mov_b64 exec, 255
    buffer_load_dword v55, v53, s[56:59], s69 offen
    s_mov_b64 exec, -1
    s_waitcnt vmcnt(14)
    s_barrier
    s_add_u32 s12, s15, 1536
    s_and_b32 s12, s12, 2047
    s_add_u32 m0, s22, 0
    s_nop 0
    buffer_load_dwordx4 v40, s[4:7], s12 offen  lds
    s_add_u32 m0, s22, 1024
    s_nop 0
    buffer_load_dwordx4 v41, s[4:7], s12 offen  lds
    s_add_u32 m0, s22, 2048
    s_nop 0
    buffer_load_dwordx4 v42, s[4:7], s12 offen  lds
    s_add_u32 m0, s22, 3072
    s_nop 0
    buffer_load_dwordx4 v43, s[4:7], s12 offen  lds
    s_add_u32 m0, s22, 4096
    s_nop 0
    buffer_load_dwordx4 v44, s[4:7], s12 offen  lds
    s_add_u32 m0, s22, 5120
    s_nop 0
    buffer_load_dwordx4 v45, s[4:7], s12 offen  lds
    s_add_u32 m0, s22, 6144
    s_nop 0
    buffer_load_dwordx4 v46, s[4:7], s12 offen  lds
    s_add_u32 m0, s22, 7168
    s_nop 0
    buffer_load_dwordx4 v47, s[4:7], s12 offen  lds
    s_add_u32 m0, s23, 0
    s_nop 0
    buffer_load_dwordx4 v48, s[8:11], s12 offen  lds
    s_add_u32 m0, s23, 1024
    s_nop 0
    buffer_load_dwordx4 v49, s[8:11], s12 offen  lds
    s_add_u32 m0, s23, 2048
    s_nop 0
    buffer_load_dwordx4 v50, s[8:11], s12 offen  lds
    s_add_u32 m0, s23, 3072
    s_nop 0
    buffer_load_dwordx4 v51, s[8:11], s12 offen  lds
    s_add_u32 s69, s68, 2048
    s_mov_b64 exec, 255
    buffer_load_dword v55, v53, s[56:59], s69 offen
    s_mov_b64 exec, -1
    s_waitcnt vmcnt(14)
    s_barrier
    s_add_u32 s12, s15, 1664
    s_and_b32 s12, s12, 2047
    s_add_u32 m0, s22, 49152
    s_nop 0
    buffer_load_dwordx4 v40, s[4:7], s12 offen  lds
    s_add_u32 m0, s22, 50176
    s_nop 0
    buffer_load_dwordx4 v41, s[4:7], s12 offen  lds
    s_add_u32 m0, s22, 51200
    s_nop 0
    buffer_load_dwordx4 v42, s[4:7], s12 offen  lds
    s_add_u32 m0, s22, 52224
    s_nop 0
    buffer_load_dwordx4 v43, s[4:7], s12 offen  lds
    s_add_u32 m0, s22, 53248
    s_nop 0
    buffer_load_dwordx4 v44, s[4:7], s12 offen  lds
    s_add_u32 m0, s22, 54272
    s_nop 0
    buffer_load_dwordx4 v45, s[4:7], s12 offen  lds
    s_add_u32 m0, s22, 55296
    s_nop 0
    buffer_load_dwordx4 v46, s[4:7], s12 offen  lds
    s_add_u32 m0, s22, 56320
    s_nop 0
    buffer_load_dwordx4 v47, s[4:7], s12 offen  lds
    s_add_u32 m0, s23, 49152
    s_nop 0
    buffer_load_dwordx4 v48, s[8:11], s12 offen  lds
    s_add_u32 m0, s23, 50176
    s_nop 0
    buffer_load_dwordx4 v49, s[8:11], s12 offen  lds
    s_add_u32 m0, s23, 51200
    s_nop 0
    buffer_load_dwordx4 v50, s[8:11], s12 offen  lds
    s_add_u32 m0, s23, 52224
    s_nop 0
    buffer_load_dwordx4 v51, s[8:11], s12 offen  lds
    s_add_u32 s69, s68, 3072
    s_mov_b64 exec, 255
    buffer_load_dword v55, v53, s[56:59], s69 offen
    s_mov_b64 exec, -1
    s_waitcnt vmcnt(14)
    s_barrier
    s_add_u32 s12, s15, 1792
    s_and_b32 s12, s12, 2047
    s_add_u32 m0, s22, 98304
    s_nop 0
    buffer_load_dwordx4 v40, s[4:7], s12 offen  lds
    s_add_u32 m0, s22, 99328
    s_nop 0
    buffer_load_dwordx4 v41, s[4:7], s12 offen  lds
    s_add_u32 m0, s22, 100352
    s_nop 0
    buffer_load_dwordx4 v42, s[4:7], s12 offen  lds
    s_add_u32 m0, s22, 101376
    s_nop 0
    buffer_load_dwordx4 v43, s[4:7], s12 offen  lds
    s_add_u32 m0, s22, 102400
    s_nop 0
    buffer_load_dwordx4 v44, s[4:7], s12 offen  lds
    s_add_u32 m0, s22, 103424
    s_nop 0
    buffer_load_dwordx4 v45, s[4:7], s12 offen  lds
    s_add_u32 m0, s22, 104448
    s_nop 0
    buffer_load_dwordx4 v46, s[4:7], s12 offen  lds
    s_add_u32 m0, s22, 105472
    s_nop 0
    buffer_load_dwordx4 v47, s[4:7], s12 offen  lds
    s_add_u32 m0, s23, 98304
    s_nop 0
    buffer_load_dwordx4 v48, s[8:11], s12 offen  lds
    s_add_u32 m0, s23, 99328
    s_nop 0
    buffer_load_dwordx4 v49, s[8:11], s12 offen  lds
    s_add_u32 m0, s23, 100352
    s_nop 0
    buffer_load_dwordx4 v50, s[8:11], s12 offen  lds
    s_add_u32 m0, s23, 101376
    s_nop 0
    buffer_load_dwordx4 v51, s[8:11], s12 offen  lds
    s_add_u32 s69, s68, 4096
    s_mov_b64 exec, 255
    buffer_load_dword v55, v53, s[56:59], s69 offen
    s_mov_b64 exec, -1
    s_waitcnt vmcnt(14)
    s_barrier
    s_add_u32 s12, s15, 1920
    s_and_b32 s12, s12, 2047
    s_add_u32 m0, s22, 0
    s_nop 0
    buffer_load_dwordx4 v40, s[4:7], s12 offen  lds
    s_add_u32 m0, s22, 1024
    s_nop 0
    buffer_load_dwordx4 v41, s[4:7], s12 offen  lds
    s_add_u32 m0, s22, 2048
    s_nop 0
    buffer_load_dwordx4 v42, s[4:7], s12 offen  lds
    s_add_u32 m0, s22, 3072
    s_nop 0
    buffer_load_dwordx4 v43, s[4:7], s12 offen  lds
    s_add_u32 m0, s22, 4096
    s_nop 0
    buffer_load_dwordx4 v44, s[4:7], s12 offen  lds
    s_add_u32 m0, s22, 5120
    s_nop 0
    buffer_load_dwordx4 v45, s[4:7], s12 offen  lds
    s_add_u32 m0, s22, 6144
    s_nop 0
    buffer_load_dwordx4 v46, s[4:7], s12 offen  lds
    s_add_u32 m0, s22, 7168
    s_nop 0
    buffer_load_dwordx4 v47, s[4:7], s12 offen  lds
    s_add_u32 m0, s23, 0
    s_nop 0
    buffer_load_dwordx4 v48, s[8:11], s12 offen  lds
    s_add_u32 m0, s23, 1024
    s_nop 0
    buffer_load_dwordx4 v49, s[8:11], s12 offen  lds
    s_add_u32 m0, s23, 2048
    s_nop 0
    buffer_load_dwordx4 v50, s[8:11], s12 offen  lds
    s_add_u32 m0, s23, 3072
    s_nop 0
    buffer_load_dwordx4 v51, s[8:11], s12 offen  lds
    s_add_u32 s69, s68, 5120
    s_mov_b64 exec, 255
    buffer_load_dword v55, v53, s[56:59], s69 offen
    s_mov_b64 exec, -1
    s_waitcnt vmcnt(14)
    s_barrier
    s_add_u32 s69, s68, 6144
    s_mov_b64 exec, 255
    buffer_load_dword v55, v53, s[56:59], s69 offen
    s_mov_b64 exec, -1
    s_waitcnt vmcnt(2)
    s_barrier
    s_add_u32 s69, s68, 7168
    s_mov_b64 exec, 255
    buffer_load_dword v55, v53, s[56:59], s69 offen
    s_mov_b64 exec, -1
    s_barrier
    v_mov_b32 v14, 152576
    ds_read_b32 v15, v14
    s_barrier
    buffer_load_dwordx4 v[56:59], v52, s[4:7], s41 offen
    buffer_load_dwordx4 v[60:63], v52, s[4:7], s41 offen offset:16
    buffer_load_dwordx4 v[64:67], v52, s[4:7], s42 offen
    buffer_load_dwordx4 v[68:71], v52, s[4:7], s42 offen offset:16
    buffer_load_dwordx4 v[72:75], v52, s[36:39], 0 offen
    buffer_load_dwordx4 v[76:79], v52, s[36:39], 0 offen offset:16
    s_waitcnt vmcnt(0) lgkmcnt(0)
    v_lshlrev_b32 v80, 16, v72
    v_and_b32 v81, 0xffff0000, v72
    v_lshlrev_b32 v82, 16, v73
    v_and_b32 v83, 0xffff0000, v73
    v_lshlrev_b32 v84, 16, v74
    v_and_b32 v85, 0xffff0000, v74
    v_lshlrev_b32 v86, 16, v75
    v_and_b32 v87, 0xffff0000, v75
    v_lshlrev_b32 v88, 16, v76
    v_and_b32 v89, 0xffff0000, v76
    v_lshlrev_b32 v90, 16, v77
    v_and_b32 v91, 0xffff0000, v77
    v_lshlrev_b32 v92, 16, v78
    v_and_b32 v93, 0xffff0000, v78
    v_lshlrev_b32 v94, 16, v79
    v_and_b32 v95, 0xffff0000, v79
    v_mov_b32 v96, 0
    v_lshlrev_b32 v97, 16, v56
    v_and_b32 v98, 0xffff0000, v56
    v_mul_f32 v97, v97, v80
    v_mul_f32 v98, v98, v81
    v_cvt_pk_bf16_f32 v99, v97, v98
    v_lshlrev_b32 v97, 16, v99
    v_and_b32 v98, 0xffff0000, v99
    v_add_f32 v96, v96, v97
    v_add_f32 v96, v96, v98
    v_lshlrev_b32 v97, 16, v57
    v_and_b32 v98, 0xffff0000, v57
    v_mul_f32 v97, v97, v82
    v_mul_f32 v98, v98, v83
    v_cvt_pk_bf16_f32 v99, v97, v98
    v_lshlrev_b32 v97, 16, v99
    v_and_b32 v98, 0xffff0000, v99
    v_add_f32 v96, v96, v97
    v_add_f32 v96, v96, v98
    v_lshlrev_b32 v97, 16, v58
    v_and_b32 v98, 0xffff0000, v58
    v_mul_f32 v97, v97, v84
    v_mul_f32 v98, v98, v85
    v_cvt_pk_bf16_f32 v99, v97, v98
    v_lshlrev_b32 v97, 16, v99
    v_and_b32 v98, 0xffff0000, v99
    v_add_f32 v96, v96, v97
    v_add_f32 v96, v96, v98
    v_lshlrev_b32 v97, 16, v59
    v_and_b32 v98, 0xffff0000, v59
    v_mul_f32 v97, v97, v86
    v_mul_f32 v98, v98, v87
    v_cvt_pk_bf16_f32 v99, v97, v98
    v_lshlrev_b32 v97, 16, v99
    v_and_b32 v98, 0xffff0000, v99
    v_add_f32 v96, v96, v97
    v_add_f32 v96, v96, v98
    v_lshlrev_b32 v97, 16, v60
    v_and_b32 v98, 0xffff0000, v60
    v_mul_f32 v97, v97, v88
    v_mul_f32 v98, v98, v89
    v_cvt_pk_bf16_f32 v99, v97, v98
    v_lshlrev_b32 v97, 16, v99
    v_and_b32 v98, 0xffff0000, v99
    v_add_f32 v96, v96, v97
    v_add_f32 v96, v96, v98
    v_lshlrev_b32 v97, 16, v61
    v_and_b32 v98, 0xffff0000, v61
    v_mul_f32 v97, v97, v90
    v_mul_f32 v98, v98, v91
    v_cvt_pk_bf16_f32 v99, v97, v98
    v_lshlrev_b32 v97, 16, v99
    v_and_b32 v98, 0xffff0000, v99
    v_add_f32 v96, v96, v97
    v_add_f32 v96, v96, v98
    v_lshlrev_b32 v97, 16, v62
    v_and_b32 v98, 0xffff0000, v62
    v_mul_f32 v97, v97, v92
    v_mul_f32 v98, v98, v93
    v_cvt_pk_bf16_f32 v99, v97, v98
    v_lshlrev_b32 v97, 16, v99
    v_and_b32 v98, 0xffff0000, v99
    v_add_f32 v96, v96, v97
    v_add_f32 v96, v96, v98
    v_lshlrev_b32 v97, 16, v63
    v_and_b32 v98, 0xffff0000, v63
    v_mul_f32 v97, v97, v94
    v_mul_f32 v98, v98, v95
    v_cvt_pk_bf16_f32 v99, v97, v98
    v_lshlrev_b32 v97, 16, v99
    v_and_b32 v98, 0xffff0000, v99
    v_add_f32 v96, v96, v97
    v_add_f32 v96, v96, v98
    s_nop 1
    v_add_f32_dpp v96, v96, v96 quad_perm:[1,0,3,2] row_mask:0xf bank_mask:0xf
    s_nop 1
    v_add_f32_dpp v96, v96, v96 quad_perm:[2,3,0,1] row_mask:0xf bank_mask:0xf
    s_nop 1
    v_add_f32_dpp v96, v96, v96 row_half_mirror row_mask:0xf bank_mask:0xf
    s_nop 1
    v_add_f32_dpp v96, v96, v96 row_mirror row_mask:0xf bank_mask:0xf
    s_nop 1
    v_readlane_b32 s48, v96, 0
    v_readlane_b32 s49, v96, 16
    v_readlane_b32 s50, v96, 32
    v_readlane_b32 s51, v96, 48
    s_nop 1
    v_mov_b32 v97, s48
    v_add_f32 v97, s49, v97
    v_mov_b32 v98, s50
    v_add_f32 v98, s51, v98
    v_add_f32 v97, v97, v98
    v_cvt_pk_bf16_f32 v97, v97, v97
    v_lshlrev_b32 v97, 16, v97
    v_mul_f32 v97, 0xbfb8aa3b, v97
    v_exp_f32 v97, v97
    s_nop 0
    v_add_f32 v97, 1.0, v97
    v_rcp_f32 v97, v97
    s_nop 0
    v_cvt_pk_bf16_f32 v97, v97, v97
    v_lshlrev_b32 v100, 16, v97
    v_sub_f32 v98, 1.0, v100
    v_cvt_pk_bf16_f32 v98, v98, v98
    v_lshlrev_b32 v102, 16, v98
    v_mov_b32 v101, v15
    v_mov_b32 v103, v15
    s_add_u32 s43, s40, 0
    s_lshl_b32 s43, s43, 4
    s_add_u32 s43, s43, 17825792
    v_mov_b32 v97, 0
    s_mov_b64 s[52:53], exec
    s_mov_b64 exec, 1
    buffer_store_dwordx4 v[100:103], v97, s[44:47], s43 offen sc1
    s_mov_b64 exec, s[52:53]
    v_mov_b32 v96, 0
    v_lshlrev_b32 v97, 16, v64
    v_and_b32 v98, 0xffff0000, v64
    v_mul_f32 v97, v97, v80
    v_mul_f32 v98, v98, v81
    v_cvt_pk_bf16_f32 v99, v97, v98
    v_lshlrev_b32 v97, 16, v99
    v_and_b32 v98, 0xffff0000, v99
    v_add_f32 v96, v96, v97
    v_add_f32 v96, v96, v98
    v_lshlrev_b32 v97, 16, v65
    v_and_b32 v98, 0xffff0000, v65
    v_mul_f32 v97, v97, v82
    v_mul_f32 v98, v98, v83
    v_cvt_pk_bf16_f32 v99, v97, v98
    v_lshlrev_b32 v97, 16, v99
    v_and_b32 v98, 0xffff0000, v99
    v_add_f32 v96, v96, v97
    v_add_f32 v96, v96, v98
    v_lshlrev_b32 v97, 16, v66
    v_and_b32 v98, 0xffff0000, v66
    v_mul_f32 v97, v97, v84
    v_mul_f32 v98, v98, v85
    v_cvt_pk_bf16_f32 v99, v97, v98
    v_lshlrev_b32 v97, 16, v99
    v_and_b32 v98, 0xffff0000, v99
    v_add_f32 v96, v96, v97
    v_add_f32 v96, v96, v98
    v_lshlrev_b32 v97, 16, v67
    v_and_b32 v98, 0xffff0000, v67
    v_mul_f32 v97, v97, v86
    v_mul_f32 v98, v98, v87
    v_cvt_pk_bf16_f32 v99, v97, v98
    v_lshlrev_b32 v97, 16, v99
    v_and_b32 v98, 0xffff0000, v99
    v_add_f32 v96, v96, v97
    v_add_f32 v96, v96, v98
    v_lshlrev_b32 v97, 16, v68
    v_and_b32 v98, 0xffff0000, v68
    v_mul_f32 v97, v97, v88
    v_mul_f32 v98, v98, v89
    v_cvt_pk_bf16_f32 v99, v97, v98
    v_lshlrev_b32 v97, 16, v99
    v_and_b32 v98, 0xffff0000, v99
    v_add_f32 v96, v96, v97
    v_add_f32 v96, v96, v98
    v_lshlrev_b32 v97, 16, v69
    v_and_b32 v98, 0xffff0000, v69
    v_mul_f32 v97, v97, v90
    v_mul_f32 v98, v98, v91
    v_cvt_pk_bf16_f32 v99, v97, v98
    v_lshlrev_b32 v97, 16, v99
    v_and_b32 v98, 0xffff0000, v99
    v_add_f32 v96, v96, v97
    v_add_f32 v96, v96, v98
    v_lshlrev_b32 v97, 16, v70
    v_and_b32 v98, 0xffff0000, v70
    v_mul_f32 v97, v97, v92
    v_mul_f32 v98, v98, v93
    v_cvt_pk_bf16_f32 v99, v97, v98
    v_lshlrev_b32 v97, 16, v99
    v_and_b32 v98, 0xffff0000, v99
    v_add_f32 v96, v96, v97
    v_add_f32 v96, v96, v98
    v_lshlrev_b32 v97, 16, v71
    v_and_b32 v98, 0xffff0000, v71
    v_mul_f32 v97, v97, v94
    v_mul_f32 v98, v98, v95
    v_cvt_pk_bf16_f32 v99, v97, v98
    v_lshlrev_b32 v97, 16, v99
    v_and_b32 v98, 0xffff0000, v99
    v_add_f32 v96, v96, v97
    v_add_f32 v96, v96, v98
    s_nop 1
    v_add_f32_dpp v96, v96, v96 quad_perm:[1,0,3,2] row_mask:0xf bank_mask:0xf
    s_nop 1
    v_add_f32_dpp v96, v96, v96 quad_perm:[2,3,0,1] row_mask:0xf bank_mask:0xf
    s_nop 1
    v_add_f32_dpp v96, v96, v96 row_half_mirror row_mask:0xf bank_mask:0xf
    s_nop 1
    v_add_f32_dpp v96, v96, v96 row_mirror row_mask:0xf bank_mask:0xf
    s_nop 1
    v_readlane_b32 s48, v96, 0
    v_readlane_b32 s49, v96, 16
    v_readlane_b32 s50, v96, 32
    v_readlane_b32 s51, v96, 48
    s_nop 1
    v_mov_b32 v97, s48
    v_add_f32 v97, s49, v97
    v_mov_b32 v98, s50
    v_add_f32 v98, s51, v98
    v_add_f32 v97, v97, v98
    v_cvt_pk_bf16_f32 v97, v97, v97
    v_lshlrev_b32 v97, 16, v97
    v_mul_f32 v97, 0xbfb8aa3b, v97
    v_exp_f32 v97, v97
    s_nop 0
    v_add_f32 v97, 1.0, v97
    v_rcp_f32 v97, v97
    s_nop 0
    v_cvt_pk_bf16_f32 v97, v97, v97
    v_lshlrev_b32 v100, 16, v97
    v_sub_f32 v98, 1.0, v100
    v_cvt_pk_bf16_f32 v98, v98, v98
    v_lshlrev_b32 v102, 16, v98
    v_mov_b32 v101, v15
    v_mov_b32 v103, v15
    s_add_u32 s43, s40, 1
    s_lshl_b32 s43, s43, 4
    s_add_u32 s43, s43, 17825792
    v_mov_b32 v97, 0
    s_mov_b64 s[52:53], exec
    s_mov_b64 exec, 1
    buffer_store_dwordx4 v[100:103], v97, s[44:47], s43 offen sc1
    s_mov_b64 exec, s[52:53]
    v_lshlrev_b32 v3, 4, v2
    v_lshrrev_b32 v4, 3, v2
    s_lshl_b32 s20, s72, 7
    s_lshl_b32 s21, s19, 5
    s_add_u32 s20, s20, s21
    v_add_u32 v8, s20, v4
    v_lshlrev_b32 v8, 11, v8
    v_add_u32 v40, 0, v8
    v_add_u32 v40, v40, v5
    v_add_u32 v41, 16384, v8
    v_add_u32 v41, v41, v6
    v_add_u32 v42, 32768, v8
    v_add_u32 v42, v42, v5
    v_add_u32 v43, 49152, v8
    v_add_u32 v43, v43, v6
    s_lshl_b32 s20, s71, 6
    s_lshl_b32 s21, s70, 5
    s_add_u32 s20, s20, s21
    s_mul_i32 s20, s20, 16896
    s_lshl_b32 s21, s19, 12
    s_add_u32 s20, s20, s21
    s_mul_i32 s22, s19, 4352
    s_lshl_b32 s23, s19, 12
    s_add_u32 s23, s23, 17408
    s_cmp_eq_u32 s70, 0
    s_cselect_b32 s8, s60, s64
    s_cselect_b32 s9, s61, s65
    s_mov_b32 s10, 0x200000
    s_mov_b32 s11, 0x00020000
    s_cselect_b32 s36, s62, s66
    s_cselect_b32 s37, s63, s67
    s_mov_b32 s38, 0x200000
    s_mov_b32 s39, 0x00020000
    s_load_dwordx2 s[60:61], s[0:1], 64
    s_load_dwordx2 s[64:65], s[0:1], 136
    s_mov_b32 s62, 2048
    s_mov_b32 s63, 0x00020000
    s_mov_b32 s66, 2048
    s_mov_b32 s67, 0x00020000
    v_lshlrev_b32 v48, 2, v2
    s_lshl_b32 s28, s72, 8
    v_lshrrev_b32 v49, 5, v2
    v_lshlrev_b32 v49, 6, v49
    v_and_b32 v50, 31, v2
    v_add_u32 v49, v49, v50
    v_lshlrev_b32 v49, 4, v49
    s_lshl_b32 s29, s71, 7
    s_lshl_b32 s25, s70, 5
    s_add_u32 s29, s29, s25
    s_lshl_b32 s29, s29, 4
    s_add_u32 s29, s29, 17825792
    s_waitcnt lgkmcnt(0)
    v_lshrrev_b32 v10, 4, v2
    v_and_b32 v11, 15, v2
    v_add_u32 v12, 0, v10
    v_xor_b32 v12, v12, v11
    v_lshlrev_b32 v12, 4, v12
    v_lshl_add_u32 v44, v10, 11, v12
    v_add_u32 v12, 4, v10
    v_xor_b32 v12, v12, v11
    v_lshlrev_b32 v12, 4, v12
    v_lshl_add_u32 v45, v10, 11, v12
    v_add_u32 v12, 8, v10
    v_xor_b32 v12, v12, v11
    v_lshlrev_b32 v12, 4, v12
    v_lshl_add_u32 v46, v10, 11, v12
    v_add_u32 v12, 12, v10
    v_xor_b32 v12, v12, v11
    v_lshlrev_b32 v12, 4, v12
    v_lshl_add_u32 v47, v10, 11, v12
    s_lshl_b32 s27, s71, 7
    s_lshr_b32 s25, s19, 1
    s_lshl_b32 s25, s25, 6
    s_add_u32 s27, s27, s25
    s_lshl_b32 s25, s70, 5
    s_add_u32 s27, s27, s25
    s_and_b32 s25, s19, 1
    s_lshl_b32 s25, s25, 4
    s_add_u32 s27, s27, s25
    s_lshl_b32 s27, s27, 11
    s_lshl_b32 s25, s72, 8
    s_add_u32 s27, s27, s25
    s_lshl_b32 s26, s19, 12
    s_load_dword s69, s[60:61], 0
    s_load_dword s69, s[64:65], 0
    s_add_u32 s50, s4, s27
    s_addc_u32 s51, s5, 0
    s_load_dword s69, s[50:51], 0
    s_lshl_b32 s24, s71, 1
    s_add_u32 s24, s24, s70
    s_lshl_b32 s24, s24, 8
    s_add_u32 s24, s24, 18284544
    v_and_b32 v9, 31, v2
    v_lshlrev_b32 v9, 2, v9
    s_mov_b32 s12, 0
    s_add_u32 m0, s23, 0
    s_nop 0
    buffer_load_dwordx4 v40, s[8:11], s12 offen  lds
    s_add_u32 m0, s23, 1024
    s_nop 0
    buffer_load_dwordx4 v41, s[8:11], s12 offen  lds
    s_add_u32 m0, s23, 2048
    s_nop 0
    buffer_load_dwordx4 v42, s[8:11], s12 offen  lds
    s_add_u32 m0, s23, 3072
    s_nop 0
    buffer_load_dwordx4 v43, s[8:11], s12 offen  lds
    s_mov_b32 s12, 128
    s_add_u32 m0, s23, 33792
    s_nop 0
    buffer_load_dwordx4 v40, s[8:11], s12 offen  lds
    s_add_u32 m0, s23, 34816
    s_nop 0
    buffer_load_dwordx4 v41, s[8:11], s12 offen  lds
    s_add_u32 m0, s23, 35840
    s_nop 0
    buffer_load_dwordx4 v42, s[8:11], s12 offen  lds
    s_add_u32 m0, s23, 36864
    s_nop 0
    buffer_load_dwordx4 v43, s[8:11], s12 offen  lds
    s_mov_b32 s12, 256
    s_add_u32 m0, s23, 67584
    s_nop 0
    buffer_load_dwordx4 v40, s[8:11], s12 offen  lds
    s_add_u32 m0, s23, 68608
    s_nop 0
    buffer_load_dwordx4 v41, s[8:11], s12 offen  lds
    s_add_u32 m0, s23, 69632
    s_nop 0
    buffer_load_dwordx4 v42, s[8:11], s12 offen  lds
    s_add_u32 m0, s23, 70656
    s_nop 0
    buffer_load_dwordx4 v43, s[8:11], s12 offen  lds
    s_barrier
    buffer_load_dword v10, v9, s[44:47], s24 offen sc1
    s_waitcnt vmcnt(0)
    s_mov_b32 s98, 0
LL_nf0:
    v_cmp_ne_u32 vcc, v10, v15
    s_nop 1
    s_and_b32 s25, vcc_lo, 0x3
    s_cbranch_scc0 LL_nk0
    s_add_u32 s98, s98, 1
    s_cmp_gt_u32 s98, 262144
    s_cbranch_scc1 L_end
    s_sleep 4
    buffer_load_dword v10, v9, s[44:47], s24 offen offset:0 sc1
    s_waitcnt vmcnt(0)
    s_branch LL_nf0
LL_nk0:
    s_add_u32 m0, s22, 0
    s_add_u32 s12, s20, 0
    buffer_load_dwordx4 v3, s[44:47], s12 offen sc1 lds
    s_add_u32 m0, s22, 1088
    s_add_u32 s12, s20, 1024
    buffer_load_dwordx4 v3, s[44:47], s12 offen sc1 lds
    s_add_u32 m0, s22, 2176
    s_add_u32 s12, s20, 2048
    buffer_load_dwordx4 v3, s[44:47], s12 offen sc1 lds
    s_add_u32 m0, s22, 3264
    s_add_u32 s12, s20, 3072
    buffer_load_dwordx4 v3, s[44:47], s12 offen sc1 lds
    s_mov_b32 s98, 0
LL_nf1:
    v_cmp_ne_u32 vcc, v10, v15
    s_nop 1
    s_and_b32 s25, vcc_lo, 0xc
    s_cbranch_scc0 LL_nk1
    s_add_u32 s98, s98, 1
    s_cmp_gt_u32 s98, 262144
    s_cbranch_scc1 L_end
    s_sleep 4
    buffer_load_dword v10, v9, s[44:47], s24 offen offset:0 sc1
    s_waitcnt vmcnt(0)
    s_branch LL_nf1
LL_nk1:
    s_add_u32 m0, s22, 33792
    s_add_u32 s12, s20, 16896
    buffer_load_dwordx4 v3, s[44:47], s12 offen sc1 lds
    s_add_u32 m0, s22, 34880
    s_add_u32 s12, s20, 17920
    buffer_load_dwordx4 v3, s[44:47], s12 offen sc1 lds
    s_add_u32 m0, s22, 35968
    s_add_u32 s12, s20, 18944
    buffer_load_dwordx4 v3, s[44:47], s12 offen sc1 lds
    s_add_u32 m0, s22, 37056
    s_add_u32 s12, s20, 19968
    buffer_load_dwordx4 v3, s[44:47], s12 offen sc1 lds
    s_mov_b32 s98, 0
LL_nf2:
    v_cmp_ne_u32 vcc, v10, v15
    s_nop 1
    s_and_b32 s25, vcc_lo, 0x30
    s_cbranch_scc0 LL_nk2
    s_add_u32 s98, s98, 1
    s_cmp_gt_u32 s98, 262144
    s_cbranch_scc1 L_end
    s_sleep 4
    buffer_load_dword v10, v9, s[44:47], s24 offen offset:0 sc1
    s_waitcnt vmcnt(0)
    s_branch LL_nf2
LL_nk2:
    s_add_u32 m0, s22, 67584
    s_add_u32 s12, s20, 33792
    buffer_load_dwordx4 v3, s[44:47], s12 offen sc1 lds
    s_add_u32 m0, s22, 68672
    s_add_u32 s12, s20, 34816
    buffer_load_dwordx4 v3, s[44:47], s12 offen sc1 lds
    s_add_u32 m0, s22, 69760
    s_add_u32 s12, s20, 35840
    buffer_load_dwordx4 v3, s[44:47], s12 offen sc1 lds
    s_add_u32 m0, s22, 70848
    s_add_u32 s12, s20, 36864
    buffer_load_dwordx4 v3, s[44:47], s12 offen sc1 lds
    s_waitcnt vmcnt(8)
    s_barrier
    v_mov_b32 v55, 0
    s_mov_b32 s98, 0
LL_nf3:
    v_cmp_ne_u32 vcc, v10, v15
    s_nop 1
    s_and_b32 s25, vcc_lo, 0xc0
    s_cbranch_scc0 LL_nk3
    s_add_u32 s98, s98, 1
    s_cmp_gt_u32 s98, 262144
    s_cbranch_scc1 L_end
    s_sleep 4
    buffer_load_dword v10, v9, s[44:47], s24 offen offset:0 sc1
    s_waitcnt vmcnt(0)
    s_branch LL_nf3
LL_nk3:
    s_add_u32 m0, s22, 101376
    s_add_u32 s12, s20, 50688
    buffer_load_dwordx4 v3, s[44:47], s12 offen sc1 lds
    s_add_u32 m0, s22, 102464
    s_add_u32 s12, s20, 51712
    buffer_load_dwordx4 v3, s[44:47], s12 offen sc1 lds
    s_add_u32 m0, s22, 103552
    s_add_u32 s12, s20, 52736
    buffer_load_dwordx4 v3, s[44:47], s12 offen sc1 lds
    s_add_u32 m0, s22, 104640
    s_add_u32 s12, s20, 53760
    buffer_load_dwordx4 v3, s[44:47], s12 offen sc1 lds
    s_mov_b32 s12, 384
    s_add_u32 m0, s23, 101376
    s_nop 0
    buffer_load_dwordx4 v40, s[8:11], s12 offen  lds
    s_add_u32 m0, s23, 102400
    s_nop 0
    buffer_load_dwordx4 v41, s[8:11], s12 offen  lds
    s_add_u32 m0, s23, 103424
    s_nop 0
    buffer_load_dwordx4 v42, s[8:11], s12 offen  lds
    s_add_u32 m0, s23, 104448
    s_nop 0
    buffer_load_dwordx4 v43, s[8:11], s12 offen  lds
    s_waitcnt vmcnt(12)
    s_barrier
    s_mov_b32 s98, 0
LL_nf4:
    v_cmp_ne_u32 vcc, v10, v15
    s_nop 1
    s_and_b32 s25, vcc_lo, 0x300
    s_cbranch_scc0 LL_nk4
    s_add_u32 s98, s98, 1
    s_cmp_gt_u32 s98, 262144
    s_cbranch_scc1 L_end
    s_sleep 4
    buffer_load_dword v10, v9, s[44:47], s24 offen offset:0 sc1
    s_waitcnt vmcnt(0)
    s_branch LL_nf4
LL_nk4:
    s_add_u32 m0, s22, 0
    s_add_u32 s12, s20, 67584
    buffer_load_dwordx4 v3, s[44:47], s12 offen sc1 lds
    s_add_u32 m0, s22, 1088
    s_add_u32 s12, s20, 68608
    buffer_load_dwordx4 v3, s[44:47], s12 offen sc1 lds
    s_add_u32 m0, s22, 2176
    s_add_u32 s12, s20, 69632
    buffer_load_dwordx4 v3, s[44:47], s12 offen sc1 lds
    s_add_u32 m0, s22, 3264
    s_add_u32 s12, s20, 70656
    buffer_load_dwordx4 v3, s[44:47], s12 offen sc1 lds
    s_mov_b32 s12, 512
    s_add_u32 m0, s23, 0
    s_nop 0
    buffer_load_dwordx4 v40, s[8:11], s12 offen  lds
    s_add_u32 m0, s23, 1024
    s_nop 0
    buffer_load_dwordx4 v41, s[8:11], s12 offen  lds
    s_add_u32 m0, s23, 2048
    s_nop 0
    buffer_load_dwordx4 v42, s[8:11], s12 offen  lds
    s_add_u32 m0, s23, 3072
    s_nop 0
    buffer_load_dwordx4 v43, s[8:11], s12 offen  lds
    s_waitcnt vmcnt(16)
    s_barrier
    s_mov_b32 s98, 0
LL_nf5:
    v_cmp_ne_u32 vcc, v10, v15
    s_nop 1
    s_and_b32 s25, vcc_lo, 0xc00
    s_cbranch_scc0 LL_nk5
    s_add_u32 s98, s98, 1
    s_cmp_gt_u32 s98, 262144
    s_cbranch_scc1 L_end
    s_sleep 4
    buffer_load_dword v10, v9, s[44:47], s24 offen offset:0 sc1
    s_waitcnt vmcnt(0)
    s_branch LL_nf5
LL_nk5:
    s_add_u32 m0, s22, 33792
    s_add_u32 s12, s20, 84480
    buffer_load_dwordx4 v3, s[44:47], s12 offen sc1 lds
    s_add_u32 m0, s22, 34880
    s_add_u32 s12, s20, 85504
    buffer_load_dwordx4 v3, s[44:47], s12 offen sc1 lds
    s_add_u32 m0, s22, 35968
    s_add_u32 s12, s20, 86528
    buffer_load_dwordx4 v3, s[44:47], s12 offen sc1 lds
    s_add_u32 m0, s22, 37056
    s_add_u32 s12, s20, 87552
    buffer_load_dwordx4 v3, s[44:47], s12 offen sc1 lds
    s_mov_b32 s12, 640
    s_add_u32 m0, s23, 33792
    s_nop 0
    buffer_load_dwordx4 v40, s[8:11], s12 offen  lds
    s_add_u32 m0, s23, 34816
    s_nop 0
    buffer_load_dwordx4 v41, s[8:11], s12 offen  lds
    s_add_u32 m0, s23, 35840
    s_nop 0
    buffer_load_dwordx4 v42, s[8:11], s12 offen  lds
    s_add_u32 m0, s23, 36864
    s_nop 0
    buffer_load_dwordx4 v43, s[8:11], s12 offen  lds
    s_waitcnt vmcnt(16)
    s_barrier
    s_mov_b32 s98, 0
LL_nf6:
    v_cmp_ne_u32 vcc, v10, v15
    s_nop 1
    s_and_b32 s25, vcc_lo, 0x3000
    s_cbranch_scc0 LL_nk6
    s_add_u32 s98, s98, 1
    s_cmp_gt_u32 s98, 262144
    s_cbranch_scc1 L_end
    s_sleep 4
    buffer_load_dword v10, v9, s[44:47], s24 offen offset:0 sc1
    s_waitcnt vmcnt(0)
    s_branch LL_nf6
LL_nk6:
    s_add_u32 m0, s22, 67584
    s_add_u32 s12, s20, 101376
    buffer_load_dwordx4 v3, s[44:47], s12 offen sc1 lds
    s_add_u32 m0, s22, 68672
    s_add_u32 s12, s20, 102400
    buffer_load_dwordx4 v3, s[44:47], s12 offen sc1 lds
    s_add_u32 m0, s22, 69760
    s_add_u32 s12, s20, 103424
    buffer_load_dwordx4 v3, s[44:47], s12 offen sc1 lds
    s_add_u32 m0, s22, 70848
    s_add_u32 s12, s20, 104448
    buffer_load_dwordx4 v3, s[44:47], s12 offen sc1 lds
    s_mov_b32 s12, 768
    s_add_u32 m0, s23, 67584
    s_nop 0
    buffer_load_dwordx4 v40, s[8:11], s12 offen  lds
    s_add_u32 m0, s23, 68608
    s_nop 0
    buffer_load_dwordx4 v41, s[8:11], s12 offen  lds
    s_add_u32 m0, s23, 69632
    s_nop 0
    buffer_load_dwordx4 v42, s[8:11], s12 offen  lds
    s_add_u32 m0, s23, 70656
    s_nop 0
    buffer_load_dwordx4 v43, s[8:11], s12 offen  lds
    s_waitcnt vmcnt(16)
    s_barrier
    s_mov_b32 s98, 0
LL_nf7:
    v_cmp_ne_u32 vcc, v10, v15
    s_nop 1
    s_and_b32 s25, vcc_lo, 0xc000
    s_cbranch_scc0 LL_nk7
    s_add_u32 s98, s98, 1
    s_cmp_gt_u32 s98, 262144
    s_cbranch_scc1 L_end
    s_sleep 4
    buffer_load_dword v10, v9, s[44:47], s24 offen offset:0 sc1
    s_waitcnt vmcnt(0)
    s_branch LL_nf7
LL_nk7:
    s_add_u32 m0, s22, 101376
    s_add_u32 s12, s20, 118272
    buffer_load_dwordx4 v3, s[44:47], s12 offen sc1 lds
    s_add_u32 m0, s22, 102464
    s_add_u32 s12, s20, 119296
    buffer_load_dwordx4 v3, s[44:47], s12 offen sc1 lds
    s_add_u32 m0, s22, 103552
    s_add_u32 s12, s20, 120320
    buffer_load_dwordx4 v3, s[44:47], s12 offen sc1 lds
    s_add_u32 m0, s22, 104640
    s_add_u32 s12, s20, 121344
    buffer_load_dwordx4 v3, s[44:47], s12 offen sc1 lds
    s_mov_b32 s12, 896
    s_add_u32 m0, s23, 101376
    s_nop 0
    buffer_load_dwordx4 v40, s[8:11], s12 offen  lds
    s_add_u32 m0, s23, 102400
    s_nop 0
    buffer_load_dwordx4 v41, s[8:11], s12 offen  lds
    s_add_u32 m0, s23, 103424
    s_nop 0
    buffer_load_dwordx4 v42, s[8:11], s12 offen  lds
    s_add_u32 m0, s23, 104448
    s_nop 0
    buffer_load_dwordx4 v43, s[8:11], s12 offen  lds
    s_waitcnt vmcnt(16)
    s_barrier
    s_mov_b32 s98, 0
LL_nf8:
    v_cmp_ne_u32 vcc, v10, v15
    s_nop 1
    s_and_b32 s25, vcc_lo, 0x30000
    s_cbranch_scc0 LL_nk8
    s_add_u32 s98, s98, 1
    s_cmp_gt_u32 s98, 262144
    s_cbranch_scc1 L_end
    s_sleep 4
    buffer_load_dword v10, v9, s[44:47], s24 offen offset:0 sc1
    s_waitcnt vmcnt(0)
    s_branch LL_nf8
LL_nk8:
    s_add_u32 m0, s22, 0
    s_add_u32 s12, s20, 135168
    buffer_load_dwordx4 v3, s[44:47], s12 offen sc1 lds
    s_add_u32 m0, s22, 1088
    s_add_u32 s12, s20, 136192
    buffer_load_dwordx4 v3, s[44:47], s12 offen sc1 lds
    s_add_u32 m0, s22, 2176
    s_add_u32 s12, s20, 137216
    buffer_load_dwordx4 v3, s[44:47], s12 offen sc1 lds
    s_add_u32 m0, s22, 3264
    s_add_u32 s12, s20, 138240
    buffer_load_dwordx4 v3, s[44:47], s12 offen sc1 lds
    s_mov_b32 s12, 1024
    s_add_u32 m0, s23, 0
    s_nop 0
    buffer_load_dwordx4 v40, s[8:11], s12 offen  lds
    s_add_u32 m0, s23, 1024
    s_nop 0
    buffer_load_dwordx4 v41, s[8:11], s12 offen  lds
    s_add_u32 m0, s23, 2048
    s_nop 0
    buffer_load_dwordx4 v42, s[8:11], s12 offen  lds
    s_add_u32 m0, s23, 3072
    s_nop 0
    buffer_load_dwordx4 v43, s[8:11], s12 offen  lds
    s_waitcnt vmcnt(16)
    s_barrier
    s_mov_b32 s98, 0
LL_nf9:
    v_cmp_ne_u32 vcc, v10, v15
    s_nop 1
    s_and_b32 s25, vcc_lo, 0xc0000
    s_cbranch_scc0 LL_nk9
    s_add_u32 s98, s98, 1
    s_cmp_gt_u32 s98, 262144
    s_cbranch_scc1 L_end
    s_sleep 4
    buffer_load_dword v10, v9, s[44:47], s24 offen offset:0 sc1
    s_waitcnt vmcnt(0)
    s_branch LL_nf9
LL_nk9:
    s_add_u32 m0, s22, 33792
    s_add_u32 s12, s20, 152064
    buffer_load_dwordx4 v3, s[44:47], s12 offen sc1 lds
    s_add_u32 m0, s22, 34880
    s_add_u32 s12, s20, 153088
    buffer_load_dwordx4 v3, s[44:47], s12 offen sc1 lds
    s_add_u32 m0, s22, 35968
    s_add_u32 s12, s20, 154112
    buffer_load_dwordx4 v3, s[44:47], s12 offen sc1 lds
    s_add_u32 m0, s22, 37056
    s_add_u32 s12, s20, 155136
    buffer_load_dwordx4 v3, s[44:47], s12 offen sc1 lds
    s_mov_b32 s12, 1152
    s_add_u32 m0, s23, 33792
    s_nop 0
    buffer_load_dwordx4 v40, s[8:11], s12 offen  lds
    s_add_u32 m0, s23, 34816
    s_nop 0
    buffer_load_dwordx4 v41, s[8:11], s12 offen  lds
    s_add_u32 m0, s23, 35840
    s_nop 0
    buffer_load_dwordx4 v42, s[8:11], s12 offen  lds
    s_add_u32 m0, s23, 36864
    s_nop 0
    buffer_load_dwordx4 v43, s[8:11], s12 offen  lds
    s_waitcnt vmcnt(16)
    s_barrier
    s_mov_b32 s98, 0
LL_nf10:
    v_cmp_ne_u32 vcc, v10, v15
    s_nop 1
    s_and_b32 s25, vcc_lo, 0x300000
    s_cbranch_scc0 LL_nk10
    s_add_u32 s98, s98, 1
    s_cmp_gt_u32 s98, 262144
    s_cbranch_scc1 L_end
    s_sleep 4
    buffer_load_dword v10, v9, s[44:47], s24 offen offset:0 sc1
    s_waitcnt vmcnt(0)
    s_branch LL_nf10
LL_nk10:
    s_add_u32 m0, s22, 67584
    s_add_u32 s12, s20, 168960
    buffer_load_dwordx4 v3, s[44:47], s12 offen sc1 lds
    s_add_u32 m0, s22, 68672
    s_add_u32 s12, s20, 169984
    buffer_load_dwordx4 v3, s[44:47], s12 offen sc1 lds
    s_add_u32 m0, s22, 69760
    s_add_u32 s12, s20, 171008
    buffer_load_dwordx4 v3, s[44:47], s12 offen sc1 lds
    s_add_u32 m0, s22, 70848
    s_add_u32 s12, s20, 172032
    buffer_load_dwordx4 v3, s[44:47], s12 offen sc1 lds
    s_mov_b32 s12, 1280
    s_add_u32 m0, s23, 67584
    s_nop 0
    buffer_load_dwordx4 v40, s[8:11], s12 offen  lds
    s_add_u32 m0, s23, 68608
    s_nop 0
    buffer_load_dwordx4 v41, s[8:11], s12 offen  lds
    s_add_u32 m0, s23, 69632
    s_nop 0
    buffer_load_dwordx4 v42, s[8:11], s12 offen  lds
    s_add_u32 m0, s23, 70656
    s_nop 0
    buffer_load_dwordx4 v43, s[8:11], s12 offen  lds
    s_waitcnt vmcnt(16)
    s_barrier
    buffer_load_dword v11, v9, s[44:47], s24 offen offset:128 sc1
    s_mov_b32 s98, 0
LL_nf11:
    v_cmp_ne_u32 vcc, v10, v15
    s_nop 1
    s_and_b32 s25, vcc_lo, 0xc00000
    s_cbranch_scc0 LL_nk11
    s_add_u32 s98, s98, 1
    s_cmp_gt_u32 s98, 262144
    s_cbranch_scc1 L_end
    s_sleep 4
    buffer_load_dword v10, v9, s[44:47], s24 offen offset:0 sc1
    s_waitcnt vmcnt(0)
    s_branch LL_nf11
LL_nk11:
    s_add_u32 m0, s22, 101376
    s_add_u32 s12, s20, 185856
    buffer_load_dwordx4 v3, s[44:47], s12 offen sc1 lds
    s_add_u32 m0, s22, 102464
    s_add_u32 s12, s20, 186880
    buffer_load_dwordx4 v3, s[44:47], s12 offen sc1 lds
    s_add_u32 m0, s22, 103552
    s_add_u32 s12, s20, 187904
    buffer_load_dwordx4 v3, s[44:47], s12 offen sc1 lds
    s_add_u32 m0, s22, 104640
    s_add_u32 s12, s20, 188928
    buffer_load_dwordx4 v3, s[44:47], s12 offen sc1 lds
    s_mov_b32 s12, 1408
    s_add_u32 m0, s23, 101376
    s_nop 0
    buffer_load_dwordx4 v40, s[8:11], s12 offen  lds
    s_add_u32 m0, s23, 102400
    s_nop 0
    buffer_load_dwordx4 v41, s[8:11], s12 offen  lds
    s_add_u32 m0, s23, 103424
    s_nop 0
    buffer_load_dwordx4 v42, s[8:11], s12 offen  lds
    s_add_u32 m0, s23, 104448
    s_nop 0
    buffer_load_dwordx4 v43, s[8:11], s12 offen  lds
    s_waitcnt vmcnt(17)
    s_barrier
    s_mov_b32 s98, 0
LL_nf12:
    v_cmp_ne_u32 vcc, v10, v15
    s_nop 1
    s_and_b32 s25, vcc_lo, 0x3000000
    s_cbranch_scc0 LL_nk12
    s_add_u32 s98, s98, 1
    s_cmp_gt_u32 s98, 262144
    s_cbranch_scc1 L_end
    s_sleep 4
    buffer_load_dword v10, v9, s[44:47], s24 offen offset:0 sc1
    s_waitcnt vmcnt(0)
    s_branch LL_nf12
LL_nk12:
    s_add_u32 m0, s22, 0
    s_add_u32 s12, s20, 202752
    buffer_load_dwordx4 v3, s[44:47], s12 offen sc1 lds
    s_add_u32 m0, s22, 1088
    s_add_u32 s12, s20, 203776
    buffer_load_dwordx4 v3, s[44:47], s12 offen sc1 lds
    s_add_u32 m0, s22, 2176
    s_add_u32 s12, s20, 204800
    buffer_load_dwordx4 v3, s[44:47], s12 offen sc1 lds
    s_add_u32 m0, s22, 3264
    s_add_u32 s12, s20, 205824
    buffer_load_dwordx4 v3, s[44:47], s12 offen sc1 lds
    s_mov_b32 s12, 1536
    s_add_u32 m0, s23, 0
    s_nop 0
    buffer_load_dwordx4 v40, s[8:11], s12 offen  lds
    s_add_u32 m0, s23, 1024
    s_nop 0
    buffer_load_dwordx4 v41, s[8:11], s12 offen  lds
    s_add_u32 m0, s23, 2048
    s_nop 0
    buffer_load_dwordx4 v42, s[8:11], s12 offen  lds
    s_add_u32 m0, s23, 3072
    s_nop 0
    buffer_load_dwordx4 v43, s[8:11], s12 offen  lds
    s_waitcnt vmcnt(17)
    s_barrier
    s_mov_b32 s98, 0
LL_nf13:
    v_cmp_ne_u32 vcc, v10, v15
    s_nop 1
    s_and_b32 s25, vcc_lo, 0xc000000
    s_cbranch_scc0 LL_nk13
    s_add_u32 s98, s98, 1
    s_cmp_gt_u32 s98, 262144
    s_cbranch_scc1 L_end
    s_sleep 4
    buffer_load_dword v10, v9, s[44:47], s24 offen offset:0 sc1
    s_waitcnt vmcnt(0)
    s_branch LL_nf13
LL_nk13:
    s_add_u32 m0, s22, 33792
    s_add_u32 s12, s20, 219648
    buffer_load_dwordx4 v3, s[44:47], s12 offen sc1 lds
    s_add_u32 m0, s22, 34880
    s_add_u32 s12, s20, 220672
    buffer_load_dwordx4 v3, s[44:47], s12 offen sc1 lds
    s_add_u32 m0, s22, 35968
    s_add_u32 s12, s20, 221696
    buffer_load_dwordx4 v3, s[44:47], s12 offen sc1 lds
    s_add_u32 m0, s22, 37056
    s_add_u32 s12, s20, 222720
    buffer_load_dwordx4 v3, s[44:47], s12 offen sc1 lds
    s_mov_b32 s12, 1664
    s_add_u32 m0, s23, 33792
    s_nop 0
    buffer_load_dwordx4 v40, s[8:11], s12 offen  lds
    s_add_u32 m0, s23, 34816
    s_nop 0
    buffer_load_dwordx4 v41, s[8:11], s12 offen  lds
    s_add_u32 m0, s23, 35840
    s_nop 0
    buffer_load_dwordx4 v42, s[8:11], s12 offen  lds
    s_add_u32 m0, s23, 36864
    s_nop 0
    buffer_load_dwordx4 v43, s[8:11], s12 offen  lds
    s_waitcnt vmcnt(16)
    s_barrier
    s_mov_b32 s98, 0
LL_nf14:
    v_cmp_ne_u32 vcc, v10, v15
    s_nop 1
    s_and_b32 s25, vcc_lo, 0x30000000
    s_cbranch_scc0 LL_nk14
    s_add_u32 s98, s98, 1
    s_cmp_gt_u32 s98, 262144
    s_cbranch_scc1 L_end
    s_sleep 4
    buffer_load_dword v10, v9, s[44:47], s24 offen offset:0 sc1
    s_waitcnt vmcnt(0)
    s_branch LL_nf14
LL_nk14:
    s_add_u32 m0, s22, 67584
    s_add_u32 s12, s20, 236544
    buffer_load_dwordx4 v3, s[44:47], s12 offen sc1 lds
    s_add_u32 m0, s22, 68672
    s_add_u32 s12, s20, 237568
    buffer_load_dwordx4 v3, s[44:47], s12 offen sc1 lds
    s_add_u32 m0, s22, 69760
    s_add_u32 s12, s20, 238592
    buffer_load_dwordx4 v3, s[44:47], s12 offen sc1 lds
    s_add_u32 m0, s22, 70848
    s_add_u32 s12, s20, 239616
    buffer_load_dwordx4 v3, s[44:47], s12 offen sc1 lds
    s_mov_b32 s12, 1792
    s_add_u32 m0, s23, 67584
    s_nop 0
    buffer_load_dwordx4 v40, s[8:11], s12 offen  lds
    s_add_u32 m0, s23, 68608
    s_nop 0
    buffer_load_dwordx4 v41, s[8:11], s12 offen  lds
    s_add_u32 m0, s23, 69632
    s_nop 0
    buffer_load_dwordx4 v42, s[8:11], s12 offen  lds
    s_add_u32 m0, s23, 70656
    s_nop 0
    buffer_load_dwordx4 v43, s[8:11], s12 offen  lds
    s_waitcnt vmcnt(16)
    s_barrier
    s_mov_b32 s98, 0
LL_nf15:
    v_cmp_ne_u32 vcc, v10, v15
    s_nop 1
    s_and_b32 s25, vcc_lo, 0xc0000000
    s_cbranch_scc0 LL_nk15
    s_add_u32 s98, s98, 1
    s_cmp_gt_u32 s98, 262144
    s_cbranch_scc1 L_end
    s_sleep 4
    buffer_load_dword v10, v9, s[44:47], s24 offen offset:0 sc1
    s_waitcnt vmcnt(0)
    s_branch LL_nf15
LL_nk15:
    s_add_u32 m0, s22, 101376
    s_add_u32 s12, s20, 253440
    buffer_load_dwordx4 v3, s[44:47], s12 offen sc1 lds
    s_add_u32 m0, s22, 102464
    s_add_u32 s12, s20, 254464
    buffer_load_dwordx4 v3, s[44:47], s12 offen sc1 lds
    s_add_u32 m0, s22, 103552
    s_add_u32 s12, s20, 255488
    buffer_load_dwordx4 v3, s[44:47], s12 offen sc1 lds
    s_add_u32 m0, s22, 104640
    s_add_u32 s12, s20, 256512
    buffer_load_dwordx4 v3, s[44:47], s12 offen sc1 lds
    s_mov_b32 s12, 1920
    s_add_u32 m0, s23, 101376
    s_nop 0
    buffer_load_dwordx4 v40, s[8:11], s12 offen  lds
    s_add_u32 m0, s23, 102400
    s_nop 0
    buffer_load_dwordx4 v41, s[8:11], s12 offen  lds
    s_add_u32 m0, s23, 103424
    s_nop 0
    buffer_load_dwordx4 v42, s[8:11], s12 offen  lds
    s_add_u32 m0, s23, 104448
    s_nop 0
    buffer_load_dwordx4 v43, s[8:11], s12 offen  lds
    s_waitcnt vmcnt(16)
    s_barrier
    s_mov_b32 s98, 0
LL_nf16:
    v_cmp_ne_u32 vcc, v11, v15
    s_nop 1
    s_and_b32 s25, vcc_lo, 0x3
    s_cbranch_scc0 LL_nk16
    s_add_u32 s98, s98, 1
    s_cmp_gt_u32 s98, 262144
    s_cbranch_scc1 L_end
    s_sleep 4
    buffer_load_dword v11, v9, s[44:47], s24 offen offset:128 sc1
    s_waitcnt vmcnt(0)
    s_branch LL_nf16
LL_nk16:
    s_add_u32 m0, s22, 0
    s_add_u32 s12, s20, 270336
    buffer_load_dwordx4 v3, s[44:47], s12 offen sc1 lds
    s_add_u32 m0, s22, 1088
    s_add_u32 s12, s20, 271360
    buffer_load_dwordx4 v3, s[44:47], s12 offen sc1 lds
    s_add_u32 m0, s22, 2176
    s_add_u32 s12, s20, 272384
    buffer_load_dwordx4 v3, s[44:47], s12 offen sc1 lds
    s_add_u32 m0, s22, 3264
    s_add_u32 s12, s20, 273408
    buffer_load_dwordx4 v3, s[44:47], s12 offen sc1 lds
    s_mov_b32 s12, 0
    s_add_u32 m0, s23, 0
    s_nop 0
    buffer_load_dwordx4 v40, s[36:39], s12 offen  lds
    s_add_u32 m0, s23, 1024
    s_nop 0
    buffer_load_dwordx4 v41, s[36:39], s12 offen  lds
    s_add_u32 m0, s23, 2048
    s_nop 0
    buffer_load_dwordx4 v42, s[36:39], s12 offen  lds
    s_add_u32 m0, s23, 3072
    s_nop 0
    buffer_load_dwordx4 v43, s[36:39], s12 offen  lds
    s_waitcnt vmcnt(16)
    s_barrier
    s_mov_b32 s98, 0
LL_nf17:
    v_cmp_ne_u32 vcc, v11, v15
    s_nop 1
    s_and_b32 s25, vcc_lo, 0xc
    s_cbranch_scc0 LL_nk17
    s_add_u32 s98, s98, 1
    s_cmp_gt_u32 s98, 262144
    s_cbranch_scc1 L_end
    s_sleep 4
    buffer_load_dword v11, v9, s[44:47], s24 offen offset:128 sc1
    s_waitcnt vmcnt(0)
    s_branch LL_nf17
LL_nk17:
    s_add_u32 m0, s22, 33792
    s_add_u32 s12, s20, 287232
    buffer_load_dwordx4 v3, s[44:47], s12 offen sc1 lds
    s_add_u32 m0, s22, 34880
    s_add_u32 s12, s20, 288256
    buffer_load_dwordx4 v3, s[44:47], s12 offen sc1 lds
    s_add_u32 m0, s22, 35968
    s_add_u32 s12, s20, 289280
    buffer_load_dwordx4 v3, s[44:47], s12 offen sc1 lds
    s_add_u32 m0, s22, 37056
    s_add_u32 s12, s20, 290304
    buffer_load_dwordx4 v3, s[44:47], s12 offen sc1 lds
    s_mov_b32 s12, 128
    s_add_u32 m0, s23, 33792
    s_nop 0
    buffer_load_dwordx4 v40, s[36:39], s12 offen  lds
    s_add_u32 m0, s23, 34816
    s_nop 0
    buffer_load_dwordx4 v41, s[36:39], s12 offen  lds
    s_add_u32 m0, s23, 35840
    s_nop 0
    buffer_load_dwordx4 v42, s[36:39], s12 offen  lds
    s_add_u32 m0, s23, 36864
    s_nop 0
    buffer_load_dwordx4 v43, s[36:39], s12 offen  lds
    s_waitcnt vmcnt(16)
    s_barrier
    s_mov_b32 s98, 0
LL_nf18:
    v_cmp_ne_u32 vcc, v11, v15
    s_nop 1
    s_and_b32 s25, vcc_lo, 0x30
    s_cbranch_scc0 LL_nk18
    s_add_u32 s98, s98, 1
    s_cmp_gt_u32 s98, 262144
    s_cbranch_scc1 L_end
    s_sleep 4
    buffer_load_dword v11, v9, s[44:47], s24 offen offset:128 sc1
    s_waitcnt vmcnt(0)
    s_branch LL_nf18
LL_nk18:
    s_add_u32 m0, s22, 67584
    s_add_u32 s12, s20, 304128
    buffer_load_dwordx4 v3, s[44:47], s12 offen sc1 lds
    s_add_u32 m0, s22, 68672
    s_add_u32 s12, s20, 305152
    buffer_load_dwordx4 v3, s[44:47], s12 offen sc1 lds
    s_add_u32 m0, s22, 69760
    s_add_u32 s12, s20, 306176
    buffer_load_dwordx4 v3, s[44:47], s12 offen sc1 lds
    s_add_u32 m0, s22, 70848
    s_add_u32 s12, s20, 307200
    buffer_load_dwordx4 v3, s[44:47], s12 offen sc1 lds
    s_mov_b32 s12, 256
    s_add_u32 m0, s23, 67584
    s_nop 0
    buffer_load_dwordx4 v40, s[36:39], s12 offen  lds
    s_add_u32 m0, s23, 68608
    s_nop 0
    buffer_load_dwordx4 v41, s[36:39], s12 offen  lds
    s_add_u32 m0, s23, 69632
    s_nop 0
    buffer_load_dwordx4 v42, s[36:39], s12 offen  lds
    s_add_u32 m0, s23, 70656
    s_nop 0
    buffer_load_dwordx4 v43, s[36:39], s12 offen  lds
    s_waitcnt vmcnt(16)
    s_barrier
    s_mov_b32 s98, 0
LL_nf19:
    v_cmp_ne_u32 vcc, v11, v15
    s_nop 1
    s_and_b32 s25, vcc_lo, 0xc0
    s_cbranch_scc0 LL_nk19
    s_add_u32 s98, s98, 1
    s_cmp_gt_u32 s98, 262144
    s_cbranch_scc1 L_end
    s_sleep 4
    buffer_load_dword v11, v9, s[44:47], s24 offen offset:128 sc1
    s_waitcnt vmcnt(0)
    s_branch LL_nf19
LL_nk19:
    s_add_u32 m0, s22, 101376
    s_add_u32 s12, s20, 321024
    buffer_load_dwordx4 v3, s[44:47], s12 offen sc1 lds
    s_add_u32 m0, s22, 102464
    s_add_u32 s12, s20, 322048
    buffer_load_dwordx4 v3, s[44:47], s12 offen sc1 lds
    s_add_u32 m0, s22, 103552
    s_add_u32 s12, s20, 323072
    buffer_load_dwordx4 v3, s[44:47], s12 offen sc1 lds
    s_add_u32 m0, s22, 104640
    s_add_u32 s12, s20, 324096
    buffer_load_dwordx4 v3, s[44:47], s12 offen sc1 lds
    s_mov_b32 s12, 384
    s_add_u32 m0, s23, 101376
    s_nop 0
    buffer_load_dwordx4 v40, s[36:39], s12 offen  lds
    s_add_u32 m0, s23, 102400
    s_nop 0
    buffer_load_dwordx4 v41, s[36:39], s12 offen  lds
    s_add_u32 m0, s23, 103424
    s_nop 0
    buffer_load_dwordx4 v42, s[36:39], s12 offen  lds
    s_add_u32 m0, s23, 104448
    s_nop 0
    buffer_load_dwordx4 v43, s[36:39], s12 offen  lds
    s_waitcnt vmcnt(16)
    s_barrier
    s_mov_b32 s98, 0
LL_nf20:
    v_cmp_ne_u32 vcc, v11, v15
    s_nop 1
    s_and_b32 s25, vcc_lo, 0x300
    s_cbranch_scc0 LL_nk20
    s_add_u32 s98, s98, 1
    s_cmp_gt_u32 s98, 262144
    s_cbranch_scc1 L_end
    s_sleep 4
    buffer_load_dword v11, v9, s[44:47], s24 offen offset:128 sc1
    s_waitcnt vmcnt(0)
    s_branch LL_nf20
LL_nk20:
    s_add_u32 m0, s22, 0
    s_add_u32 s12, s20, 337920
    buffer_load_dwordx4 v3, s[44:47], s12 offen sc1 lds
    s_add_u32 m0, s22, 1088
    s_add_u32 s12, s20, 338944
    buffer_load_dwordx4 v3, s[44:47], s12 offen sc1 lds
    s_add_u32 m0, s22, 2176
    s_add_u32 s12, s20, 339968
    buffer_load_dwordx4 v3, s[44:47], s12 offen sc1 lds
    s_add_u32 m0, s22, 3264
    s_add_u32 s12, s20, 340992
    buffer_load_dwordx4 v3, s[44:47], s12 offen sc1 lds
    s_mov_b32 s12, 512
    s_add_u32 m0, s23, 0
    s_nop 0
    buffer_load_dwordx4 v40, s[36:39], s12 offen  lds
    s_add_u32 m0, s23, 1024
    s_nop 0
    buffer_load_dwordx4 v41, s[36:39], s12 offen  lds
    s_add_u32 m0, s23, 2048
    s_nop 0
    buffer_load_dwordx4 v42, s[36:39], s12 offen  lds
    s_add_u32 m0, s23, 3072
    s_nop 0
    buffer_load_dwordx4 v43, s[36:39], s12 offen  lds
    s_waitcnt vmcnt(16)
    s_barrier
    s_mov_b32 s98, 0
LL_nf21:
    v_cmp_ne_u32 vcc, v11, v15
    s_nop 1
    s_and_b32 s25, vcc_lo, 0xc00
    s_cbranch_scc0 LL_nk21
    s_add_u32 s98, s98, 1
    s_cmp_gt_u32 s98, 262144
    s_cbranch_scc1 L_end
    s_sleep 4
    buffer_load_dword v11, v9, s[44:47], s24 offen offset:128 sc1
    s_waitcnt vmcnt(0)
    s_branch LL_nf21
LL_nk21:
    s_add_u32 m0, s22, 33792
    s_add_u32 s12, s20, 354816
    buffer_load_dwordx4 v3, s[44:47], s12 offen sc1 lds
    s_add_u32 m0, s22, 34880
    s_add_u32 s12, s20, 355840
    buffer_load_dwordx4 v3, s[44:47], s12 offen sc1 lds
    s_add_u32 m0, s22, 35968
    s_add_u32 s12, s20, 356864
    buffer_load_dwordx4 v3, s[44:47], s12 offen sc1 lds
    s_add_u32 m0, s22, 37056
    s_add_u32 s12, s20, 357888
    buffer_load_dwordx4 v3, s[44:47], s12 offen sc1 lds
    s_mov_b32 s12, 640
    s_add_u32 m0, s23, 33792
    s_nop 0
    buffer_load_dwordx4 v40, s[36:39], s12 offen  lds
    s_add_u32 m0, s23, 34816
    s_nop 0
    buffer_load_dwordx4 v41, s[36:39], s12 offen  lds
    s_add_u32 m0, s23, 35840
    s_nop 0
    buffer_load_dwordx4 v42, s[36:39], s12 offen  lds
    s_add_u32 m0, s23, 36864
    s_nop 0
    buffer_load_dwordx4 v43, s[36:39], s12 offen  lds
    s_waitcnt vmcnt(16)
    s_barrier
    s_mov_b32 s98, 0
LL_nf22:
    v_cmp_ne_u32 vcc, v11, v15
    s_nop 1
    s_and_b32 s25, vcc_lo, 0x3000
    s_cbranch_scc0 LL_nk22
    s_add_u32 s98, s98, 1
    s_cmp_gt_u32 s98, 262144
    s_cbranch_scc1 L_end
    s_sleep 4
    buffer_load_dword v11, v9, s[44:47], s24 offen offset:128 sc1
    s_waitcnt vmcnt(0)
    s_branch LL_nf22
LL_nk22:
    s_add_u32 m0, s22, 67584
    s_add_u32 s12, s20, 371712
    buffer_load_dwordx4 v3, s[44:47], s12 offen sc1 lds
    s_add_u32 m0, s22, 68672
    s_add_u32 s12, s20, 372736
    buffer_load_dwordx4 v3, s[44:47], s12 offen sc1 lds
    s_add_u32 m0, s22, 69760
    s_add_u32 s12, s20, 373760
    buffer_load_dwordx4 v3, s[44:47], s12 offen sc1 lds
    s_add_u32 m0, s22, 70848
    s_add_u32 s12, s20, 374784
    buffer_load_dwordx4 v3, s[44:47], s12 offen sc1 lds
    s_mov_b32 s12, 768
    s_add_u32 m0, s23, 67584
    s_nop 0
    buffer_load_dwordx4 v40, s[36:39], s12 offen  lds
    s_add_u32 m0, s23, 68608
    s_nop 0
    buffer_load_dwordx4 v41, s[36:39], s12 offen  lds
    s_add_u32 m0, s23, 69632
    s_nop 0
    buffer_load_dwordx4 v42, s[36:39], s12 offen  lds
    s_add_u32 m0, s23, 70656
    s_nop 0
    buffer_load_dwordx4 v43, s[36:39], s12 offen  lds
    s_waitcnt vmcnt(16)
    s_barrier
    s_mov_b32 s98, 0
LL_nf23:
    v_cmp_ne_u32 vcc, v11, v15
    s_nop 1
    s_and_b32 s25, vcc_lo, 0xc000
    s_cbranch_scc0 LL_nk23
    s_add_u32 s98, s98, 1
    s_cmp_gt_u32 s98, 262144
    s_cbranch_scc1 L_end
    s_sleep 4
    buffer_load_dword v11, v9, s[44:47], s24 offen offset:128 sc1
    s_waitcnt vmcnt(0)
    s_branch LL_nf23
LL_nk23:
    s_add_u32 m0, s22, 101376
    s_add_u32 s12, s20, 388608
    buffer_load_dwordx4 v3, s[44:47], s12 offen sc1 lds
    s_add_u32 m0, s22, 102464
    s_add_u32 s12, s20, 389632
    buffer_load_dwordx4 v3, s[44:47], s12 offen sc1 lds
    s_add_u32 m0, s22, 103552
    s_add_u32 s12, s20, 390656
    buffer_load_dwordx4 v3, s[44:47], s12 offen sc1 lds
    s_add_u32 m0, s22, 104640
    s_add_u32 s12, s20, 391680
    buffer_load_dwordx4 v3, s[44:47], s12 offen sc1 lds
    s_mov_b32 s12, 896
    s_add_u32 m0, s23, 101376
    s_nop 0
    buffer_load_dwordx4 v40, s[36:39], s12 offen  lds
    s_add_u32 m0, s23, 102400
    s_nop 0
    buffer_load_dwordx4 v41, s[36:39], s12 offen  lds
    s_add_u32 m0, s23, 103424
    s_nop 0
    buffer_load_dwordx4 v42, s[36:39], s12 offen  lds
    s_add_u32 m0, s23, 104448
    s_nop 0
    buffer_load_dwordx4 v43, s[36:39], s12 offen  lds
    s_waitcnt vmcnt(16)
    s_barrier
    s_mov_b32 s98, 0
LL_nf24:
    v_cmp_ne_u32 vcc, v11, v15
    s_nop 1
    s_and_b32 s25, vcc_lo, 0x30000
    s_cbranch_scc0 LL_nk24
    s_add_u32 s98, s98, 1
    s_cmp_gt_u32 s98, 262144
    s_cbranch_scc1 L_end
    s_sleep 4
    buffer_load_dword v11, v9, s[44:47], s24 offen offset:128 sc1
    s_waitcnt vmcnt(0)
    s_branch LL_nf24
LL_nk24:
    s_add_u32 m0, s22, 0
    s_add_u32 s12, s20, 405504
    buffer_load_dwordx4 v3, s[44:47], s12 offen sc1 lds
    s_add_u32 m0, s22, 1088
    s_add_u32 s12, s20, 406528
    buffer_load_dwordx4 v3, s[44:47], s12 offen sc1 lds
    s_add_u32 m0, s22, 2176
    s_add_u32 s12, s20, 407552
    buffer_load_dwordx4 v3, s[44:47], s12 offen sc1 lds
    s_add_u32 m0, s22, 3264
    s_add_u32 s12, s20, 408576
    buffer_load_dwordx4 v3, s[44:47], s12 offen sc1 lds
    s_mov_b32 s12, 1024
    s_add_u32 m0, s23, 0
    s_nop 0
    buffer_load_dwordx4 v40, s[36:39], s12 offen  lds
    s_add_u32 m0, s23, 1024
    s_nop 0
    buffer_load_dwordx4 v41, s[36:39], s12 offen  lds
    s_add_u32 m0, s23, 2048
    s_nop 0
    buffer_load_dwordx4 v42, s[36:39], s12 offen  lds
    s_add_u32 m0, s23, 3072
    s_nop 0
    buffer_load_dwordx4 v43, s[36:39], s12 offen  lds
    s_waitcnt vmcnt(16)
    s_barrier
    s_mov_b32 s98, 0
LL_nf25:
    v_cmp_ne_u32 vcc, v11, v15
    s_nop 1
    s_and_b32 s25, vcc_lo, 0xc0000
    s_cbranch_scc0 LL_nk25
    s_add_u32 s98, s98, 1
    s_cmp_gt_u32 s98, 262144
    s_cbranch_scc1 L_end
    s_sleep 4
    buffer_load_dword v11, v9, s[44:47], s24 offen offset:128 sc1
    s_waitcnt vmcnt(0)
    s_branch LL_nf25
LL_nk25:
    s_add_u32 m0, s22, 33792
    s_add_u32 s12, s20, 422400
    buffer_load_dwordx4 v3, s[44:47], s12 offen sc1 lds
    s_add_u32 m0, s22, 34880
    s_add_u32 s12, s20, 423424
    buffer_load_dwordx4 v3, s[44:47], s12 offen sc1 lds
    s_add_u32 m0, s22, 35968
    s_add_u32 s12, s20, 424448
    buffer_load_dwordx4 v3, s[44:47], s12 offen sc1 lds
    s_add_u32 m0, s22, 37056
    s_add_u32 s12, s20, 425472
    buffer_load_dwordx4 v3, s[44:47], s12 offen sc1 lds
    s_mov_b32 s12, 1152
    s_add_u32 m0, s23, 33792
    s_nop 0
    buffer_load_dwordx4 v40, s[36:39], s12 offen  lds
    s_add_u32 m0, s23, 34816
    s_nop 0
    buffer_load_dwordx4 v41, s[36:39], s12 offen  lds
    s_add_u32 m0, s23, 35840
    s_nop 0
    buffer_load_dwordx4 v42, s[36:39], s12 offen  lds
    s_add_u32 m0, s23, 36864
    s_nop 0
    buffer_load_dwordx4 v43, s[36:39], s12 offen  lds
    s_waitcnt vmcnt(16)
    s_barrier
    s_mov_b32 s98, 0
LL_nf26:
    v_cmp_ne_u32 vcc, v11, v15
    s_nop 1
    s_and_b32 s25, vcc_lo, 0x300000
    s_cbranch_scc0 LL_nk26
    s_add_u32 s98, s98, 1
    s_cmp_gt_u32 s98, 262144
    s_cbranch_scc1 L_end
    s_sleep 4
    buffer_load_dword v11, v9, s[44:47], s24 offen offset:128 sc1
    s_waitcnt vmcnt(0)
    s_branch LL_nf26
LL_nk26:
    s_add_u32 m0, s22, 67584
    s_add_u32 s12, s20, 439296
    buffer_load_dwordx4 v3, s[44:47], s12 offen sc1 lds
    s_add_u32 m0, s22, 68672
    s_add_u32 s12, s20, 440320
    buffer_load_dwordx4 v3, s[44:47], s12 offen sc1 lds
    s_add_u32 m0, s22, 69760
    s_add_u32 s12, s20, 441344
    buffer_load_dwordx4 v3, s[44:47], s12 offen sc1 lds
    s_add_u32 m0, s22, 70848
    s_add_u32 s12, s20, 442368
    buffer_load_dwordx4 v3, s[44:47], s12 offen sc1 lds
    s_mov_b32 s12, 1280
    s_add_u32 m0, s23, 67584
    s_nop 0
    buffer_load_dwordx4 v40, s[36:39], s12 offen  lds
    s_add_u32 m0, s23, 68608
    s_nop 0
    buffer_load_dwordx4 v41, s[36:39], s12 offen  lds
    s_add_u32 m0, s23, 69632
    s_nop 0
    buffer_load_dwordx4 v42, s[36:39], s12 offen  lds
    s_add_u32 m0, s23, 70656
    s_nop 0
    buffer_load_dwordx4 v43, s[36:39], s12 offen  lds
    s_waitcnt vmcnt(16)
    s_barrier
    s_mov_b32 s98, 0
LL_nf27:
    v_cmp_ne_u32 vcc, v11, v15
    s_nop 1
    s_and_b32 s25, vcc_lo, 0xc00000
    s_cbranch_scc0 LL_nk27
    s_add_u32 s98, s98, 1
    s_cmp_gt_u32 s98, 262144
    s_cbranch_scc1 L_end
    s_sleep 4
    buffer_load_dword v11, v9, s[44:47], s24 offen offset:128 sc1
    s_waitcnt vmcnt(0)
    s_branch LL_nf27
LL_nk27:
    s_add_u32 m0, s22, 101376
    s_add_u32 s12, s20, 456192
    buffer_load_dwordx4 v3, s[44:47], s12 offen sc1 lds
    s_add_u32 m0, s22, 102464
    s_add_u32 s12, s20, 457216
    buffer_load_dwordx4 v3, s[44:47], s12 offen sc1 lds
    s_add_u32 m0, s22, 103552
    s_add_u32 s12, s20, 458240
    buffer_load_dwordx4 v3, s[44:47], s12 offen sc1 lds
    s_add_u32 m0, s22, 104640
    s_add_u32 s12, s20, 459264
    buffer_load_dwordx4 v3, s[44:47], s12 offen sc1 lds
    s_mov_b32 s12, 1408
    s_add_u32 m0, s23, 101376
    s_nop 0
    buffer_load_dwordx4 v40, s[36:39], s12 offen  lds
    s_add_u32 m0, s23, 102400
    s_nop 0
    buffer_load_dwordx4 v41, s[36:39], s12 offen  lds
    s_add_u32 m0, s23, 103424
    s_nop 0
    buffer_load_dwordx4 v42, s[36:39], s12 offen  lds
    s_add_u32 m0, s23, 104448
    s_nop 0
    buffer_load_dwordx4 v43, s[36:39], s12 offen  lds
    s_waitcnt vmcnt(16)
    s_barrier
    s_mov_b32 s98, 0
LL_nf28:
    v_cmp_ne_u32 vcc, v11, v15
    s_nop 1
    s_and_b32 s25, vcc_lo, 0x3000000
    s_cbranch_scc0 LL_nk28
    s_add_u32 s98, s98, 1
    s_cmp_gt_u32 s98, 262144
    s_cbranch_scc1 L_end
    s_sleep 4
    buffer_load_dword v11, v9, s[44:47], s24 offen offset:128 sc1
    s_waitcnt vmcnt(0)
    s_branch LL_nf28
LL_nk28:
    s_add_u32 m0, s22, 0
    s_add_u32 s12, s20, 473088
    buffer_load_dwordx4 v3, s[44:47], s12 offen sc1 lds
    s_add_u32 m0, s22, 1088
    s_add_u32 s12, s20, 474112
    buffer_load_dwordx4 v3, s[44:47], s12 offen sc1 lds
    s_add_u32 m0, s22, 2176
    s_add_u32 s12, s20, 475136
    buffer_load_dwordx4 v3, s[44:47], s12 offen sc1 lds
    s_add_u32 m0, s22, 3264
    s_add_u32 s12, s20, 476160
    buffer_load_dwordx4 v3, s[44:47], s12 offen sc1 lds
    s_mov_b32 s12, 1536
    s_add_u32 m0, s23, 0
    s_nop 0
    buffer_load_dwordx4 v40, s[36:39], s12 offen  lds
    s_add_u32 m0, s23, 1024
    s_nop 0
    buffer_load_dwordx4 v41, s[36:39], s12 offen  lds
    s_add_u32 m0, s23, 2048
    s_nop 0
    buffer_load_dwordx4 v42, s[36:39], s12 offen  lds
    s_add_u32 m0, s23, 3072
    s_nop 0
    buffer_load_dwordx4 v43, s[36:39], s12 offen  lds
    s_waitcnt vmcnt(16)
    s_barrier
    s_mov_b32 s98, 0
LL_nf29:
    v_cmp_ne_u32 vcc, v11, v15
    s_nop 1
    s_and_b32 s25, vcc_lo, 0xc000000
    s_cbranch_scc0 LL_nk29
    s_add_u32 s98, s98, 1
    s_cmp_gt_u32 s98, 262144
    s_cbranch_scc1 L_end
    s_sleep 4
    buffer_load_dword v11, v9, s[44:47], s24 offen offset:128 sc1
    s_waitcnt vmcnt(0)
    s_branch LL_nf29
LL_nk29:
    s_add_u32 m0, s22, 33792
    s_add_u32 s12, s20, 489984
    buffer_load_dwordx4 v3, s[44:47], s12 offen sc1 lds
    s_add_u32 m0, s22, 34880
    s_add_u32 s12, s20, 491008
    buffer_load_dwordx4 v3, s[44:47], s12 offen sc1 lds
    s_add_u32 m0, s22, 35968
    s_add_u32 s12, s20, 492032
    buffer_load_dwordx4 v3, s[44:47], s12 offen sc1 lds
    s_add_u32 m0, s22, 37056
    s_add_u32 s12, s20, 493056
    buffer_load_dwordx4 v3, s[44:47], s12 offen sc1 lds
    s_mov_b32 s12, 1664
    s_add_u32 m0, s23, 33792
    s_nop 0
    buffer_load_dwordx4 v40, s[36:39], s12 offen  lds
    s_add_u32 m0, s23, 34816
    s_nop 0
    buffer_load_dwordx4 v41, s[36:39], s12 offen  lds
    s_add_u32 m0, s23, 35840
    s_nop 0
    buffer_load_dwordx4 v42, s[36:39], s12 offen  lds
    s_add_u32 m0, s23, 36864
    s_nop 0
    buffer_load_dwordx4 v43, s[36:39], s12 offen  lds
    s_waitcnt vmcnt(16)
    s_barrier
    s_mov_b32 s98, 0
LL_nf30:
    v_cmp_ne_u32 vcc, v11, v15
    s_nop 1
    s_and_b32 s25, vcc_lo, 0x30000000
    s_cbranch_scc0 LL_nk30
    s_add_u32 s98, s98, 1
    s_cmp_gt_u32 s98, 262144
    s_cbranch_scc1 L_end
    s_sleep 4
    buffer_load_dword v11, v9, s[44:47], s24 offen offset:128 sc1
    s_waitcnt vmcnt(0)
    s_branch LL_nf30
LL_nk30:
    s_add_u32 m0, s22, 67584
    s_add_u32 s12, s20, 506880
    buffer_load_dwordx4 v3, s[44:47], s12 offen sc1 lds
    s_add_u32 m0, s22, 68672
    s_add_u32 s12, s20, 507904
    buffer_load_dwordx4 v3, s[44:47], s12 offen sc1 lds
    s_add_u32 m0, s22, 69760
    s_add_u32 s12, s20, 508928
    buffer_load_dwordx4 v3, s[44:47], s12 offen sc1 lds
    s_add_u32 m0, s22, 70848
    s_add_u32 s12, s20, 509952
    buffer_load_dwordx4 v3, s[44:47], s12 offen sc1 lds
    s_mov_b32 s12, 1792
    s_add_u32 m0, s23, 67584
    s_nop 0
    buffer_load_dwordx4 v40, s[36:39], s12 offen  lds
    s_add_u32 m0, s23, 68608
    s_nop 0
    buffer_load_dwordx4 v41, s[36:39], s12 offen  lds
    s_add_u32 m0, s23, 69632
    s_nop 0
    buffer_load_dwordx4 v42, s[36:39], s12 offen  lds
    s_add_u32 m0, s23, 70656
    s_nop 0
    buffer_load_dwordx4 v43, s[36:39], s12 offen  lds
    s_waitcnt vmcnt(16)
    s_barrier
    s_mov_b32 s98, 0
LL_nf31:
    v_cmp_ne_u32 vcc, v11, v15
    s_nop 1
    s_and_b32 s25, vcc_lo, 0xc0000000
    s_cbranch_scc0 LL_nk31
    s_add_u32 s98, s98, 1
    s_cmp_gt_u32 s98, 262144
    s_cbranch_scc1 L_end
    s_sleep 4
    buffer_load_dword v11, v9, s[44:47], s24 offen offset:128 sc1
    s_waitcnt vmcnt(0)
    s_branch LL_nf31
LL_nk31:
    s_add_u32 m0, s22, 101376
    s_add_u32 s12, s20, 523776
    buffer_load_dwordx4 v3, s[44:47], s12 offen sc1 lds
    s_add_u32 m0, s22, 102464
    s_add_u32 s12, s20, 524800
    buffer_load_dwordx4 v3, s[44:47], s12 offen sc1 lds
    s_add_u32 m0, s22, 103552
    s_add_u32 s12, s20, 525824
    buffer_load_dwordx4 v3, s[44:47], s12 offen sc1 lds
    s_add_u32 m0, s22, 104640
    s_add_u32 s12, s20, 526848
    buffer_load_dwordx4 v3, s[44:47], s12 offen sc1 lds
    s_mov_b32 s12, 1920
    s_add_u32 m0, s23, 101376
    s_nop 0
    buffer_load_dwordx4 v40, s[36:39], s12 offen  lds
    s_add_u32 m0, s23, 102400
    s_nop 0
    buffer_load_dwordx4 v41, s[36:39], s12 offen  lds
    s_add_u32 m0, s23, 103424
    s_nop 0
    buffer_load_dwordx4 v42, s[36:39], s12 offen  lds
    s_add_u32 m0, s23, 104448
    s_nop 0
    buffer_load_dwordx4 v43, s[36:39], s12 offen  lds
    s_waitcnt vmcnt(16)
    s_barrier
    s_add_u32 m0, s26, 0
    s_add_u32 s12, s27, 0
    buffer_load_dwordx4 v44, s[4:7], s12 offen lds
    s_add_u32 m0, s26, 1024
    s_add_u32 s12, s27, 8192
    buffer_load_dwordx4 v45, s[4:7], s12 offen lds
    s_add_u32 m0, s26, 2048
    s_add_u32 s12, s27, 16384
    buffer_load_dwordx4 v46, s[4:7], s12 offen lds
    s_add_u32 m0, s26, 3072
    s_add_u32 s12, s27, 24576
    buffer_load_dwordx4 v47, s[4:7], s12 offen lds
    s_cmp_eq_u32 s19, 0
    s_cbranch_scc0 LL_t1
    s_mov_b32 m0, 16384
    s_nop 0
    buffer_load_dword v48, s[60:63], s28 offen lds
    s_branch LL_t3
LL_t1:
    s_cmp_eq_u32 s19, 1
    s_cbranch_scc0 LL_t2
    s_mov_b32 m0, 16640
    s_nop 0
    buffer_load_dword v48, s[64:67], s28 offen lds
    s_branch LL_t3
LL_t2:
    s_mov_b32 m0, 16896
    s_nop 0
    buffer_load_dwordx4 v49, s[44:47], s29 offen sc1 lds
LL_t3:
    s_waitcnt vmcnt(13)
    s_barrier
    s_waitcnt vmcnt(5)
    s_barrier
    s_waitcnt vmcnt(0)
    s_barrier
    s_endpgm
L_compute:
    s_load_dwordx4 s[36:39], s[0:1], 8
    s_load_dwordx2 s[40:41], s[0:1], 56
    s_load_dwordx4 s[48:51], s[0:1], 80
    s_load_dwordx2 s[52:53], s[0:1], 128
    s_getreg_b32 s73, hwreg(HW_REG_XCC_ID, 0, 4)
    v_and_b32 v3, 15, v2
    v_lshrrev_b32 v4, 4, v2
    s_and_b32 s21, s19, 1
    s_lshr_b32 s20, s19, 1
    s_lshl_b32 s22, s21, 5
    v_add_u32 v9, s22, v3
    s_and_b32 s22, s14, 15
    s_lshl_b32 s22, s22, 6
    v_add_u32 v10, s22, v9
    v_lshlrev_b32 v10, 1, v10
    s_waitcnt lgkmcnt(0)
    s_cmp_eq_u32 s77, 0
    s_cselect_b32 s36, s36, s48
    s_cselect_b32 s37, s37, s49
    s_cselect_b32 s38, s38, s50
    s_cselect_b32 s39, s39, s51
    s_cselect_b32 s40, s40, s52
    s_cselect_b32 s41, s41, s53
    global_load_ushort v112, v10, s[36:37] offset:0
    global_load_ushort v113, v10, s[38:39] offset:0
    global_load_ushort v114, v10, s[40:41] offset:0
    global_load_ushort v116, v10, s[36:37] offset:32
    global_load_ushort v117, v10, s[38:39] offset:32
    global_load_ushort v118, v10, s[40:41] offset:32
    s_or_b32 s58, s2, s3
    s_cmp_lg_u32 s58, 0
    s_cbranch_scc1 LC_nononce
    s_memrealtime s[54:55]
    s_waitcnt lgkmcnt(0)
    s_or_b32 s54, s54, 1
    v_mov_b32 v12, s54
    v_mov_b32 v13, 0
    s_mov_b64 s[56:57], exec
    s_mov_b64 exec, 1
    global_store_dword v13, v12, s[32:33] sc1
    s_mov_b64 exec, s[56:57]
LC_nononce:
    v_bfe_u32 v5, v2, 1, 3
    v_xor_b32 v6, v4, v5
    v_lshlrev_b32 v6, 4, v6
    v_lshl_add_u32 v6, v3, 7, v6
    s_lshl_b32 s22, s20, 14
    s_lshl_b32 s23, s21, 13
    s_add_u32 s23, s23, 32768
    v_xor_b32 v5, 0, v6
    v_add_u32 v5, 0, v5
    v_add_u32 v16, s22, v5
    v_add_u32 v22, s23, v5
    v_xor_b32 v5, 64, v6
    v_add_u32 v5, 0, v5
    v_add_u32 v17, s22, v5
    v_add_u32 v23, s23, v5
    v_xor_b32 v5, 0, v6
    v_add_u32 v5, 49152, v5
    v_add_u32 v18, s22, v5
    v_add_u32 v24, s23, v5
    v_xor_b32 v5, 64, v6
    v_add_u32 v5, 49152, v5
    v_add_u32 v19, s22, v5
    v_add_u32 v25, s23, v5
    v_xor_b32 v5, 0, v6
    v_add_u32 v5, 98304, v5
    v_add_u32 v20, s22, v5
    v_add_u32 v26, s23, v5
    v_xor_b32 v5, 64, v6
    v_add_u32 v5, 98304, v5
    v_add_u32 v21, s22, v5
    v_add_u32 v27, s23, v5
    v_mov_b32 v128, 0
    v_mov_b32 v129, 0
    v_mov_b32 v130, 0
    v_mov_b32 v131, 0
    v_mov_b32 v132, 0
    v_mov_b32 v133, 0
    v_mov_b32 v134, 0
    v_mov_b32 v135, 0
    v_mov_b32 v136, 0
    v_mov_b32 v137, 0
    v_mov_b32 v138, 0
    v_mov_b32 v139, 0
    v_mov_b32 v140, 0
    v_mov_b32 v141, 0
    v_mov_b32 v142, 0
    v_mov_b32 v143, 0
    v_mov_b32 v144, 0
    v_mov_b32 v145, 0
    v_mov_b32 v146, 0
    v_mov_b32 v147, 0
    v_mov_b32 v148, 0
    v_mov_b32 v149, 0
    v_mov_b32 v150, 0
    v_mov_b32 v151, 0
    v_mov_b32 v152, 0
    v_mov_b32 v153, 0
    v_mov_b32 v154, 0
    v_mov_b32 v155, 0
    v_mov_b32 v156, 0
    v_mov_b32 v157, 0
    v_mov_b32 v158, 0
    v_mov_b32 v159, 0
    v_mov_b32 v160, 0
    v_mov_b32 v161, 0
    v_mov_b32 v162, 0
    v_mov_b32 v163, 0
    v_mov_b32 v164, 0
    v_mov_b32 v165, 0
    v_mov_b32 v166, 0
    v_mov_b32 v167, 0
    v_mov_b32 v168, 0
    v_mov_b32 v169, 0
    v_mov_b32 v170, 0
    v_mov_b32 v171, 0
    v_mov_b32 v172, 0
    v_mov_b32 v173, 0
    v_mov_b32 v174, 0
    v_mov_b32 v175, 0
    v_mov_b32 v176, 0
    v_mov_b32 v177, 0
    v_mov_b32 v178, 0
    v_mov_b32 v179, 0
    v_mov_b32 v180, 0
    v_mov_b32 v181, 0
    v_mov_b32 v182, 0
    v_mov_b32 v183, 0
    v_mov_b32 v184, 0
    v_mov_b32 v185, 0
    v_mov_b32 v186, 0
    v_mov_b32 v187, 0
    v_mov_b32 v188, 0
    v_mov_b32 v189, 0
    v_mov_b32 v190, 0
    v_mov_b32 v191, 0
    v_mov_b32 v192, 0
    v_mov_b32 v193, 0
    v_mov_b32 v194, 0
    v_mov_b32 v195, 0
    v_mov_b32 v196, 0
    v_mov_b32 v197, 0
    v_mov_b32 v198, 0
    v_mov_b32 v199, 0
    v_mov_b32 v200, 0
    v_mov_b32 v201, 0
    v_mov_b32 v202, 0
    v_mov_b32 v203, 0
    v_mov_b32 v204, 0
    v_mov_b32 v205, 0
    v_mov_b32 v206, 0
    v_mov_b32 v207, 0
    v_mov_b32 v208, 0
    v_mov_b32 v209, 0
    v_mov_b32 v210, 0
    v_mov_b32 v211, 0
    v_mov_b32 v212, 0
    v_mov_b32 v213, 0
    v_mov_b32 v214, 0
    v_mov_b32 v215, 0
    v_mov_b32 v216, 0
    v_mov_b32 v217, 0
    v_mov_b32 v218, 0
    v_mov_b32 v219, 0
    v_mov_b32 v220, 0
    v_mov_b32 v221, 0
    v_mov_b32 v222, 0
    v_mov_b32 v223, 0
    v_mov_b32 v224, 0
    v_mov_b32 v225, 0
    v_mov_b32 v226, 0
    v_mov_b32 v227, 0
    v_mov_b32 v228, 0
    v_mov_b32 v229, 0
    v_mov_b32 v230, 0
    v_mov_b32 v231, 0
    v_mov_b32 v232, 0
    v_mov_b32 v233, 0
    v_mov_b32 v234, 0
    v_mov_b32 v235, 0
    v_mov_b32 v236, 0
    v_mov_b32 v237, 0
    v_mov_b32 v238, 0
    v_mov_b32 v239, 0
    v_mov_b32 v240, 0
    v_mov_b32 v241, 0
    v_mov_b32 v242, 0
    v_mov_b32 v243, 0
    v_mov_b32 v244, 0
    v_mov_b32 v245, 0
    v_mov_b32 v246, 0
    v_mov_b32 v247, 0
    v_mov_b32 v248, 0
    v_mov_b32 v249, 0
    v_mov_b32 v250, 0
    v_mov_b32 v251, 0
    v_mov_b32 v252, 0
    v_mov_b32 v253, 0
    v_mov_b32 v254, 0
    v_mov_b32 v255, 0
    s_barrier
    ds_read_b128 v[80:83], v22 offset:0
    ds_read_b128 v[84:87], v22 offset:2048
    ds_read_b128 v[88:91], v22 offset:4096
    ds_read_b128 v[92:95], v22 offset:6144
    ds_read_b128 v[64:67], v16 offset:0
    ds_read_b128 v[68:71], v16 offset:2048
    ds_read_b128 v[72:75], v16 offset:4096
    s_waitcnt lgkmcnt(2)
    v_mfma_f32_16x16x32_bf16 v[128:131], v[64:67], v[80:83], v[128:131]
    ds_read_b128 v[76:79], v16 offset:6144
    v_mfma_f32_16x16x32_bf16 v[132:135], v[64:67], v[84:87], v[132:135]
    v_mfma_f32_16x16x32_bf16 v[136:139], v[64:67], v[88:91], v[136:139]
    v_mfma_f32_16x16x32_bf16 v[140:143], v[64:67], v[92:95], v[140:143]
    s_waitcnt lgkmcnt(2)
    v_mfma_f32_16x16x32_bf16 v[156:159], v[68:71], v[92:95], v[156:159]
    ds_read_b128 v[64:67], v16 offset:8192
    v_mfma_f32_16x16x32_bf16 v[152:155], v[68:71], v[88:91], v[152:155]
    ds_read_b128 v[96:99], v23 offset:0
    v_mfma_f32_16x16x32_bf16 v[148:151], v[68:71], v[84:87], v[148:151]
    v_mfma_f32_16x16x32_bf16 v[144:147], v[68:71], v[80:83], v[144:147]
    s_waitcnt lgkmcnt(3)
    v_mfma_f32_16x16x32_bf16 v[160:163], v[72:75], v[80:83], v[160:163]
    ds_read_b128 v[68:71], v16 offset:10240
    v_mfma_f32_16x16x32_bf16 v[164:167], v[72:75], v[84:87], v[164:167]
    ds_read_b128 v[100:103], v23 offset:2048
    v_mfma_f32_16x16x32_bf16 v[168:171], v[72:75], v[88:91], v[168:171]
    v_mfma_f32_16x16x32_bf16 v[172:175], v[72:75], v[92:95], v[172:175]
    s_waitcnt lgkmcnt(4)
    v_mfma_f32_16x16x32_bf16 v[188:191], v[76:79], v[92:95], v[188:191]
    ds_read_b128 v[72:75], v16 offset:12288
    v_mfma_f32_16x16x32_bf16 v[184:187], v[76:79], v[88:91], v[184:187]
    ds_read_b128 v[104:107], v23 offset:4096
    v_mfma_f32_16x16x32_bf16 v[180:183], v[76:79], v[84:87], v[180:183]
    v_mfma_f32_16x16x32_bf16 v[176:179], v[76:79], v[80:83], v[176:179]
    s_waitcnt lgkmcnt(5)
    v_mfma_f32_16x16x32_bf16 v[192:195], v[64:67], v[80:83], v[192:195]
    ds_read_b128 v[76:79], v16 offset:14336
    v_mfma_f32_16x16x32_bf16 v[196:199], v[64:67], v[84:87], v[196:199]
    ds_read_b128 v[108:111], v23 offset:6144
    v_mfma_f32_16x16x32_bf16 v[200:203], v[64:67], v[88:91], v[200:203]
    v_mfma_f32_16x16x32_bf16 v[204:207], v[64:67], v[92:95], v[204:207]
    s_waitcnt lgkmcnt(5)
    v_mfma_f32_16x16x32_bf16 v[220:223], v[68:71], v[92:95], v[220:223]
    ds_read_b128 v[64:67], v17 offset:0
    v_mfma_f32_16x16x32_bf16 v[216:219], v[68:71], v[88:91], v[216:219]
    v_mfma_f32_16x16x32_bf16 v[212:215], v[68:71], v[84:87], v[212:215]
    v_mfma_f32_16x16x32_bf16 v[208:211], v[68:71], v[80:83], v[208:211]
    s_waitcnt lgkmcnt(4)
    v_mfma_f32_16x16x32_bf16 v[224:227], v[72:75], v[80:83], v[224:227]
    ds_read_b128 v[68:71], v17 offset:2048
    v_mfma_f32_16x16x32_bf16 v[228:231], v[72:75], v[84:87], v[228:231]
    v_mfma_f32_16x16x32_bf16 v[232:235], v[72:75], v[88:91], v[232:235]
    v_mfma_f32_16x16x32_bf16 v[236:239], v[72:75], v[92:95], v[236:239]
    s_waitcnt lgkmcnt(3)
    v_mfma_f32_16x16x32_bf16 v[252:255], v[76:79], v[92:95], v[252:255]
    ds_read_b128 v[72:75], v17 offset:4096
    v_mfma_f32_16x16x32_bf16 v[248:251], v[76:79], v[88:91], v[248:251]
    v_mfma_f32_16x16x32_bf16 v[244:247], v[76:79], v[84:87], v[244:247]
    v_mfma_f32_16x16x32_bf16 v[240:243], v[76:79], v[80:83], v[240:243]
    s_waitcnt lgkmcnt(2)
    v_mfma_f32_16x16x32_bf16 v[128:131], v[64:67], v[96:99], v[128:131]
    ds_read_b128 v[76:79], v17 offset:6144
    v_mfma_f32_16x16x32_bf16 v[132:135], v[64:67], v[100:103], v[132:135]
    v_mfma_f32_16x16x32_bf16 v[136:139], v[64:67], v[104:107], v[136:139]
    v_mfma_f32_16x16x32_bf16 v[140:143], v[64:67], v[108:111], v[140:143]
    s_waitcnt lgkmcnt(2)
    v_mfma_f32_16x16x32_bf16 v[156:159], v[68:71], v[108:111], v[156:159]
    ds_read_b128 v[64:67], v17 offset:8192
    v_mfma_f32_16x16x32_bf16 v[152:155], v[68:71], v[104:107], v[152:155]
    v_mfma_f32_16x16x32_bf16 v[148:151], v[68:71], v[100:103], v[148:151]
    v_mfma_f32_16x16x32_bf16 v[144:147], v[68:71], v[96:99], v[144:147]
    s_waitcnt lgkmcnt(2)
    v_mfma_f32_16x16x32_bf16 v[160:163], v[72:75], v[96:99], v[160:163]
    ds_read_b128 v[68:71], v17 offset:10240
    v_mfma_f32_16x16x32_bf16 v[164:167], v[72:75], v[100:103], v[164:167]
    v_mfma_f32_16x16x32_bf16 v[168:171], v[72:75], v[104:107], v[168:171]
    v_mfma_f32_16x16x32_bf16 v[172:175], v[72:75], v[108:111], v[172:175]
    s_waitcnt lgkmcnt(2)
    v_mfma_f32_16x16x32_bf16 v[188:191], v[76:79], v[108:111], v[188:191]
    ds_read_b128 v[72:75], v17 offset:12288
    v_mfma_f32_16x16x32_bf16 v[184:187], v[76:79], v[104:107], v[184:187]
    v_mfma_f32_16x16x32_bf16 v[180:183], v[76:79], v[100:103], v[180:183]
    v_mfma_f32_16x16x32_bf16 v[176:179], v[76:79], v[96:99], v[176:179]
    s_waitcnt lgkmcnt(2)
    v_mfma_f32_16x16x32_bf16 v[192:195], v[64:67], v[96:99], v[192:195]
    ds_read_b128 v[76:79], v17 offset:14336
    v_mfma_f32_16x16x32_bf16 v[196:199], v[64:67], v[100:103], v[196:199]
    v_mfma_f32_16x16x32_bf16 v[200:203], v[64:67], v[104:107], v[200:203]
    v_mfma_f32_16x16x32_bf16 v[204:207], v[64:67], v[108:111], v[204:207]
    s_waitcnt lgkmcnt(0)
    s_barrier
    v_mfma_f32_16x16x32_bf16 v[220:223], v[68:71], v[108:111], v[220:223]
    ds_read_b128 v[64:67], v18 offset:0
    v_mfma_f32_16x16x32_bf16 v[216:219], v[68:71], v[104:107], v[216:219]
    ds_read_b128 v[80:83], v24 offset:0
    v_mfma_f32_16x16x32_bf16 v[212:215], v[68:71], v[100:103], v[212:215]
    ds_read_b128 v[84:87], v24 offset:2048
    v_mfma_f32_16x16x32_bf16 v[208:211], v[68:71], v[96:99], v[208:211]
    v_mfma_f32_16x16x32_bf16 v[224:227], v[72:75], v[96:99], v[224:227]
    ds_read_b128 v[68:71], v18 offset:2048
    v_mfma_f32_16x16x32_bf16 v[228:231], v[72:75], v[100:103], v[228:231]
    ds_read_b128 v[88:91], v24 offset:4096
    v_mfma_f32_16x16x32_bf16 v[232:235], v[72:75], v[104:107], v[232:235]
    v_mfma_f32_16x16x32_bf16 v[236:239], v[72:75], v[108:111], v[236:239]
    v_mfma_f32_16x16x32_bf16 v[252:255], v[76:79], v[108:111], v[252:255]
    ds_read_b128 v[72:75], v18 offset:4096
    v_mfma_f32_16x16x32_bf16 v[248:251], v[76:79], v[104:107], v[248:251]
    ds_read_b128 v[92:95], v24 offset:6144
    v_mfma_f32_16x16x32_bf16 v[244:247], v[76:79], v[100:103], v[244:247]
    v_mfma_f32_16x16x32_bf16 v[240:243], v[76:79], v[96:99], v[240:243]
    s_waitcnt vmcnt(0)
    v_lshlrev_b32 v112, 16, v112
    v_lshlrev_b32 v113, 16, v113
    v_lshlrev_b32 v114, 16, v114
    v_mul_f32 v29, 0x3fb8aa3b, v114
    s_mov_b32 s58, 0x3fb8aa3b
    v_fma_f32 v30, v114, s58, -v29
    s_mov_b32 s58, 0x32a57060
    v_fma_f32 v30, v114, s58, v30
    v_exp_f32 v29, v29
    v_mul_f32 v30, 0x3f317218, v30
    v_fma_f32 v28, v29, v30, v29
    v_cvt_pk_bf16_f32 v28, v28, v28
    v_lshlrev_b32 v28, 16, v28
    v_mul_f32 v29, v28, v112
    v_mul_f32 v30, v28, v113
    v_mul_f32 v32, 0x3fb8aa3b, v29
    s_mov_b32 s58, 0x3fb8aa3b
    v_fma_f32 v33, v29, s58, -v32
    s_mov_b32 s58, 0x32a57060
    v_fma_f32 v33, v29, s58, v33
    v_exp_f32 v32, v32
    v_mul_f32 v33, 0x3f317218, v33
    v_fma_f32 v31, v32, v33, v32
    v_mul_f32 v30, 0.15915494, v30
    v_rndne_f32 v32, v30
    v_sub_f32 v30, v30, v32
    v_cos_f32 v32, v30
    v_sin_f32 v33, v30
    s_nop 0
    v_mul_f32 v40, v31, v32
    v_mul_f32 v41, v31, v33
    v_add_f32 v34, -1.0, v40
    v_mul_f32 v35, v112, v112
    v_fma_f32 v35, v113, v113, v35
    v_rcp_f32 v35, v35
    v_mul_f32 v36, v34, v112
    v_fma_f32 v36, v41, v113, v36
    v_mul_f32 v37, v41, v112
    v_fma_f32 v37, -v34, v113, v37
    v_add_f32 v35, v35, v35
    v_mul_f32 v42, v36, v35
    v_mul_f32 v43, v37, v35
    v_mul_f32 v28, v40, v40
    v_mul_f32 v29, v40, v41
    v_fma_f32 v28, -v41, v41, v28
    v_add_f32 v29, v29, v29
    v_mul_f32 v30, v28, v28
    v_mul_f32 v31, v28, v29
    v_fma_f32 v30, -v29, v29, v30
    v_add_f32 v31, v31, v31
    v_mul_f32 v28, v30, v30
    v_mul_f32 v29, v30, v31
    v_fma_f32 v28, -v31, v31, v28
    v_add_f32 v29, v29, v29
    v_mul_f32 v44, v28, v28
    v_mul_f32 v45, v28, v29
    v_fma_f32 v44, -v29, v29, v44
    v_add_f32 v45, v45, v45
    v_mul_f32 v46, v44, v44
    v_mul_f32 v47, v44, v45
    v_fma_f32 v46, -v45, v45, v46
    v_add_f32 v47, v47, v47
    v_mul_f32 v28, v46, v46
    v_mul_f32 v29, v46, v47
    v_fma_f32 v28, -v47, v47, v28
    v_add_f32 v29, v29, v29
    v_mul_f32 v30, v28, v28
    v_mul_f32 v31, v28, v29
    v_fma_f32 v30, -v29, v29, v30
    v_add_f32 v31, v31, v31
    v_mul_f32 v48, v30, v30
    v_mul_f32 v49, v30, v31
    v_fma_f32 v48, -v31, v31, v48
    v_add_f32 v49, v49, v49
    v_lshlrev_b32 v116, 16, v116
    v_lshlrev_b32 v117, 16, v117
    v_lshlrev_b32 v118, 16, v118
    v_mul_f32 v29, 0x3fb8aa3b, v118
    s_mov_b32 s58, 0x3fb8aa3b
    v_fma_f32 v30, v118, s58, -v29
    s_mov_b32 s58, 0x32a57060
    v_fma_f32 v30, v118, s58, v30
    v_exp_f32 v29, v29
    v_mul_f32 v30, 0x3f317218, v30
    v_fma_f32 v28, v29, v30, v29
    v_cvt_pk_bf16_f32 v28, v28, v28
    v_lshlrev_b32 v28, 16, v28
    v_mul_f32 v29, v28, v116
    v_mul_f32 v30, v28, v117
    v_mul_f32 v32, 0x3fb8aa3b, v29
    s_mov_b32 s58, 0x3fb8aa3b
    v_fma_f32 v33, v29, s58, -v32
    s_mov_b32 s58, 0x32a57060
    v_fma_f32 v33, v29, s58, v33
    v_exp_f32 v32, v32
    v_mul_f32 v33, 0x3f317218, v33
    v_fma_f32 v31, v32, v33, v32
    v_mul_f32 v30, 0.15915494, v30
    v_rndne_f32 v32, v30
    v_sub_f32 v30, v30, v32
    v_cos_f32 v32, v30
    v_sin_f32 v33, v30
    s_nop 0
    v_mul_f32 v52, v31, v32
    v_mul_f32 v53, v31, v33
    v_add_f32 v34, -1.0, v52
    v_mul_f32 v35, v116, v116
    v_fma_f32 v35, v117, v117, v35
    v_rcp_f32 v35, v35
    v_mul_f32 v36, v34, v116
    v_fma_f32 v36, v53, v117, v36
    v_mul_f32 v37, v53, v116
    v_fma_f32 v37, -v34, v117, v37
    v_add_f32 v35, v35, v35
    v_mul_f32 v54, v36, v35
    v_mul_f32 v55, v37, v35
    v_mul_f32 v28, v52, v52
    v_mul_f32 v29, v52, v53
    v_fma_f32 v28, -v53, v53, v28
    v_add_f32 v29, v29, v29
    v_mul_f32 v30, v28, v28
    v_mul_f32 v31, v28, v29
    v_fma_f32 v30, -v29, v29, v30
    v_add_f32 v31, v31, v31
    v_mul_f32 v28, v30, v30
    v_mul_f32 v29, v30, v31
    v_fma_f32 v28, -v31, v31, v28
    v_add_f32 v29, v29, v29
    v_mul_f32 v56, v28, v28
    v_mul_f32 v57, v28, v29
    v_fma_f32 v56, -v29, v29, v56
    v_add_f32 v57, v57, v57
    v_mul_f32 v58, v56, v56
    v_mul_f32 v59, v56, v57
    v_fma_f32 v58, -v57, v57, v58
    v_add_f32 v59, v59, v59
    v_mul_f32 v28, v58, v58
    v_mul_f32 v29, v58, v59
    v_fma_f32 v28, -v59, v59, v28
    v_add_f32 v29, v29, v29
    v_mul_f32 v30, v28, v28
    v_mul_f32 v31, v28, v29
    v_fma_f32 v30, -v29, v29, v30
    v_add_f32 v31, v31, v31
    v_mul_f32 v60, v30, v30
    v_mul_f32 v61, v30, v31
    v_fma_f32 v60, -v31, v31, v60
    v_add_f32 v61, v61, v61
    s_waitcnt lgkmcnt(5)
    v_mfma_f32_16x16x32_bf16 v[128:131], v[64:67], v[80:83], v[128:131]
    ds_read_b128 v[76:79], v18 offset:6144
    s_waitcnt lgkmcnt(5)
    v_mfma_f32_16x16x32_bf16 v[132:135], v[64:67], v[84:87], v[132:135]
    s_waitcnt lgkmcnt(3)
    v_mfma_f32_16x16x32_bf16 v[136:139], v[64:67], v[88:91], v[136:139]
    s_waitcnt lgkmcnt(1)
    v_mfma_f32_16x16x32_bf16 v[140:143], v[64:67], v[92:95], v[140:143]
    v_mfma_f32_16x16x32_bf16 v[156:159], v[68:71], v[92:95], v[156:159]
    ds_read_b128 v[64:67], v18 offset:8192
    v_mfma_f32_16x16x32_bf16 v[152:155], v[68:71], v[88:91], v[152:155]
    ds_read_b128 v[96:99], v25 offset:0
    v_mfma_f32_16x16x32_bf16 v[148:151], v[68:71], v[84:87], v[148:151]
    v_mfma_f32_16x16x32_bf16 v[144:147], v[68:71], v[80:83], v[144:147]
    v_mfma_f32_16x16x32_bf16 v[160:163], v[72:75], v[80:83], v[160:163]
    ds_read_b128 v[68:71], v18 offset:10240
    v_mfma_f32_16x16x32_bf16 v[164:167], v[72:75], v[84:87], v[164:167]
    ds_read_b128 v[100:103], v25 offset:2048
    v_mfma_f32_16x16x32_bf16 v[168:171], v[72:75], v[88:91], v[168:171]
    v_mfma_f32_16x16x32_bf16 v[172:175], v[72:75], v[92:95], v[172:175]
    s_waitcnt lgkmcnt(4)
    v_mfma_f32_16x16x32_bf16 v[188:191], v[76:79], v[92:95], v[188:191]
    ds_read_b128 v[72:75], v18 offset:12288
    v_mfma_f32_16x16x32_bf16 v[184:187], v[76:79], v[88:91], v[184:187]
    ds_read_b128 v[104:107], v25 offset:4096
    v_mfma_f32_16x16x32_bf16 v[180:183], v[76:79], v[84:87], v[180:183]
    v_mfma_f32_16x16x32_bf16 v[176:179], v[76:79], v[80:83], v[176:179]
    s_waitcnt lgkmcnt(5)
    v_mfma_f32_16x16x32_bf16 v[192:195], v[64:67], v[80:83], v[192:195]
    ds_read_b128 v[76:79], v18 offset:14336
    v_mfma_f32_16x16x32_bf16 v[196:199], v[64:67], v[84:87], v[196:199]
    ds_read_b128 v[108:111], v25 offset:6144
    v_mfma_f32_16x16x32_bf16 v[200:203], v[64:67], v[88:91], v[200:203]
    v_mfma_f32_16x16x32_bf16 v[204:207], v[64:67], v[92:95], v[204:207]
    s_waitcnt lgkmcnt(5)
    v_mfma_f32_16x16x32_bf16 v[220:223], v[68:71], v[92:95], v[220:223]
    ds_read_b128 v[64:67], v19 offset:0
    v_mfma_f32_16x16x32_bf16 v[216:219], v[68:71], v[88:91], v[216:219]
    v_mfma_f32_16x16x32_bf16 v[212:215], v[68:71], v[84:87], v[212:215]
    v_mfma_f32_16x16x32_bf16 v[208:211], v[68:71], v[80:83], v[208:211]
    s_waitcnt lgkmcnt(4)
    v_mfma_f32_16x16x32_bf16 v[224:227], v[72:75], v[80:83], v[224:227]
    ds_read_b128 v[68:71], v19 offset:2048
    v_mfma_f32_16x16x32_bf16 v[228:231], v[72:75], v[84:87], v[228:231]
    v_mfma_f32_16x16x32_bf16 v[232:235], v[72:75], v[88:91], v[232:235]
    v_mfma_f32_16x16x32_bf16 v[236:239], v[72:75], v[92:95], v[236:239]
    s_waitcnt lgkmcnt(3)
    v_mfma_f32_16x16x32_bf16 v[252:255], v[76:79], v[92:95], v[252:255]
    ds_read_b128 v[72:75], v19 offset:4096
    v_mfma_f32_16x16x32_bf16 v[248:251], v[76:79], v[88:91], v[248:251]
    v_mfma_f32_16x16x32_bf16 v[244:247], v[76:79], v[84:87], v[244:247]
    v_mfma_f32_16x16x32_bf16 v[240:243], v[76:79], v[80:83], v[240:243]
    s_waitcnt lgkmcnt(2)
    v_mfma_f32_16x16x32_bf16 v[128:131], v[64:67], v[96:99], v[128:131]
    ds_read_b128 v[76:79], v19 offset:6144
    v_mfma_f32_16x16x32_bf16 v[132:135], v[64:67], v[100:103], v[132:135]
    v_mfma_f32_16x16x32_bf16 v[136:139], v[64:67], v[104:107], v[136:139]
    v_mfma_f32_16x16x32_bf16 v[140:143], v[64:67], v[108:111], v[140:143]
    s_waitcnt lgkmcnt(2)
    v_mfma_f32_16x16x32_bf16 v[156:159], v[68:71], v[108:111], v[156:159]
    ds_read_b128 v[64:67], v19 offset:8192
    v_mfma_f32_16x16x32_bf16 v[152:155], v[68:71], v[104:107], v[152:155]
    v_mfma_f32_16x16x32_bf16 v[148:151], v[68:71], v[100:103], v[148:151]
    v_mfma_f32_16x16x32_bf16 v[144:147], v[68:71], v[96:99], v[144:147]
    s_waitcnt lgkmcnt(2)
    v_mfma_f32_16x16x32_bf16 v[160:163], v[72:75], v[96:99], v[160:163]
    ds_read_b128 v[68:71], v19 offset:10240
    v_mfma_f32_16x16x32_bf16 v[164:167], v[72:75], v[100:103], v[164:167]
    v_mfma_f32_16x16x32_bf16 v[168:171], v[72:75], v[104:107], v[168:171]
    v_mfma_f32_16x16x32_bf16 v[172:175], v[72:75], v[108:111], v[172:175]
    s_waitcnt lgkmcnt(2)
    v_mfma_f32_16x16x32_bf16 v[188:191], v[76:79], v[108:111], v[188:191]
    ds_read_b128 v[72:75], v19 offset:12288
    v_mfma_f32_16x16x32_bf16 v[184:187], v[76:79], v[104:107], v[184:187]
    v_mfma_f32_16x16x32_bf16 v[180:183], v[76:79], v[100:103], v[180:183]
    v_mfma_f32_16x16x32_bf16 v[176:179], v[76:79], v[96:99], v[176:179]
    s_waitcnt lgkmcnt(2)
    v_mfma_f32_16x16x32_bf16 v[192:195], v[64:67], v[96:99], v[192:195]
    ds_read_b128 v[76:79], v19 offset:14336
    v_mfma_f32_16x16x32_bf16 v[196:199], v[64:67], v[100:103], v[196:199]
    v_mfma_f32_16x16x32_bf16 v[200:203], v[64:67], v[104:107], v[200:203]
    v_mfma_f32_16x16x32_bf16 v[204:207], v[64:67], v[108:111], v[204:207]
    s_waitcnt lgkmcnt(0)
    s_barrier
    v_mfma_f32_16x16x32_bf16 v[220:223], v[68:71], v[108:111], v[220:223]
    ds_read_b128 v[64:67], v20 offset:0
    v_mfma_f32_16x16x32_bf16 v[216:219], v[68:71], v[104:107], v[216:219]
    ds_read_b128 v[80:83], v26 offset:0
    v_mfma_f32_16x16x32_bf16 v[212:215], v[68:71], v[100:103], v[212:215]
    ds_read_b128 v[84:87], v26 offset:2048
    v_mfma_f32_16x16x32_bf16 v[208:211], v[68:71], v[96:99], v[208:211]
    v_mfma_f32_16x16x32_bf16 v[224:227], v[72:75], v[96:99], v[224:227]
    ds_read_b128 v[68:71], v20 offset:2048
    v_mfma_f32_16x16x32_bf16 v[228:231], v[72:75], v[100:103], v[228:231]
    ds_read_b128 v[88:91], v26 offset:4096
    v_mfma_f32_16x16x32_bf16 v[232:235], v[72:75], v[104:107], v[232:235]
    v_mfma_f32_16x16x32_bf16 v[236:239], v[72:75], v[108:111], v[236:239]
    v_mfma_f32_16x16x32_bf16 v[252:255], v[76:79], v[108:111], v[252:255]
    ds_read_b128 v[72:75], v20 offset:4096
    v_mfma_f32_16x16x32_bf16 v[248:251], v[76:79], v[104:107], v[248:251]
    ds_read_b128 v[92:95], v26 offset:6144
    v_mfma_f32_16x16x32_bf16 v[244:247], v[76:79], v[100:103], v[244:247]
    v_mfma_f32_16x16x32_bf16 v[240:243], v[76:79], v[96:99], v[240:243]
    s_waitcnt lgkmcnt(5)
    v_mfma_f32_16x16x32_bf16 v[128:131], v[64:67], v[80:83], v[128:131]
    ds_read_b128 v[76:79], v20 offset:6144
    s_waitcnt lgkmcnt(5)
    v_mfma_f32_16x16x32_bf16 v[132:135], v[64:67], v[84:87], v[132:135]
    s_waitcnt lgkmcnt(3)
    v_mfma_f32_16x16x32_bf16 v[136:139], v[64:67], v[88:91], v[136:139]
    s_waitcnt lgkmcnt(1)
    v_mfma_f32_16x16x32_bf16 v[140:143], v[64:67], v[92:95], v[140:143]
    v_mfma_f32_16x16x32_bf16 v[156:159], v[68:71], v[92:95], v[156:159]
    ds_read_b128 v[64:67], v20 offset:8192
    v_mfma_f32_16x16x32_bf16 v[152:155], v[68:71], v[88:91], v[152:155]
    ds_read_b128 v[96:99], v27 offset:0
    v_mfma_f32_16x16x32_bf16 v[148:151], v[68:71], v[84:87], v[148:151]
    v_mfma_f32_16x16x32_bf16 v[144:147], v[68:71], v[80:83], v[144:147]
    v_mfma_f32_16x16x32_bf16 v[160:163], v[72:75], v[80:83], v[160:163]
    ds_read_b128 v[68:71], v20 offset:10240
    v_mfma_f32_16x16x32_bf16 v[164:167], v[72:75], v[84:87], v[164:167]
    ds_read_b128 v[100:103], v27 offset:2048
    v_mfma_f32_16x16x32_bf16 v[168:171], v[72:75], v[88:91], v[168:171]
    v_mfma_f32_16x16x32_bf16 v[172:175], v[72:75], v[92:95], v[172:175]
    s_waitcnt lgkmcnt(4)
    v_mfma_f32_16x16x32_bf16 v[188:191], v[76:79], v[92:95], v[188:191]
    ds_read_b128 v[72:75], v20 offset:12288
    v_mfma_f32_16x16x32_bf16 v[184:187], v[76:79], v[88:91], v[184:187]
    ds_read_b128 v[104:107], v27 offset:4096
    v_mfma_f32_16x16x32_bf16 v[180:183], v[76:79], v[84:87], v[180:183]
    v_mfma_f32_16x16x32_bf16 v[176:179], v[76:79], v[80:83], v[176:179]
    s_waitcnt lgkmcnt(5)
    v_mfma_f32_16x16x32_bf16 v[192:195], v[64:67], v[80:83], v[192:195]
    ds_read_b128 v[76:79], v20 offset:14336
    v_mfma_f32_16x16x32_bf16 v[196:199], v[64:67], v[84:87], v[196:199]
    ds_read_b128 v[108:111], v27 offset:6144
    v_mfma_f32_16x16x32_bf16 v[200:203], v[64:67], v[88:91], v[200:203]
    v_mfma_f32_16x16x32_bf16 v[204:207], v[64:67], v[92:95], v[204:207]
    s_waitcnt lgkmcnt(5)
    v_mfma_f32_16x16x32_bf16 v[220:223], v[68:71], v[92:95], v[220:223]
    ds_read_b128 v[64:67], v21 offset:0
    v_mfma_f32_16x16x32_bf16 v[216:219], v[68:71], v[88:91], v[216:219]
    v_mfma_f32_16x16x32_bf16 v[212:215], v[68:71], v[84:87], v[212:215]
    v_mfma_f32_16x16x32_bf16 v[208:211], v[68:71], v[80:83], v[208:211]
    s_waitcnt lgkmcnt(4)
    v_mfma_f32_16x16x32_bf16 v[224:227], v[72:75], v[80:83], v[224:227]
    ds_read_b128 v[68:71], v21 offset:2048
    v_mfma_f32_16x16x32_bf16 v[228:231], v[72:75], v[84:87], v[228:231]
    v_mfma_f32_16x16x32_bf16 v[232:235], v[72:75], v[88:91], v[232:235]
    v_mfma_f32_16x16x32_bf16 v[236:239], v[72:75], v[92:95], v[236:239]
    s_waitcnt lgkmcnt(3)
    v_mfma_f32_16x16x32_bf16 v[252:255], v[76:79], v[92:95], v[252:255]
    ds_read_b128 v[72:75], v21 offset:4096
    v_mfma_f32_16x16x32_bf16 v[248:251], v[76:79], v[88:91], v[248:251]
    v_mfma_f32_16x16x32_bf16 v[244:247], v[76:79], v[84:87], v[244:247]
    v_mfma_f32_16x16x32_bf16 v[240:243], v[76:79], v[80:83], v[240:243]
    s_waitcnt lgkmcnt(2)
    v_mfma_f32_16x16x32_bf16 v[128:131], v[64:67], v[96:99], v[128:131]
    ds_read_b128 v[76:79], v21 offset:6144
    v_mfma_f32_16x16x32_bf16 v[132:135], v[64:67], v[100:103], v[132:135]
    v_mfma_f32_16x16x32_bf16 v[136:139], v[64:67], v[104:107], v[136:139]
    v_mfma_f32_16x16x32_bf16 v[140:143], v[64:67], v[108:111], v[140:143]
    s_waitcnt lgkmcnt(2)
    v_mfma_f32_16x16x32_bf16 v[156:159], v[68:71], v[108:111], v[156:159]
    ds_read_b128 v[64:67], v21 offset:8192
    v_mfma_f32_16x16x32_bf16 v[152:155], v[68:71], v[104:107], v[152:155]
    v_mfma_f32_16x16x32_bf16 v[148:151], v[68:71], v[100:103], v[148:151]
    v_mfma_f32_16x16x32_bf16 v[144:147], v[68:71], v[96:99], v[144:147]
    s_waitcnt lgkmcnt(2)
    v_mfma_f32_16x16x32_bf16 v[160:163], v[72:75], v[96:99], v[160:163]
    ds_read_b128 v[68:71], v21 offset:10240
    v_mfma_f32_16x16x32_bf16 v[164:167], v[72:75], v[100:103], v[164:167]
    v_mfma_f32_16x16x32_bf16 v[168:171], v[72:75], v[104:107], v[168:171]
    v_mfma_f32_16x16x32_bf16 v[172:175], v[72:75], v[108:111], v[172:175]
    s_waitcnt lgkmcnt(2)
    v_mfma_f32_16x16x32_bf16 v[188:191], v[76:79], v[108:111], v[188:191]
    ds_read_b128 v[72:75], v21 offset:12288
    v_mfma_f32_16x16x32_bf16 v[184:187], v[76:79], v[104:107], v[184:187]
    v_mfma_f32_16x16x32_bf16 v[180:183], v[76:79], v[100:103], v[180:183]
    v_mfma_f32_16x16x32_bf16 v[176:179], v[76:79], v[96:99], v[176:179]
    s_waitcnt lgkmcnt(2)
    v_mfma_f32_16x16x32_bf16 v[192:195], v[64:67], v[96:99], v[192:195]
    ds_read_b128 v[76:79], v21 offset:14336
    v_mfma_f32_16x16x32_bf16 v[196:199], v[64:67], v[100:103], v[196:199]
    v_mfma_f32_16x16x32_bf16 v[200:203], v[64:67], v[104:107], v[200:203]
    v_mfma_f32_16x16x32_bf16 v[204:207], v[64:67], v[108:111], v[204:207]
    s_waitcnt lgkmcnt(0)
    s_barrier
    v_mfma_f32_16x16x32_bf16 v[220:223], v[68:71], v[108:111], v[220:223]
    ds_read_b128 v[64:67], v16 offset:0
    v_mfma_f32_16x16x32_bf16 v[216:219], v[68:71], v[104:107], v[216:219]
    ds_read_b128 v[80:83], v22 offset:0
    v_mfma_f32_16x16x32_bf16 v[212:215], v[68:71], v[100:103], v[212:215]
    ds_read_b128 v[84:87], v22 offset:2048
    v_mfma_f32_16x16x32_bf16 v[208:211], v[68:71], v[96:99], v[208:211]
    v_mfma_f32_16x16x32_bf16 v[224:227], v[72:75], v[96:99], v[224:227]
    ds_read_b128 v[68:71], v16 offset:2048
    v_mfma_f32_16x16x32_bf16 v[228:231], v[72:75], v[100:103], v[228:231]
    ds_read_b128 v[88:91], v22 offset:4096
    v_mfma_f32_16x16x32_bf16 v[232:235], v[72:75], v[104:107], v[232:235]
    v_mfma_f32_16x16x32_bf16 v[236:239], v[72:75], v[108:111], v[236:239]
    v_mfma_f32_16x16x32_bf16 v[252:255], v[76:79], v[108:111], v[252:255]
    ds_read_b128 v[72:75], v16 offset:4096
    v_mfma_f32_16x16x32_bf16 v[248:251], v[76:79], v[104:107], v[248:251]
    ds_read_b128 v[92:95], v22 offset:6144
    v_mfma_f32_16x16x32_bf16 v[244:247], v[76:79], v[100:103], v[244:247]
    v_mfma_f32_16x16x32_bf16 v[240:243], v[76:79], v[96:99], v[240:243]
    s_waitcnt lgkmcnt(5)
    v_mfma_f32_16x16x32_bf16 v[128:131], v[64:67], v[80:83], v[128:131]
    ds_read_b128 v[76:79], v16 offset:6144
    s_waitcnt lgkmcnt(5)
    v_mfma_f32_16x16x32_bf16 v[132:135], v[64:67], v[84:87], v[132:135]
    s_waitcnt lgkmcnt(3)
    v_mfma_f32_16x16x32_bf16 v[136:139], v[64:67], v[88:91], v[136:139]
    s_waitcnt lgkmcnt(1)
    v_mfma_f32_16x16x32_bf16 v[140:143], v[64:67], v[92:95], v[140:143]
    v_mfma_f32_16x16x32_bf16 v[156:159], v[68:71], v[92:95], v[156:159]
    ds_read_b128 v[64:67], v16 offset:8192
    v_mfma_f32_16x16x32_bf16 v[152:155], v[68:71], v[88:91], v[152:155]
    ds_read_b128 v[96:99], v23 offset:0
    v_mfma_f32_16x16x32_bf16 v[148:151], v[68:71], v[84:87], v[148:151]
    v_mfma_f32_16x16x32_bf16 v[144:147], v[68:71], v[80:83], v[144:147]
    v_mfma_f32_16x16x32_bf16 v[160:163], v[72:75], v[80:83], v[160:163]
    ds_read_b128 v[68:71], v16 offset:10240
    v_mfma_f32_16x16x32_bf16 v[164:167], v[72:75], v[84:87], v[164:167]
    ds_read_b128 v[100:103], v23 offset:2048
    v_mfma_f32_16x16x32_bf16 v[168:171], v[72:75], v[88:91], v[168:171]
    v_mfma_f32_16x16x32_bf16 v[172:175], v[72:75], v[92:95], v[172:175]
    s_waitcnt lgkmcnt(4)
    v_mfma_f32_16x16x32_bf16 v[188:191], v[76:79], v[92:95], v[188:191]
    ds_read_b128 v[72:75], v16 offset:12288
    v_mfma_f32_16x16x32_bf16 v[184:187], v[76:79], v[88:91], v[184:187]
    ds_read_b128 v[104:107], v23 offset:4096
    v_mfma_f32_16x16x32_bf16 v[180:183], v[76:79], v[84:87], v[180:183]
    v_mfma_f32_16x16x32_bf16 v[176:179], v[76:79], v[80:83], v[176:179]
    s_waitcnt lgkmcnt(5)
    v_mfma_f32_16x16x32_bf16 v[192:195], v[64:67], v[80:83], v[192:195]
    ds_read_b128 v[76:79], v16 offset:14336
    v_mfma_f32_16x16x32_bf16 v[196:199], v[64:67], v[84:87], v[196:199]
    ds_read_b128 v[108:111], v23 offset:6144
    v_mfma_f32_16x16x32_bf16 v[200:203], v[64:67], v[88:91], v[200:203]
    v_mfma_f32_16x16x32_bf16 v[204:207], v[64:67], v[92:95], v[204:207]
    s_waitcnt lgkmcnt(5)
    v_mfma_f32_16x16x32_bf16 v[220:223], v[68:71], v[92:95], v[220:223]
    ds_read_b128 v[64:67], v17 offset:0
    v_mfma_f32_16x16x32_bf16 v[216:219], v[68:71], v[88:91], v[216:219]
    v_mfma_f32_16x16x32_bf16 v[212:215], v[68:71], v[84:87], v[212:215]
    v_mfma_f32_16x16x32_bf16 v[208:211], v[68:71], v[80:83], v[208:211]
    s_waitcnt lgkmcnt(4)
    v_mfma_f32_16x16x32_bf16 v[224:227], v[72:75], v[80:83], v[224:227]
    ds_read_b128 v[68:71], v17 offset:2048
    v_mfma_f32_16x16x32_bf16 v[228:231], v[72:75], v[84:87], v[228:231]
    v_mfma_f32_16x16x32_bf16 v[232:235], v[72:75], v[88:91], v[232:235]
    v_mfma_f32_16x16x32_bf16 v[236:239], v[72:75], v[92:95], v[236:239]
    s_waitcnt lgkmcnt(3)
    v_mfma_f32_16x16x32_bf16 v[252:255], v[76:79], v[92:95], v[252:255]
    ds_read_b128 v[72:75], v17 offset:4096
    v_mfma_f32_16x16x32_bf16 v[248:251], v[76:79], v[88:91], v[248:251]
    v_mfma_f32_16x16x32_bf16 v[244:247], v[76:79], v[84:87], v[244:247]
    v_mfma_f32_16x16x32_bf16 v[240:243], v[76:79], v[80:83], v[240:243]
    s_waitcnt lgkmcnt(2)
    v_mfma_f32_16x16x32_bf16 v[128:131], v[64:67], v[96:99], v[128:131]
    ds_read_b128 v[76:79], v17 offset:6144
    v_mfma_f32_16x16x32_bf16 v[132:135], v[64:67], v[100:103], v[132:135]
    v_mfma_f32_16x16x32_bf16 v[136:139], v[64:67], v[104:107], v[136:139]
    v_mfma_f32_16x16x32_bf16 v[140:143], v[64:67], v[108:111], v[140:143]
    s_waitcnt lgkmcnt(2)
    v_mfma_f32_16x16x32_bf16 v[156:159], v[68:71], v[108:111], v[156:159]
    ds_read_b128 v[64:67], v17 offset:8192
    v_mfma_f32_16x16x32_bf16 v[152:155], v[68:71], v[104:107], v[152:155]
    v_mfma_f32_16x16x32_bf16 v[148:151], v[68:71], v[100:103], v[148:151]
    v_mfma_f32_16x16x32_bf16 v[144:147], v[68:71], v[96:99], v[144:147]
    s_waitcnt lgkmcnt(2)
    v_mfma_f32_16x16x32_bf16 v[160:163], v[72:75], v[96:99], v[160:163]
    ds_read_b128 v[68:71], v17 offset:10240
    v_mfma_f32_16x16x32_bf16 v[164:167], v[72:75], v[100:103], v[164:167]
    v_mfma_f32_16x16x32_bf16 v[168:171], v[72:75], v[104:107], v[168:171]
    v_mfma_f32_16x16x32_bf16 v[172:175], v[72:75], v[108:111], v[172:175]
    s_waitcnt lgkmcnt(2)
    v_mfma_f32_16x16x32_bf16 v[188:191], v[76:79], v[108:111], v[188:191]
    ds_read_b128 v[72:75], v17 offset:12288
    v_mfma_f32_16x16x32_bf16 v[184:187], v[76:79], v[104:107], v[184:187]
    v_mfma_f32_16x16x32_bf16 v[180:183], v[76:79], v[100:103], v[180:183]
    v_mfma_f32_16x16x32_bf16 v[176:179], v[76:79], v[96:99], v[176:179]
    s_waitcnt lgkmcnt(2)
    v_mfma_f32_16x16x32_bf16 v[192:195], v[64:67], v[96:99], v[192:195]
    ds_read_b128 v[76:79], v17 offset:14336
    v_mfma_f32_16x16x32_bf16 v[196:199], v[64:67], v[100:103], v[196:199]
    v_mfma_f32_16x16x32_bf16 v[200:203], v[64:67], v[104:107], v[200:203]
    v_mfma_f32_16x16x32_bf16 v[204:207], v[64:67], v[108:111], v[204:207]
    s_waitcnt lgkmcnt(0)
    s_barrier
    v_mfma_f32_16x16x32_bf16 v[220:223], v[68:71], v[108:111], v[220:223]
    ds_read_b128 v[64:67], v18 offset:0
    v_mfma_f32_16x16x32_bf16 v[216:219], v[68:71], v[104:107], v[216:219]
    ds_read_b128 v[80:83], v24 offset:0
    v_mfma_f32_16x16x32_bf16 v[212:215], v[68:71], v[100:103], v[212:215]
    ds_read_b128 v[84:87], v24 offset:2048
    v_mfma_f32_16x16x32_bf16 v[208:211], v[68:71], v[96:99], v[208:211]
    v_mfma_f32_16x16x32_bf16 v[224:227], v[72:75], v[96:99], v[224:227]
    ds_read_b128 v[68:71], v18 offset:2048
    v_mfma_f32_16x16x32_bf16 v[228:231], v[72:75], v[100:103], v[228:231]
    ds_read_b128 v[88:91], v24 offset:4096
    v_mfma_f32_16x16x32_bf16 v[232:235], v[72:75], v[104:107], v[232:235]
    v_mfma_f32_16x16x32_bf16 v[236:239], v[72:75], v[108:111], v[236:239]
    v_mfma_f32_16x16x32_bf16 v[252:255], v[76:79], v[108:111], v[252:255]
    ds_read_b128 v[72:75], v18 offset:4096
    v_mfma_f32_16x16x32_bf16 v[248:251], v[76:79], v[104:107], v[248:251]
    ds_read_b128 v[92:95], v24 offset:6144
    v_mfma_f32_16x16x32_bf16 v[244:247], v[76:79], v[100:103], v[244:247]
    v_mfma_f32_16x16x32_bf16 v[240:243], v[76:79], v[96:99], v[240:243]
    s_waitcnt lgkmcnt(5)
    v_mfma_f32_16x16x32_bf16 v[128:131], v[64:67], v[80:83], v[128:131]
    ds_read_b128 v[76:79], v18 offset:6144
    s_waitcnt lgkmcnt(5)
    v_mfma_f32_16x16x32_bf16 v[132:135], v[64:67], v[84:87], v[132:135]
    s_waitcnt lgkmcnt(3)
    v_mfma_f32_16x16x32_bf16 v[136:139], v[64:67], v[88:91], v[136:139]
    s_waitcnt lgkmcnt(1)
    v_mfma_f32_16x16x32_bf16 v[140:143], v[64:67], v[92:95], v[140:143]
    v_mfma_f32_16x16x32_bf16 v[156:159], v[68:71], v[92:95], v[156:159]
    ds_read_b128 v[64:67], v18 offset:8192
    v_mfma_f32_16x16x32_bf16 v[152:155], v[68:71], v[88:91], v[152:155]
    ds_read_b128 v[96:99], v25 offset:0
    v_mfma_f32_16x16x32_bf16 v[148:151], v[68:71], v[84:87], v[148:151]
    v_mfma_f32_16x16x32_bf16 v[144:147], v[68:71], v[80:83], v[144:147]
    v_mfma_f32_16x16x32_bf16 v[160:163], v[72:75], v[80:83], v[160:163]
    ds_read_b128 v[68:71], v18 offset:10240
    v_mfma_f32_16x16x32_bf16 v[164:167], v[72:75], v[84:87], v[164:167]
    ds_read_b128 v[100:103], v25 offset:2048
    v_mfma_f32_16x16x32_bf16 v[168:171], v[72:75], v[88:91], v[168:171]
    v_mfma_f32_16x16x32_bf16 v[172:175], v[72:75], v[92:95], v[172:175]
    s_waitcnt lgkmcnt(4)
    v_mfma_f32_16x16x32_bf16 v[188:191], v[76:79], v[92:95], v[188:191]
    ds_read_b128 v[72:75], v18 offset:12288
    v_mfma_f32_16x16x32_bf16 v[184:187], v[76:79], v[88:91], v[184:187]
    ds_read_b128 v[104:107], v25 offset:4096
    v_mfma_f32_16x16x32_bf16 v[180:183], v[76:79], v[84:87], v[180:183]
    v_mfma_f32_16x16x32_bf16 v[176:179], v[76:79], v[80:83], v[176:179]
    s_waitcnt lgkmcnt(5)
    v_mfma_f32_16x16x32_bf16 v[192:195], v[64:67], v[80:83], v[192:195]
    ds_read_b128 v[76:79], v18 offset:14336
    v_mfma_f32_16x16x32_bf16 v[196:199], v[64:67], v[84:87], v[196:199]
    ds_read_b128 v[108:111], v25 offset:6144
    v_mfma_f32_16x16x32_bf16 v[200:203], v[64:67], v[88:91], v[200:203]
    v_mfma_f32_16x16x32_bf16 v[204:207], v[64:67], v[92:95], v[204:207]
    s_waitcnt lgkmcnt(5)
    v_mfma_f32_16x16x32_bf16 v[220:223], v[68:71], v[92:95], v[220:223]
    ds_read_b128 v[64:67], v19 offset:0
    v_mfma_f32_16x16x32_bf16 v[216:219], v[68:71], v[88:91], v[216:219]
    v_mfma_f32_16x16x32_bf16 v[212:215], v[68:71], v[84:87], v[212:215]
    v_mfma_f32_16x16x32_bf16 v[208:211], v[68:71], v[80:83], v[208:211]
    s_waitcnt lgkmcnt(4)
    v_mfma_f32_16x16x32_bf16 v[224:227], v[72:75], v[80:83], v[224:227]
    ds_read_b128 v[68:71], v19 offset:2048
    v_mfma_f32_16x16x32_bf16 v[228:231], v[72:75], v[84:87], v[228:231]
    v_mfma_f32_16x16x32_bf16 v[232:235], v[72:75], v[88:91], v[232:235]
    v_mfma_f32_16x16x32_bf16 v[236:239], v[72:75], v[92:95], v[236:239]
    s_waitcnt lgkmcnt(3)
    v_mfma_f32_16x16x32_bf16 v[252:255], v[76:79], v[92:95], v[252:255]
    ds_read_b128 v[72:75], v19 offset:4096
    v_mfma_f32_16x16x32_bf16 v[248:251], v[76:79], v[88:91], v[248:251]
    v_mfma_f32_16x16x32_bf16 v[244:247], v[76:79], v[84:87], v[244:247]
    v_mfma_f32_16x16x32_bf16 v[240:243], v[76:79], v[80:83], v[240:243]
    s_waitcnt lgkmcnt(2)
    v_mfma_f32_16x16x32_bf16 v[128:131], v[64:67], v[96:99], v[128:131]
    ds_read_b128 v[76:79], v19 offset:6144
    v_mfma_f32_16x16x32_bf16 v[132:135], v[64:67], v[100:103], v[132:135]
    v_mfma_f32_16x16x32_bf16 v[136:139], v[64:67], v[104:107], v[136:139]
    v_mfma_f32_16x16x32_bf16 v[140:143], v[64:67], v[108:111], v[140:143]
    s_waitcnt lgkmcnt(2)
    v_mfma_f32_16x16x32_bf16 v[156:159], v[68:71], v[108:111], v[156:159]
    ds_read_b128 v[64:67], v19 offset:8192
    v_mfma_f32_16x16x32_bf16 v[152:155], v[68:71], v[104:107], v[152:155]
    v_mfma_f32_16x16x32_bf16 v[148:151], v[68:71], v[100:103], v[148:151]
    v_mfma_f32_16x16x32_bf16 v[144:147], v[68:71], v[96:99], v[144:147]
    s_waitcnt lgkmcnt(2)
    v_mfma_f32_16x16x32_bf16 v[160:163], v[72:75], v[96:99], v[160:163]
    ds_read_b128 v[68:71], v19 offset:10240
    v_mfma_f32_16x16x32_bf16 v[164:167], v[72:75], v[100:103], v[164:167]
    v_mfma_f32_16x16x32_bf16 v[168:171], v[72:75], v[104:107], v[168:171]
    v_mfma_f32_16x16x32_bf16 v[172:175], v[72:75], v[108:111], v[172:175]
    s_waitcnt lgkmcnt(2)
    v_mfma_f32_16x16x32_bf16 v[188:191], v[76:79], v[108:111], v[188:191]
    ds_read_b128 v[72:75], v19 offset:12288
    v_mfma_f32_16x16x32_bf16 v[184:187], v[76:79], v[104:107], v[184:187]
    v_mfma_f32_16x16x32_bf16 v[180:183], v[76:79], v[100:103], v[180:183]
    v_mfma_f32_16x16x32_bf16 v[176:179], v[76:79], v[96:99], v[176:179]
    s_waitcnt lgkmcnt(2)
    v_mfma_f32_16x16x32_bf16 v[192:195], v[64:67], v[96:99], v[192:195]
    ds_read_b128 v[76:79], v19 offset:14336
    v_mfma_f32_16x16x32_bf16 v[196:199], v[64:67], v[100:103], v[196:199]
    v_mfma_f32_16x16x32_bf16 v[200:203], v[64:67], v[104:107], v[200:203]
    v_mfma_f32_16x16x32_bf16 v[204:207], v[64:67], v[108:111], v[204:207]
    s_waitcnt lgkmcnt(0)
    s_barrier
    v_mfma_f32_16x16x32_bf16 v[220:223], v[68:71], v[108:111], v[220:223]
    ds_read_b128 v[64:67], v20 offset:0
    v_mfma_f32_16x16x32_bf16 v[216:219], v[68:71], v[104:107], v[216:219]
    ds_read_b128 v[80:83], v26 offset:0
    v_mfma_f32_16x16x32_bf16 v[212:215], v[68:71], v[100:103], v[212:215]
    ds_read_b128 v[84:87], v26 offset:2048
    v_mfma_f32_16x16x32_bf16 v[208:211], v[68:71], v[96:99], v[208:211]
    v_mfma_f32_16x16x32_bf16 v[224:227], v[72:75], v[96:99], v[224:227]
    ds_read_b128 v[68:71], v20 offset:2048
    v_mfma_f32_16x16x32_bf16 v[228:231], v[72:75], v[100:103], v[228:231]
    ds_read_b128 v[88:91], v26 offset:4096
    v_mfma_f32_16x16x32_bf16 v[232:235], v[72:75], v[104:107], v[232:235]
    v_mfma_f32_16x16x32_bf16 v[236:239], v[72:75], v[108:111], v[236:239]
    v_mfma_f32_16x16x32_bf16 v[252:255], v[76:79], v[108:111], v[252:255]
    ds_read_b128 v[72:75], v20 offset:4096
    v_mfma_f32_16x16x32_bf16 v[248:251], v[76:79], v[104:107], v[248:251]
    ds_read_b128 v[92:95], v26 offset:6144
    v_mfma_f32_16x16x32_bf16 v[244:247], v[76:79], v[100:103], v[244:247]
    v_mfma_f32_16x16x32_bf16 v[240:243], v[76:79], v[96:99], v[240:243]
    s_waitcnt lgkmcnt(5)
    v_mfma_f32_16x16x32_bf16 v[128:131], v[64:67], v[80:83], v[128:131]
    ds_read_b128 v[76:79], v20 offset:6144
    s_waitcnt lgkmcnt(5)
    v_mfma_f32_16x16x32_bf16 v[132:135], v[64:67], v[84:87], v[132:135]
    s_waitcnt lgkmcnt(3)
    v_mfma_f32_16x16x32_bf16 v[136:139], v[64:67], v[88:91], v[136:139]
    s_waitcnt lgkmcnt(1)
    v_mfma_f32_16x16x32_bf16 v[140:143], v[64:67], v[92:95], v[140:143]
    v_mfma_f32_16x16x32_bf16 v[156:159], v[68:71], v[92:95], v[156:159]
    ds_read_b128 v[64:67], v20 offset:8192
    v_mfma_f32_16x16x32_bf16 v[152:155], v[68:71], v[88:91], v[152:155]
    ds_read_b128 v[96:99], v27 offset:0
    v_mfma_f32_16x16x32_bf16 v[148:151], v[68:71], v[84:87], v[148:151]
    v_mfma_f32_16x16x32_bf16 v[144:147], v[68:71], v[80:83], v[144:147]
    v_mfma_f32_16x16x32_bf16 v[160:163], v[72:75], v[80:83], v[160:163]
    ds_read_b128 v[68:71], v20 offset:10240
    v_mfma_f32_16x16x32_bf16 v[164:167], v[72:75], v[84:87], v[164:167]
    ds_read_b128 v[100:103], v27 offset:2048
    v_mfma_f32_16x16x32_bf16 v[168:171], v[72:75], v[88:91], v[168:171]
    v_mfma_f32_16x16x32_bf16 v[172:175], v[72:75], v[92:95], v[172:175]
    s_waitcnt lgkmcnt(4)
    v_mfma_f32_16x16x32_bf16 v[188:191], v[76:79], v[92:95], v[188:191]
    ds_read_b128 v[72:75], v20 offset:12288
    v_mfma_f32_16x16x32_bf16 v[184:187], v[76:79], v[88:91], v[184:187]
    ds_read_b128 v[104:107], v27 offset:4096
    v_mfma_f32_16x16x32_bf16 v[180:183], v[76:79], v[84:87], v[180:183]
    v_mfma_f32_16x16x32_bf16 v[176:179], v[76:79], v[80:83], v[176:179]
    s_waitcnt lgkmcnt(5)
    v_mfma_f32_16x16x32_bf16 v[192:195], v[64:67], v[80:83], v[192:195]
    ds_read_b128 v[76:79], v20 offset:14336
    v_mfma_f32_16x16x32_bf16 v[196:199], v[64:67], v[84:87], v[196:199]
    ds_read_b128 v[108:111], v27 offset:6144
    v_mfma_f32_16x16x32_bf16 v[200:203], v[64:67], v[88:91], v[200:203]
    v_mfma_f32_16x16x32_bf16 v[204:207], v[64:67], v[92:95], v[204:207]
    s_waitcnt lgkmcnt(5)
    v_mfma_f32_16x16x32_bf16 v[220:223], v[68:71], v[92:95], v[220:223]
    ds_read_b128 v[64:67], v21 offset:0
    v_mfma_f32_16x16x32_bf16 v[216:219], v[68:71], v[88:91], v[216:219]
    v_mfma_f32_16x16x32_bf16 v[212:215], v[68:71], v[84:87], v[212:215]
    v_mfma_f32_16x16x32_bf16 v[208:211], v[68:71], v[80:83], v[208:211]
    s_waitcnt lgkmcnt(4)
    v_mfma_f32_16x16x32_bf16 v[224:227], v[72:75], v[80:83], v[224:227]
    ds_read_b128 v[68:71], v21 offset:2048
    v_mfma_f32_16x16x32_bf16 v[228:231], v[72:75], v[84:87], v[228:231]
    v_mfma_f32_16x16x32_bf16 v[232:235], v[72:75], v[88:91], v[232:235]
    v_mfma_f32_16x16x32_bf16 v[236:239], v[72:75], v[92:95], v[236:239]
    s_waitcnt lgkmcnt(3)
    v_mfma_f32_16x16x32_bf16 v[252:255], v[76:79], v[92:95], v[252:255]
    ds_read_b128 v[72:75], v21 offset:4096
    v_mfma_f32_16x16x32_bf16 v[248:251], v[76:79], v[88:91], v[248:251]
    v_mfma_f32_16x16x32_bf16 v[244:247], v[76:79], v[84:87], v[244:247]
    v_mfma_f32_16x16x32_bf16 v[240:243], v[76:79], v[80:83], v[240:243]
    s_waitcnt lgkmcnt(2)
    v_mfma_f32_16x16x32_bf16 v[128:131], v[64:67], v[96:99], v[128:131]
    ds_read_b128 v[76:79], v21 offset:6144
    v_mfma_f32_16x16x32_bf16 v[132:135], v[64:67], v[100:103], v[132:135]
    v_mfma_f32_16x16x32_bf16 v[136:139], v[64:67], v[104:107], v[136:139]
    v_mfma_f32_16x16x32_bf16 v[140:143], v[64:67], v[108:111], v[140:143]
    s_waitcnt lgkmcnt(2)
    v_mfma_f32_16x16x32_bf16 v[156:159], v[68:71], v[108:111], v[156:159]
    ds_read_b128 v[64:67], v21 offset:8192
    v_mfma_f32_16x16x32_bf16 v[152:155], v[68:71], v[104:107], v[152:155]
    v_mfma_f32_16x16x32_bf16 v[148:151], v[68:71], v[100:103], v[148:151]
    v_mfma_f32_16x16x32_bf16 v[144:147], v[68:71], v[96:99], v[144:147]
    s_waitcnt lgkmcnt(2)
    v_mfma_f32_16x16x32_bf16 v[160:163], v[72:75], v[96:99], v[160:163]
    ds_read_b128 v[68:71], v21 offset:10240
    v_mfma_f32_16x16x32_bf16 v[164:167], v[72:75], v[100:103], v[164:167]
    v_mfma_f32_16x16x32_bf16 v[168:171], v[72:75], v[104:107], v[168:171]
    v_mfma_f32_16x16x32_bf16 v[172:175], v[72:75], v[108:111], v[172:175]
    s_waitcnt lgkmcnt(2)
    v_mfma_f32_16x16x32_bf16 v[188:191], v[76:79], v[108:111], v[188:191]
    ds_read_b128 v[72:75], v21 offset:12288
    v_mfma_f32_16x16x32_bf16 v[184:187], v[76:79], v[104:107], v[184:187]
    v_mfma_f32_16x16x32_bf16 v[180:183], v[76:79], v[100:103], v[180:183]
    v_mfma_f32_16x16x32_bf16 v[176:179], v[76:79], v[96:99], v[176:179]
    s_waitcnt lgkmcnt(2)
    v_mfma_f32_16x16x32_bf16 v[192:195], v[64:67], v[96:99], v[192:195]
    ds_read_b128 v[76:79], v21 offset:14336
    v_mfma_f32_16x16x32_bf16 v[196:199], v[64:67], v[100:103], v[196:199]
    v_mfma_f32_16x16x32_bf16 v[200:203], v[64:67], v[104:107], v[200:203]
    v_mfma_f32_16x16x32_bf16 v[204:207], v[64:67], v[108:111], v[204:207]
    s_waitcnt lgkmcnt(0)
    s_barrier
    v_mfma_f32_16x16x32_bf16 v[220:223], v[68:71], v[108:111], v[220:223]
    ds_read_b128 v[64:67], v16 offset:0
    v_mfma_f32_16x16x32_bf16 v[216:219], v[68:71], v[104:107], v[216:219]
    ds_read_b128 v[80:83], v22 offset:0
    v_mfma_f32_16x16x32_bf16 v[212:215], v[68:71], v[100:103], v[212:215]
    ds_read_b128 v[84:87], v22 offset:2048
    v_mfma_f32_16x16x32_bf16 v[208:211], v[68:71], v[96:99], v[208:211]
    v_mfma_f32_16x16x32_bf16 v[224:227], v[72:75], v[96:99], v[224:227]
    ds_read_b128 v[68:71], v16 offset:2048
    v_mfma_f32_16x16x32_bf16 v[228:231], v[72:75], v[100:103], v[228:231]
    ds_read_b128 v[88:91], v22 offset:4096
    v_mfma_f32_16x16x32_bf16 v[232:235], v[72:75], v[104:107], v[232:235]
    v_mfma_f32_16x16x32_bf16 v[236:239], v[72:75], v[108:111], v[236:239]
    v_mfma_f32_16x16x32_bf16 v[252:255], v[76:79], v[108:111], v[252:255]
    ds_read_b128 v[72:75], v16 offset:4096
    v_mfma_f32_16x16x32_bf16 v[248:251], v[76:79], v[104:107], v[248:251]
    ds_read_b128 v[92:95], v22 offset:6144
    v_mfma_f32_16x16x32_bf16 v[244:247], v[76:79], v[100:103], v[244:247]
    v_mfma_f32_16x16x32_bf16 v[240:243], v[76:79], v[96:99], v[240:243]
    s_waitcnt lgkmcnt(5)
    v_mfma_f32_16x16x32_bf16 v[128:131], v[64:67], v[80:83], v[128:131]
    ds_read_b128 v[76:79], v16 offset:6144
    s_waitcnt lgkmcnt(5)
    v_mfma_f32_16x16x32_bf16 v[132:135], v[64:67], v[84:87], v[132:135]
    s_waitcnt lgkmcnt(3)
    v_mfma_f32_16x16x32_bf16 v[136:139], v[64:67], v[88:91], v[136:139]
    s_waitcnt lgkmcnt(1)
    v_mfma_f32_16x16x32_bf16 v[140:143], v[64:67], v[92:95], v[140:143]
    v_mfma_f32_16x16x32_bf16 v[156:159], v[68:71], v[92:95], v[156:159]
    ds_read_b128 v[64:67], v16 offset:8192
    v_mfma_f32_16x16x32_bf16 v[152:155], v[68:71], v[88:91], v[152:155]
    ds_read_b128 v[96:99], v23 offset:0
    v_mfma_f32_16x16x32_bf16 v[148:151], v[68:71], v[84:87], v[148:151]
    v_mfma_f32_16x16x32_bf16 v[144:147], v[68:71], v[80:83], v[144:147]
    v_mfma_f32_16x16x32_bf16 v[160:163], v[72:75], v[80:83], v[160:163]
    ds_read_b128 v[68:71], v16 offset:10240
    v_mfma_f32_16x16x32_bf16 v[164:167], v[72:75], v[84:87], v[164:167]
    ds_read_b128 v[100:103], v23 offset:2048
    v_mfma_f32_16x16x32_bf16 v[168:171], v[72:75], v[88:91], v[168:171]
    v_mfma_f32_16x16x32_bf16 v[172:175], v[72:75], v[92:95], v[172:175]
    s_waitcnt lgkmcnt(4)
    v_mfma_f32_16x16x32_bf16 v[188:191], v[76:79], v[92:95], v[188:191]
    ds_read_b128 v[72:75], v16 offset:12288
    v_mfma_f32_16x16x32_bf16 v[184:187], v[76:79], v[88:91], v[184:187]
    ds_read_b128 v[104:107], v23 offset:4096
    v_mfma_f32_16x16x32_bf16 v[180:183], v[76:79], v[84:87], v[180:183]
    v_mfma_f32_16x16x32_bf16 v[176:179], v[76:79], v[80:83], v[176:179]
    s_waitcnt lgkmcnt(5)
    v_mfma_f32_16x16x32_bf16 v[192:195], v[64:67], v[80:83], v[192:195]
    ds_read_b128 v[76:79], v16 offset:14336
    v_mfma_f32_16x16x32_bf16 v[196:199], v[64:67], v[84:87], v[196:199]
    ds_read_b128 v[108:111], v23 offset:6144
    v_mfma_f32_16x16x32_bf16 v[200:203], v[64:67], v[88:91], v[200:203]
    v_mfma_f32_16x16x32_bf16 v[204:207], v[64:67], v[92:95], v[204:207]
    s_waitcnt lgkmcnt(5)
    v_mfma_f32_16x16x32_bf16 v[220:223], v[68:71], v[92:95], v[220:223]
    ds_read_b128 v[64:67], v17 offset:0
    v_mfma_f32_16x16x32_bf16 v[216:219], v[68:71], v[88:91], v[216:219]
    v_mfma_f32_16x16x32_bf16 v[212:215], v[68:71], v[84:87], v[212:215]
    v_mfma_f32_16x16x32_bf16 v[208:211], v[68:71], v[80:83], v[208:211]
    s_waitcnt lgkmcnt(4)
    v_mfma_f32_16x16x32_bf16 v[224:227], v[72:75], v[80:83], v[224:227]
    ds_read_b128 v[68:71], v17 offset:2048
    v_mfma_f32_16x16x32_bf16 v[228:231], v[72:75], v[84:87], v[228:231]
    v_mfma_f32_16x16x32_bf16 v[232:235], v[72:75], v[88:91], v[232:235]
    v_mfma_f32_16x16x32_bf16 v[236:239], v[72:75], v[92:95], v[236:239]
    s_waitcnt lgkmcnt(3)
    v_mfma_f32_16x16x32_bf16 v[252:255], v[76:79], v[92:95], v[252:255]
    ds_read_b128 v[72:75], v17 offset:4096
    v_mfma_f32_16x16x32_bf16 v[248:251], v[76:79], v[88:91], v[248:251]
    v_mfma_f32_16x16x32_bf16 v[244:247], v[76:79], v[84:87], v[244:247]
    v_mfma_f32_16x16x32_bf16 v[240:243], v[76:79], v[80:83], v[240:243]
    s_waitcnt lgkmcnt(2)
    v_mfma_f32_16x16x32_bf16 v[128:131], v[64:67], v[96:99], v[128:131]
    ds_read_b128 v[76:79], v17 offset:6144
    v_mfma_f32_16x16x32_bf16 v[132:135], v[64:67], v[100:103], v[132:135]
    v_mfma_f32_16x16x32_bf16 v[136:139], v[64:67], v[104:107], v[136:139]
    v_mfma_f32_16x16x32_bf16 v[140:143], v[64:67], v[108:111], v[140:143]
    s_waitcnt lgkmcnt(2)
    v_mfma_f32_16x16x32_bf16 v[156:159], v[68:71], v[108:111], v[156:159]
    ds_read_b128 v[64:67], v17 offset:8192
    v_mfma_f32_16x16x32_bf16 v[152:155], v[68:71], v[104:107], v[152:155]
    v_mfma_f32_16x16x32_bf16 v[148:151], v[68:71], v[100:103], v[148:151]
    v_mfma_f32_16x16x32_bf16 v[144:147], v[68:71], v[96:99], v[144:147]
    s_waitcnt lgkmcnt(2)
    v_mfma_f32_16x16x32_bf16 v[160:163], v[72:75], v[96:99], v[160:163]
    ds_read_b128 v[68:71], v17 offset:10240
    v_mfma_f32_16x16x32_bf16 v[164:167], v[72:75], v[100:103], v[164:167]
    v_mfma_f32_16x16x32_bf16 v[168:171], v[72:75], v[104:107], v[168:171]
    v_mfma_f32_16x16x32_bf16 v[172:175], v[72:75], v[108:111], v[172:175]
    s_waitcnt lgkmcnt(2)
    v_mfma_f32_16x16x32_bf16 v[188:191], v[76:79], v[108:111], v[188:191]
    ds_read_b128 v[72:75], v17 offset:12288
    v_mfma_f32_16x16x32_bf16 v[184:187], v[76:79], v[104:107], v[184:187]
    v_mfma_f32_16x16x32_bf16 v[180:183], v[76:79], v[100:103], v[180:183]
    v_mfma_f32_16x16x32_bf16 v[176:179], v[76:79], v[96:99], v[176:179]
    s_waitcnt lgkmcnt(2)
    v_mfma_f32_16x16x32_bf16 v[192:195], v[64:67], v[96:99], v[192:195]
    ds_read_b128 v[76:79], v17 offset:14336
    v_mfma_f32_16x16x32_bf16 v[196:199], v[64:67], v[100:103], v[196:199]
    v_mfma_f32_16x16x32_bf16 v[200:203], v[64:67], v[104:107], v[200:203]
    v_mfma_f32_16x16x32_bf16 v[204:207], v[64:67], v[108:111], v[204:207]
    s_waitcnt lgkmcnt(0)
    s_barrier
    v_mfma_f32_16x16x32_bf16 v[220:223], v[68:71], v[108:111], v[220:223]
    ds_read_b128 v[64:67], v18 offset:0
    v_mfma_f32_16x16x32_bf16 v[216:219], v[68:71], v[104:107], v[216:219]
    ds_read_b128 v[80:83], v24 offset:0
    v_mfma_f32_16x16x32_bf16 v[212:215], v[68:71], v[100:103], v[212:215]
    ds_read_b128 v[84:87], v24 offset:2048
    v_mfma_f32_16x16x32_bf16 v[208:211], v[68:71], v[96:99], v[208:211]
    v_mfma_f32_16x16x32_bf16 v[224:227], v[72:75], v[96:99], v[224:227]
    ds_read_b128 v[68:71], v18 offset:2048
    v_mfma_f32_16x16x32_bf16 v[228:231], v[72:75], v[100:103], v[228:231]
    ds_read_b128 v[88:91], v24 offset:4096
    v_mfma_f32_16x16x32_bf16 v[232:235], v[72:75], v[104:107], v[232:235]
    v_mfma_f32_16x16x32_bf16 v[236:239], v[72:75], v[108:111], v[236:239]
    v_mfma_f32_16x16x32_bf16 v[252:255], v[76:79], v[108:111], v[252:255]
    ds_read_b128 v[72:75], v18 offset:4096
    v_mfma_f32_16x16x32_bf16 v[248:251], v[76:79], v[104:107], v[248:251]
    ds_read_b128 v[92:95], v24 offset:6144
    v_mfma_f32_16x16x32_bf16 v[244:247], v[76:79], v[100:103], v[244:247]
    v_mfma_f32_16x16x32_bf16 v[240:243], v[76:79], v[96:99], v[240:243]
    s_waitcnt lgkmcnt(5)
    v_mfma_f32_16x16x32_bf16 v[128:131], v[64:67], v[80:83], v[128:131]
    ds_read_b128 v[76:79], v18 offset:6144
    s_waitcnt lgkmcnt(5)
    v_mfma_f32_16x16x32_bf16 v[132:135], v[64:67], v[84:87], v[132:135]
    s_waitcnt lgkmcnt(3)
    v_mfma_f32_16x16x32_bf16 v[136:139], v[64:67], v[88:91], v[136:139]
    s_waitcnt lgkmcnt(1)
    v_mfma_f32_16x16x32_bf16 v[140:143], v[64:67], v[92:95], v[140:143]
    v_mfma_f32_16x16x32_bf16 v[156:159], v[68:71], v[92:95], v[156:159]
    ds_read_b128 v[64:67], v18 offset:8192
    v_mfma_f32_16x16x32_bf16 v[152:155], v[68:71], v[88:91], v[152:155]
    ds_read_b128 v[96:99], v25 offset:0
    v_mfma_f32_16x16x32_bf16 v[148:151], v[68:71], v[84:87], v[148:151]
    v_mfma_f32_16x16x32_bf16 v[144:147], v[68:71], v[80:83], v[144:147]
    v_mfma_f32_16x16x32_bf16 v[160:163], v[72:75], v[80:83], v[160:163]
    ds_read_b128 v[68:71], v18 offset:10240
    v_mfma_f32_16x16x32_bf16 v[164:167], v[72:75], v[84:87], v[164:167]
    ds_read_b128 v[100:103], v25 offset:2048
    v_mfma_f32_16x16x32_bf16 v[168:171], v[72:75], v[88:91], v[168:171]
    v_mfma_f32_16x16x32_bf16 v[172:175], v[72:75], v[92:95], v[172:175]
    s_waitcnt lgkmcnt(4)
    v_mfma_f32_16x16x32_bf16 v[188:191], v[76:79], v[92:95], v[188:191]
    ds_read_b128 v[72:75], v18 offset:12288
    v_mfma_f32_16x16x32_bf16 v[184:187], v[76:79], v[88:91], v[184:187]
    ds_read_b128 v[104:107], v25 offset:4096
    v_mfma_f32_16x16x32_bf16 v[180:183], v[76:79], v[84:87], v[180:183]
    v_mfma_f32_16x16x32_bf16 v[176:179], v[76:79], v[80:83], v[176:179]
    s_waitcnt lgkmcnt(5)
    v_mfma_f32_16x16x32_bf16 v[192:195], v[64:67], v[80:83], v[192:195]
    ds_read_b128 v[76:79], v18 offset:14336
    v_mfma_f32_16x16x32_bf16 v[196:199], v[64:67], v[84:87], v[196:199]
    ds_read_b128 v[108:111], v25 offset:6144
    v_mfma_f32_16x16x32_bf16 v[200:203], v[64:67], v[88:91], v[200:203]
    v_mfma_f32_16x16x32_bf16 v[204:207], v[64:67], v[92:95], v[204:207]
    s_waitcnt lgkmcnt(5)
    v_mfma_f32_16x16x32_bf16 v[220:223], v[68:71], v[92:95], v[220:223]
    ds_read_b128 v[64:67], v19 offset:0
    v_mfma_f32_16x16x32_bf16 v[216:219], v[68:71], v[88:91], v[216:219]
    v_mfma_f32_16x16x32_bf16 v[212:215], v[68:71], v[84:87], v[212:215]
    v_mfma_f32_16x16x32_bf16 v[208:211], v[68:71], v[80:83], v[208:211]
    s_waitcnt lgkmcnt(4)
    v_mfma_f32_16x16x32_bf16 v[224:227], v[72:75], v[80:83], v[224:227]
    ds_read_b128 v[68:71], v19 offset:2048
    v_mfma_f32_16x16x32_bf16 v[228:231], v[72:75], v[84:87], v[228:231]
    v_mfma_f32_16x16x32_bf16 v[232:235], v[72:75], v[88:91], v[232:235]
    v_mfma_f32_16x16x32_bf16 v[236:239], v[72:75], v[92:95], v[236:239]
    s_waitcnt lgkmcnt(3)
    v_mfma_f32_16x16x32_bf16 v[252:255], v[76:79], v[92:95], v[252:255]
    ds_read_b128 v[72:75], v19 offset:4096
    v_mfma_f32_16x16x32_bf16 v[248:251], v[76:79], v[88:91], v[248:251]
    v_mfma_f32_16x16x32_bf16 v[244:247], v[76:79], v[84:87], v[244:247]
    v_mfma_f32_16x16x32_bf16 v[240:243], v[76:79], v[80:83], v[240:243]
    s_waitcnt lgkmcnt(2)
    v_mfma_f32_16x16x32_bf16 v[128:131], v[64:67], v[96:99], v[128:131]
    ds_read_b128 v[76:79], v19 offset:6144
    v_mfma_f32_16x16x32_bf16 v[132:135], v[64:67], v[100:103], v[132:135]
    v_mfma_f32_16x16x32_bf16 v[136:139], v[64:67], v[104:107], v[136:139]
    v_mfma_f32_16x16x32_bf16 v[140:143], v[64:67], v[108:111], v[140:143]
    s_waitcnt lgkmcnt(2)
    v_mfma_f32_16x16x32_bf16 v[156:159], v[68:71], v[108:111], v[156:159]
    ds_read_b128 v[64:67], v19 offset:8192
    v_mfma_f32_16x16x32_bf16 v[152:155], v[68:71], v[104:107], v[152:155]
    v_mfma_f32_16x16x32_bf16 v[148:151], v[68:71], v[100:103], v[148:151]
    v_mfma_f32_16x16x32_bf16 v[144:147], v[68:71], v[96:99], v[144:147]
    s_waitcnt lgkmcnt(2)
    v_mfma_f32_16x16x32_bf16 v[160:163], v[72:75], v[96:99], v[160:163]
    ds_read_b128 v[68:71], v19 offset:10240
    v_mfma_f32_16x16x32_bf16 v[164:167], v[72:75], v[100:103], v[164:167]
    v_mfma_f32_16x16x32_bf16 v[168:171], v[72:75], v[104:107], v[168:171]
    v_mfma_f32_16x16x32_bf16 v[172:175], v[72:75], v[108:111], v[172:175]
    s_waitcnt lgkmcnt(2)
    v_mfma_f32_16x16x32_bf16 v[188:191], v[76:79], v[108:111], v[188:191]
    ds_read_b128 v[72:75], v19 offset:12288
    v_mfma_f32_16x16x32_bf16 v[184:187], v[76:79], v[104:107], v[184:187]
    v_mfma_f32_16x16x32_bf16 v[180:183], v[76:79], v[100:103], v[180:183]
    v_mfma_f32_16x16x32_bf16 v[176:179], v[76:79], v[96:99], v[176:179]
    s_waitcnt lgkmcnt(2)
    v_mfma_f32_16x16x32_bf16 v[192:195], v[64:67], v[96:99], v[192:195]
    ds_read_b128 v[76:79], v19 offset:14336
    v_mfma_f32_16x16x32_bf16 v[196:199], v[64:67], v[100:103], v[196:199]
    v_mfma_f32_16x16x32_bf16 v[200:203], v[64:67], v[104:107], v[200:203]
    v_mfma_f32_16x16x32_bf16 v[204:207], v[64:67], v[108:111], v[204:207]
    s_waitcnt lgkmcnt(0)
    s_barrier
    v_mfma_f32_16x16x32_bf16 v[220:223], v[68:71], v[108:111], v[220:223]
    ds_read_b128 v[64:67], v20 offset:0
    v_mfma_f32_16x16x32_bf16 v[216:219], v[68:71], v[104:107], v[216:219]
    ds_read_b128 v[80:83], v26 offset:0
    v_mfma_f32_16x16x32_bf16 v[212:215], v[68:71], v[100:103], v[212:215]
    ds_read_b128 v[84:87], v26 offset:2048
    v_mfma_f32_16x16x32_bf16 v[208:211], v[68:71], v[96:99], v[208:211]
    v_mfma_f32_16x16x32_bf16 v[224:227], v[72:75], v[96:99], v[224:227]
    ds_read_b128 v[68:71], v20 offset:2048
    v_mfma_f32_16x16x32_bf16 v[228:231], v[72:75], v[100:103], v[228:231]
    ds_read_b128 v[88:91], v26 offset:4096
    v_mfma_f32_16x16x32_bf16 v[232:235], v[72:75], v[104:107], v[232:235]
    v_mfma_f32_16x16x32_bf16 v[236:239], v[72:75], v[108:111], v[236:239]
    v_mfma_f32_16x16x32_bf16 v[252:255], v[76:79], v[108:111], v[252:255]
    ds_read_b128 v[72:75], v20 offset:4096
    v_mfma_f32_16x16x32_bf16 v[248:251], v[76:79], v[104:107], v[248:251]
    ds_read_b128 v[92:95], v26 offset:6144
    v_mfma_f32_16x16x32_bf16 v[244:247], v[76:79], v[100:103], v[244:247]
    v_mfma_f32_16x16x32_bf16 v[240:243], v[76:79], v[96:99], v[240:243]
    s_waitcnt lgkmcnt(5)
    v_mfma_f32_16x16x32_bf16 v[128:131], v[64:67], v[80:83], v[128:131]
    ds_read_b128 v[76:79], v20 offset:6144
    s_waitcnt lgkmcnt(5)
    v_mfma_f32_16x16x32_bf16 v[132:135], v[64:67], v[84:87], v[132:135]
    s_waitcnt lgkmcnt(3)
    v_mfma_f32_16x16x32_bf16 v[136:139], v[64:67], v[88:91], v[136:139]
    s_waitcnt lgkmcnt(1)
    v_mfma_f32_16x16x32_bf16 v[140:143], v[64:67], v[92:95], v[140:143]
    v_mfma_f32_16x16x32_bf16 v[156:159], v[68:71], v[92:95], v[156:159]
    ds_read_b128 v[64:67], v20 offset:8192
    v_mfma_f32_16x16x32_bf16 v[152:155], v[68:71], v[88:91], v[152:155]
    ds_read_b128 v[96:99], v27 offset:0
    v_mfma_f32_16x16x32_bf16 v[148:151], v[68:71], v[84:87], v[148:151]
    v_mfma_f32_16x16x32_bf16 v[144:147], v[68:71], v[80:83], v[144:147]
    v_mfma_f32_16x16x32_bf16 v[160:163], v[72:75], v[80:83], v[160:163]
    ds_read_b128 v[68:71], v20 offset:10240
    v_mfma_f32_16x16x32_bf16 v[164:167], v[72:75], v[84:87], v[164:167]
    ds_read_b128 v[100:103], v27 offset:2048
    v_mfma_f32_16x16x32_bf16 v[168:171], v[72:75], v[88:91], v[168:171]
    v_mfma_f32_16x16x32_bf16 v[172:175], v[72:75], v[92:95], v[172:175]
    s_waitcnt lgkmcnt(4)
    v_mfma_f32_16x16x32_bf16 v[188:191], v[76:79], v[92:95], v[188:191]
    ds_read_b128 v[72:75], v20 offset:12288
    v_mfma_f32_16x16x32_bf16 v[184:187], v[76:79], v[88:91], v[184:187]
    ds_read_b128 v[104:107], v27 offset:4096
    v_mfma_f32_16x16x32_bf16 v[180:183], v[76:79], v[84:87], v[180:183]
    v_mfma_f32_16x16x32_bf16 v[176:179], v[76:79], v[80:83], v[176:179]
    s_waitcnt lgkmcnt(5)
    v_mfma_f32_16x16x32_bf16 v[192:195], v[64:67], v[80:83], v[192:195]
    ds_read_b128 v[76:79], v20 offset:14336
    v_mfma_f32_16x16x32_bf16 v[196:199], v[64:67], v[84:87], v[196:199]
    ds_read_b128 v[108:111], v27 offset:6144
    v_mfma_f32_16x16x32_bf16 v[200:203], v[64:67], v[88:91], v[200:203]
    v_mfma_f32_16x16x32_bf16 v[204:207], v[64:67], v[92:95], v[204:207]
    s_waitcnt lgkmcnt(5)
    v_mfma_f32_16x16x32_bf16 v[220:223], v[68:71], v[92:95], v[220:223]
    ds_read_b128 v[64:67], v21 offset:0
    v_mfma_f32_16x16x32_bf16 v[216:219], v[68:71], v[88:91], v[216:219]
    v_mfma_f32_16x16x32_bf16 v[212:215], v[68:71], v[84:87], v[212:215]
    v_mfma_f32_16x16x32_bf16 v[208:211], v[68:71], v[80:83], v[208:211]
    s_waitcnt lgkmcnt(4)
    v_mfma_f32_16x16x32_bf16 v[224:227], v[72:75], v[80:83], v[224:227]
    ds_read_b128 v[68:71], v21 offset:2048
    v_mfma_f32_16x16x32_bf16 v[228:231], v[72:75], v[84:87], v[228:231]
    v_mfma_f32_16x16x32_bf16 v[232:235], v[72:75], v[88:91], v[232:235]
    v_mfma_f32_16x16x32_bf16 v[236:239], v[72:75], v[92:95], v[236:239]
    s_waitcnt lgkmcnt(3)
    v_mfma_f32_16x16x32_bf16 v[252:255], v[76:79], v[92:95], v[252:255]
    ds_read_b128 v[72:75], v21 offset:4096
    v_mfma_f32_16x16x32_bf16 v[248:251], v[76:79], v[88:91], v[248:251]
    v_mfma_f32_16x16x32_bf16 v[244:247], v[76:79], v[84:87], v[244:247]
    v_mfma_f32_16x16x32_bf16 v[240:243], v[76:79], v[80:83], v[240:243]
    s_waitcnt lgkmcnt(2)
    v_mfma_f32_16x16x32_bf16 v[128:131], v[64:67], v[96:99], v[128:131]
    ds_read_b128 v[76:79], v21 offset:6144
    v_mfma_f32_16x16x32_bf16 v[132:135], v[64:67], v[100:103], v[132:135]
    v_mfma_f32_16x16x32_bf16 v[136:139], v[64:67], v[104:107], v[136:139]
    v_mfma_f32_16x16x32_bf16 v[140:143], v[64:67], v[108:111], v[140:143]
    s_waitcnt lgkmcnt(2)
    v_mfma_f32_16x16x32_bf16 v[156:159], v[68:71], v[108:111], v[156:159]
    ds_read_b128 v[64:67], v21 offset:8192
    v_mfma_f32_16x16x32_bf16 v[152:155], v[68:71], v[104:107], v[152:155]
    v_mfma_f32_16x16x32_bf16 v[148:151], v[68:71], v[100:103], v[148:151]
    v_mfma_f32_16x16x32_bf16 v[144:147], v[68:71], v[96:99], v[144:147]
    s_waitcnt lgkmcnt(2)
    v_mfma_f32_16x16x32_bf16 v[160:163], v[72:75], v[96:99], v[160:163]
    ds_read_b128 v[68:71], v21 offset:10240
    v_mfma_f32_16x16x32_bf16 v[164:167], v[72:75], v[100:103], v[164:167]
    v_mfma_f32_16x16x32_bf16 v[168:171], v[72:75], v[104:107], v[168:171]
    v_mfma_f32_16x16x32_bf16 v[172:175], v[72:75], v[108:111], v[172:175]
    s_waitcnt lgkmcnt(2)
    v_mfma_f32_16x16x32_bf16 v[188:191], v[76:79], v[108:111], v[188:191]
    ds_read_b128 v[72:75], v21 offset:12288
    v_mfma_f32_16x16x32_bf16 v[184:187], v[76:79], v[104:107], v[184:187]
    v_mfma_f32_16x16x32_bf16 v[180:183], v[76:79], v[100:103], v[180:183]
    v_mfma_f32_16x16x32_bf16 v[176:179], v[76:79], v[96:99], v[176:179]
    s_waitcnt lgkmcnt(2)
    v_mfma_f32_16x16x32_bf16 v[192:195], v[64:67], v[96:99], v[192:195]
    ds_read_b128 v[76:79], v21 offset:14336
    v_mfma_f32_16x16x32_bf16 v[196:199], v[64:67], v[100:103], v[196:199]
    v_mfma_f32_16x16x32_bf16 v[200:203], v[64:67], v[104:107], v[200:203]
    v_mfma_f32_16x16x32_bf16 v[204:207], v[64:67], v[108:111], v[204:207]
    s_waitcnt lgkmcnt(0)
    s_barrier
    v_mfma_f32_16x16x32_bf16 v[220:223], v[68:71], v[108:111], v[220:223]
    ds_read_b128 v[64:67], v16 offset:0
    v_mfma_f32_16x16x32_bf16 v[216:219], v[68:71], v[104:107], v[216:219]
    ds_read_b128 v[80:83], v22 offset:0
    v_mfma_f32_16x16x32_bf16 v[212:215], v[68:71], v[100:103], v[212:215]
    ds_read_b128 v[84:87], v22 offset:2048
    v_mfma_f32_16x16x32_bf16 v[208:211], v[68:71], v[96:99], v[208:211]
    v_mfma_f32_16x16x32_bf16 v[224:227], v[72:75], v[96:99], v[224:227]
    ds_read_b128 v[68:71], v16 offset:2048
    v_mfma_f32_16x16x32_bf16 v[228:231], v[72:75], v[100:103], v[228:231]
    ds_read_b128 v[88:91], v22 offset:4096
    v_mfma_f32_16x16x32_bf16 v[232:235], v[72:75], v[104:107], v[232:235]
    v_mfma_f32_16x16x32_bf16 v[236:239], v[72:75], v[108:111], v[236:239]
    v_mfma_f32_16x16x32_bf16 v[252:255], v[76:79], v[108:111], v[252:255]
    ds_read_b128 v[72:75], v16 offset:4096
    v_mfma_f32_16x16x32_bf16 v[248:251], v[76:79], v[104:107], v[248:251]
    ds_read_b128 v[92:95], v22 offset:6144
    v_mfma_f32_16x16x32_bf16 v[244:247], v[76:79], v[100:103], v[244:247]
    v_mfma_f32_16x16x32_bf16 v[240:243], v[76:79], v[96:99], v[240:243]
    s_waitcnt lgkmcnt(5)
    v_mfma_f32_16x16x32_bf16 v[128:131], v[64:67], v[80:83], v[128:131]
    ds_read_b128 v[76:79], v16 offset:6144
    s_waitcnt lgkmcnt(5)
    v_mfma_f32_16x16x32_bf16 v[132:135], v[64:67], v[84:87], v[132:135]
    s_waitcnt lgkmcnt(3)
    v_mfma_f32_16x16x32_bf16 v[136:139], v[64:67], v[88:91], v[136:139]
    s_waitcnt lgkmcnt(1)
    v_mfma_f32_16x16x32_bf16 v[140:143], v[64:67], v[92:95], v[140:143]
    v_mfma_f32_16x16x32_bf16 v[156:159], v[68:71], v[92:95], v[156:159]
    ds_read_b128 v[64:67], v16 offset:8192
    v_mfma_f32_16x16x32_bf16 v[152:155], v[68:71], v[88:91], v[152:155]
    ds_read_b128 v[96:99], v23 offset:0
    v_mfma_f32_16x16x32_bf16 v[148:151], v[68:71], v[84:87], v[148:151]
    v_mfma_f32_16x16x32_bf16 v[144:147], v[68:71], v[80:83], v[144:147]
    v_mfma_f32_16x16x32_bf16 v[160:163], v[72:75], v[80:83], v[160:163]
    ds_read_b128 v[68:71], v16 offset:10240
    v_mfma_f32_16x16x32_bf16 v[164:167], v[72:75], v[84:87], v[164:167]
    ds_read_b128 v[100:103], v23 offset:2048
    v_mfma_f32_16x16x32_bf16 v[168:171], v[72:75], v[88:91], v[168:171]
    v_mfma_f32_16x16x32_bf16 v[172:175], v[72:75], v[92:95], v[172:175]
    s_waitcnt lgkmcnt(4)
    v_mfma_f32_16x16x32_bf16 v[188:191], v[76:79], v[92:95], v[188:191]
    ds_read_b128 v[72:75], v16 offset:12288
    v_mfma_f32_16x16x32_bf16 v[184:187], v[76:79], v[88:91], v[184:187]
    ds_read_b128 v[104:107], v23 offset:4096
    v_mfma_f32_16x16x32_bf16 v[180:183], v[76:79], v[84:87], v[180:183]
    v_mfma_f32_16x16x32_bf16 v[176:179], v[76:79], v[80:83], v[176:179]
    s_waitcnt lgkmcnt(5)
    v_mfma_f32_16x16x32_bf16 v[192:195], v[64:67], v[80:83], v[192:195]
    ds_read_b128 v[76:79], v16 offset:14336
    v_mfma_f32_16x16x32_bf16 v[196:199], v[64:67], v[84:87], v[196:199]
    ds_read_b128 v[108:111], v23 offset:6144
    v_mfma_f32_16x16x32_bf16 v[200:203], v[64:67], v[88:91], v[200:203]
    v_mfma_f32_16x16x32_bf16 v[204:207], v[64:67], v[92:95], v[204:207]
    s_waitcnt lgkmcnt(5)
    v_mfma_f32_16x16x32_bf16 v[220:223], v[68:71], v[92:95], v[220:223]
    ds_read_b128 v[64:67], v17 offset:0
    v_mfma_f32_16x16x32_bf16 v[216:219], v[68:71], v[88:91], v[216:219]
    v_mfma_f32_16x16x32_bf16 v[212:215], v[68:71], v[84:87], v[212:215]
    v_mfma_f32_16x16x32_bf16 v[208:211], v[68:71], v[80:83], v[208:211]
    s_waitcnt lgkmcnt(4)
    v_mfma_f32_16x16x32_bf16 v[224:227], v[72:75], v[80:83], v[224:227]
    ds_read_b128 v[68:71], v17 offset:2048
    v_mfma_f32_16x16x32_bf16 v[228:231], v[72:75], v[84:87], v[228:231]
    v_mfma_f32_16x16x32_bf16 v[232:235], v[72:75], v[88:91], v[232:235]
    v_mfma_f32_16x16x32_bf16 v[236:239], v[72:75], v[92:95], v[236:239]
    s_waitcnt lgkmcnt(3)
    v_mfma_f32_16x16x32_bf16 v[252:255], v[76:79], v[92:95], v[252:255]
    ds_read_b128 v[72:75], v17 offset:4096
    v_mfma_f32_16x16x32_bf16 v[248:251], v[76:79], v[88:91], v[248:251]
    v_mfma_f32_16x16x32_bf16 v[244:247], v[76:79], v[84:87], v[244:247]
    v_mfma_f32_16x16x32_bf16 v[240:243], v[76:79], v[80:83], v[240:243]
    s_waitcnt lgkmcnt(2)
    v_mfma_f32_16x16x32_bf16 v[128:131], v[64:67], v[96:99], v[128:131]
    ds_read_b128 v[76:79], v17 offset:6144
    v_mfma_f32_16x16x32_bf16 v[132:135], v[64:67], v[100:103], v[132:135]
    v_mfma_f32_16x16x32_bf16 v[136:139], v[64:67], v[104:107], v[136:139]
    v_mfma_f32_16x16x32_bf16 v[140:143], v[64:67], v[108:111], v[140:143]
    s_waitcnt lgkmcnt(2)
    v_mfma_f32_16x16x32_bf16 v[156:159], v[68:71], v[108:111], v[156:159]
    ds_read_b128 v[64:67], v17 offset:8192
    v_mfma_f32_16x16x32_bf16 v[152:155], v[68:71], v[104:107], v[152:155]
    v_mfma_f32_16x16x32_bf16 v[148:151], v[68:71], v[100:103], v[148:151]
    v_mfma_f32_16x16x32_bf16 v[144:147], v[68:71], v[96:99], v[144:147]
    s_waitcnt lgkmcnt(2)
    v_mfma_f32_16x16x32_bf16 v[160:163], v[72:75], v[96:99], v[160:163]
    ds_read_b128 v[68:71], v17 offset:10240
    v_mfma_f32_16x16x32_bf16 v[164:167], v[72:75], v[100:103], v[164:167]
    v_mfma_f32_16x16x32_bf16 v[168:171], v[72:75], v[104:107], v[168:171]
    v_mfma_f32_16x16x32_bf16 v[172:175], v[72:75], v[108:111], v[172:175]
    s_waitcnt lgkmcnt(2)
    v_mfma_f32_16x16x32_bf16 v[188:191], v[76:79], v[108:111], v[188:191]
    ds_read_b128 v[72:75], v17 offset:12288
    v_mfma_f32_16x16x32_bf16 v[184:187], v[76:79], v[104:107], v[184:187]
    v_mfma_f32_16x16x32_bf16 v[180:183], v[76:79], v[100:103], v[180:183]
    v_mfma_f32_16x16x32_bf16 v[176:179], v[76:79], v[96:99], v[176:179]
    s_waitcnt lgkmcnt(2)
    v_mfma_f32_16x16x32_bf16 v[192:195], v[64:67], v[96:99], v[192:195]
    ds_read_b128 v[76:79], v17 offset:14336
    v_mfma_f32_16x16x32_bf16 v[196:199], v[64:67], v[100:103], v[196:199]
    v_mfma_f32_16x16x32_bf16 v[200:203], v[64:67], v[104:107], v[200:203]
    v_mfma_f32_16x16x32_bf16 v[204:207], v[64:67], v[108:111], v[204:207]
    s_waitcnt lgkmcnt(0)
    s_barrier
    v_mfma_f32_16x16x32_bf16 v[220:223], v[68:71], v[108:111], v[220:223]
    ds_read_b128 v[64:67], v18 offset:0
    v_mfma_f32_16x16x32_bf16 v[216:219], v[68:71], v[104:107], v[216:219]
    ds_read_b128 v[80:83], v24 offset:0
    v_mfma_f32_16x16x32_bf16 v[212:215], v[68:71], v[100:103], v[212:215]
    ds_read_b128 v[84:87], v24 offset:2048
    v_mfma_f32_16x16x32_bf16 v[208:211], v[68:71], v[96:99], v[208:211]
    v_mfma_f32_16x16x32_bf16 v[224:227], v[72:75], v[96:99], v[224:227]
    ds_read_b128 v[68:71], v18 offset:2048
    v_mfma_f32_16x16x32_bf16 v[228:231], v[72:75], v[100:103], v[228:231]
    ds_read_b128 v[88:91], v24 offset:4096
    v_mfma_f32_16x16x32_bf16 v[232:235], v[72:75], v[104:107], v[232:235]
    v_mfma_f32_16x16x32_bf16 v[236:239], v[72:75], v[108:111], v[236:239]
    v_mfma_f32_16x16x32_bf16 v[252:255], v[76:79], v[108:111], v[252:255]
    ds_read_b128 v[72:75], v18 offset:4096
    v_mfma_f32_16x16x32_bf16 v[248:251], v[76:79], v[104:107], v[248:251]
    ds_read_b128 v[92:95], v24 offset:6144
    v_mfma_f32_16x16x32_bf16 v[244:247], v[76:79], v[100:103], v[244:247]
    v_mfma_f32_16x16x32_bf16 v[240:243], v[76:79], v[96:99], v[240:243]
    v_mov_b32 v14, 0
    global_load_dword v15, v14, s[32:33] sc1
    s_waitcnt lgkmcnt(5)
    v_mfma_f32_16x16x32_bf16 v[128:131], v[64:67], v[80:83], v[128:131]
    ds_read_b128 v[76:79], v18 offset:6144
    s_waitcnt lgkmcnt(5)
    v_mfma_f32_16x16x32_bf16 v[132:135], v[64:67], v[84:87], v[132:135]
    s_waitcnt lgkmcnt(3)
    v_mfma_f32_16x16x32_bf16 v[136:139], v[64:67], v[88:91], v[136:139]
    s_waitcnt lgkmcnt(1)
    v_mfma_f32_16x16x32_bf16 v[140:143], v[64:67], v[92:95], v[140:143]
    v_mfma_f32_16x16x32_bf16 v[156:159], v[68:71], v[92:95], v[156:159]
    ds_read_b128 v[64:67], v18 offset:8192
    v_mfma_f32_16x16x32_bf16 v[152:155], v[68:71], v[88:91], v[152:155]
    ds_read_b128 v[96:99], v25 offset:0
    v_mfma_f32_16x16x32_bf16 v[148:151], v[68:71], v[84:87], v[148:151]
    v_mfma_f32_16x16x32_bf16 v[144:147], v[68:71], v[80:83], v[144:147]
    v_mfma_f32_16x16x32_bf16 v[160:163], v[72:75], v[80:83], v[160:163]
    ds_read_b128 v[68:71], v18 offset:10240
    v_mfma_f32_16x16x32_bf16 v[164:167], v[72:75], v[84:87], v[164:167]
    ds_read_b128 v[100:103], v25 offset:2048
    v_mfma_f32_16x16x32_bf16 v[168:171], v[72:75], v[88:91], v[168:171]
    v_mfma_f32_16x16x32_bf16 v[172:175], v[72:75], v[92:95], v[172:175]
    s_waitcnt lgkmcnt(4)
    v_mfma_f32_16x16x32_bf16 v[188:191], v[76:79], v[92:95], v[188:191]
    ds_read_b128 v[72:75], v18 offset:12288
    v_mfma_f32_16x16x32_bf16 v[184:187], v[76:79], v[88:91], v[184:187]
    ds_read_b128 v[104:107], v25 offset:4096
    v_mfma_f32_16x16x32_bf16 v[180:183], v[76:79], v[84:87], v[180:183]
    v_mfma_f32_16x16x32_bf16 v[176:179], v[76:79], v[80:83], v[176:179]
    s_waitcnt lgkmcnt(5)
    v_mfma_f32_16x16x32_bf16 v[192:195], v[64:67], v[80:83], v[192:195]
    ds_read_b128 v[76:79], v18 offset:14336
    v_mfma_f32_16x16x32_bf16 v[196:199], v[64:67], v[84:87], v[196:199]
    ds_read_b128 v[108:111], v25 offset:6144
    v_mfma_f32_16x16x32_bf16 v[200:203], v[64:67], v[88:91], v[200:203]
    v_mfma_f32_16x16x32_bf16 v[204:207], v[64:67], v[92:95], v[204:207]
    s_waitcnt lgkmcnt(5)
    v_mfma_f32_16x16x32_bf16 v[220:223], v[68:71], v[92:95], v[220:223]
    ds_read_b128 v[64:67], v19 offset:0
    v_mfma_f32_16x16x32_bf16 v[216:219], v[68:71], v[88:91], v[216:219]
    v_mfma_f32_16x16x32_bf16 v[212:215], v[68:71], v[84:87], v[212:215]
    v_mfma_f32_16x16x32_bf16 v[208:211], v[68:71], v[80:83], v[208:211]
    s_waitcnt lgkmcnt(4)
    v_mfma_f32_16x16x32_bf16 v[224:227], v[72:75], v[80:83], v[224:227]
    ds_read_b128 v[68:71], v19 offset:2048
    v_mfma_f32_16x16x32_bf16 v[228:231], v[72:75], v[84:87], v[228:231]
    v_mfma_f32_16x16x32_bf16 v[232:235], v[72:75], v[88:91], v[232:235]
    v_mfma_f32_16x16x32_bf16 v[236:239], v[72:75], v[92:95], v[236:239]
    s_waitcnt lgkmcnt(3)
    v_mfma_f32_16x16x32_bf16 v[252:255], v[76:79], v[92:95], v[252:255]
    ds_read_b128 v[72:75], v19 offset:4096
    v_mfma_f32_16x16x32_bf16 v[248:251], v[76:79], v[88:91], v[248:251]
    v_mfma_f32_16x16x32_bf16 v[244:247], v[76:79], v[84:87], v[244:247]
    v_mfma_f32_16x16x32_bf16 v[240:243], v[76:79], v[80:83], v[240:243]
    s_waitcnt lgkmcnt(2)
    v_mfma_f32_16x16x32_bf16 v[128:131], v[64:67], v[96:99], v[128:131]
    ds_read_b128 v[76:79], v19 offset:6144
    v_mfma_f32_16x16x32_bf16 v[132:135], v[64:67], v[100:103], v[132:135]
    v_mfma_f32_16x16x32_bf16 v[136:139], v[64:67], v[104:107], v[136:139]
    v_mfma_f32_16x16x32_bf16 v[140:143], v[64:67], v[108:111], v[140:143]
    s_waitcnt lgkmcnt(2)
    v_mfma_f32_16x16x32_bf16 v[156:159], v[68:71], v[108:111], v[156:159]
    ds_read_b128 v[64:67], v19 offset:8192
    v_mfma_f32_16x16x32_bf16 v[152:155], v[68:71], v[104:107], v[152:155]
    v_mfma_f32_16x16x32_bf16 v[148:151], v[68:71], v[100:103], v[148:151]
    v_mfma_f32_16x16x32_bf16 v[144:147], v[68:71], v[96:99], v[144:147]
    s_waitcnt lgkmcnt(2)
    v_mfma_f32_16x16x32_bf16 v[160:163], v[72:75], v[96:99], v[160:163]
    ds_read_b128 v[68:71], v19 offset:10240
    v_mfma_f32_16x16x32_bf16 v[164:167], v[72:75], v[100:103], v[164:167]
    v_mfma_f32_16x16x32_bf16 v[168:171], v[72:75], v[104:107], v[168:171]
    v_mfma_f32_16x16x32_bf16 v[172:175], v[72:75], v[108:111], v[172:175]
    s_waitcnt lgkmcnt(2)
    v_mfma_f32_16x16x32_bf16 v[188:191], v[76:79], v[108:111], v[188:191]
    ds_read_b128 v[72:75], v19 offset:12288
    v_mfma_f32_16x16x32_bf16 v[184:187], v[76:79], v[104:107], v[184:187]
    v_mfma_f32_16x16x32_bf16 v[180:183], v[76:79], v[100:103], v[180:183]
    v_mfma_f32_16x16x32_bf16 v[176:179], v[76:79], v[96:99], v[176:179]
    s_waitcnt lgkmcnt(2)
    v_mfma_f32_16x16x32_bf16 v[192:195], v[64:67], v[96:99], v[192:195]
    ds_read_b128 v[76:79], v19 offset:14336
    v_mfma_f32_16x16x32_bf16 v[196:199], v[64:67], v[100:103], v[196:199]
    v_mfma_f32_16x16x32_bf16 v[200:203], v[64:67], v[104:107], v[200:203]
    v_mfma_f32_16x16x32_bf16 v[204:207], v[64:67], v[108:111], v[204:207]
    s_waitcnt lgkmcnt(0)
    s_barrier
    v_mfma_f32_16x16x32_bf16 v[220:223], v[68:71], v[108:111], v[220:223]
    ds_read_b128 v[64:67], v20 offset:0
    v_mfma_f32_16x16x32_bf16 v[216:219], v[68:71], v[104:107], v[216:219]
    ds_read_b128 v[80:83], v26 offset:0
    v_mfma_f32_16x16x32_bf16 v[212:215], v[68:71], v[100:103], v[212:215]
    ds_read_b128 v[84:87], v26 offset:2048
    v_mfma_f32_16x16x32_bf16 v[208:211], v[68:71], v[96:99], v[208:211]
    v_mfma_f32_16x16x32_bf16 v[224:227], v[72:75], v[96:99], v[224:227]
    ds_read_b128 v[68:71], v20 offset:2048
    v_mfma_f32_16x16x32_bf16 v[228:231], v[72:75], v[100:103], v[228:231]
    ds_read_b128 v[88:91], v26 offset:4096
    v_mfma_f32_16x16x32_bf16 v[232:235], v[72:75], v[104:107], v[232:235]
    v_mfma_f32_16x16x32_bf16 v[236:239], v[72:75], v[108:111], v[236:239]
    v_mfma_f32_16x16x32_bf16 v[252:255], v[76:79], v[108:111], v[252:255]
    ds_read_b128 v[72:75], v20 offset:4096
    v_mfma_f32_16x16x32_bf16 v[248:251], v[76:79], v[104:107], v[248:251]
    ds_read_b128 v[92:95], v26 offset:6144
    v_mfma_f32_16x16x32_bf16 v[244:247], v[76:79], v[100:103], v[244:247]
    v_mfma_f32_16x16x32_bf16 v[240:243], v[76:79], v[96:99], v[240:243]
    s_waitcnt lgkmcnt(5)
    v_mfma_f32_16x16x32_bf16 v[128:131], v[64:67], v[80:83], v[128:131]
    ds_read_b128 v[76:79], v20 offset:6144
    s_waitcnt lgkmcnt(5)
    v_mfma_f32_16x16x32_bf16 v[132:135], v[64:67], v[84:87], v[132:135]
    s_waitcnt lgkmcnt(3)
    v_mfma_f32_16x16x32_bf16 v[136:139], v[64:67], v[88:91], v[136:139]
    s_waitcnt lgkmcnt(1)
    v_mfma_f32_16x16x32_bf16 v[140:143], v[64:67], v[92:95], v[140:143]
    v_mfma_f32_16x16x32_bf16 v[156:159], v[68:71], v[92:95], v[156:159]
    ds_read_b128 v[64:67], v20 offset:8192
    v_mfma_f32_16x16x32_bf16 v[152:155], v[68:71], v[88:91], v[152:155]
    ds_read_b128 v[96:99], v27 offset:0
    v_mfma_f32_16x16x32_bf16 v[148:151], v[68:71], v[84:87], v[148:151]
    v_mfma_f32_16x16x32_bf16 v[144:147], v[68:71], v[80:83], v[144:147]
    v_mfma_f32_16x16x32_bf16 v[160:163], v[72:75], v[80:83], v[160:163]
    ds_read_b128 v[68:71], v20 offset:10240
    v_mfma_f32_16x16x32_bf16 v[164:167], v[72:75], v[84:87], v[164:167]
    ds_read_b128 v[100:103], v27 offset:2048
    v_mfma_f32_16x16x32_bf16 v[168:171], v[72:75], v[88:91], v[168:171]
    v_mfma_f32_16x16x32_bf16 v[172:175], v[72:75], v[92:95], v[172:175]
    s_waitcnt lgkmcnt(4)
    v_mfma_f32_16x16x32_bf16 v[188:191], v[76:79], v[92:95], v[188:191]
    ds_read_b128 v[72:75], v20 offset:12288
    v_mfma_f32_16x16x32_bf16 v[184:187], v[76:79], v[88:91], v[184:187]
    ds_read_b128 v[104:107], v27 offset:4096
    v_mfma_f32_16x16x32_bf16 v[180:183], v[76:79], v[84:87], v[180:183]
    v_mfma_f32_16x16x32_bf16 v[176:179], v[76:79], v[80:83], v[176:179]
    s_waitcnt lgkmcnt(5)
    v_mfma_f32_16x16x32_bf16 v[192:195], v[64:67], v[80:83], v[192:195]
    ds_read_b128 v[76:79], v20 offset:14336
    v_mfma_f32_16x16x32_bf16 v[196:199], v[64:67], v[84:87], v[196:199]
    ds_read_b128 v[108:111], v27 offset:6144
    v_mfma_f32_16x16x32_bf16 v[200:203], v[64:67], v[88:91], v[200:203]
    v_mfma_f32_16x16x32_bf16 v[204:207], v[64:67], v[92:95], v[204:207]
    s_waitcnt lgkmcnt(5)
    v_mfma_f32_16x16x32_bf16 v[220:223], v[68:71], v[92:95], v[220:223]
    ds_read_b128 v[64:67], v21 offset:0
    v_mfma_f32_16x16x32_bf16 v[216:219], v[68:71], v[88:91], v[216:219]
    v_mfma_f32_16x16x32_bf16 v[212:215], v[68:71], v[84:87], v[212:215]
    v_mfma_f32_16x16x32_bf16 v[208:211], v[68:71], v[80:83], v[208:211]
    s_waitcnt lgkmcnt(4)
    v_mfma_f32_16x16x32_bf16 v[224:227], v[72:75], v[80:83], v[224:227]
    ds_read_b128 v[68:71], v21 offset:2048
    v_mfma_f32_16x16x32_bf16 v[228:231], v[72:75], v[84:87], v[228:231]
    v_mfma_f32_16x16x32_bf16 v[232:235], v[72:75], v[88:91], v[232:235]
    v_mfma_f32_16x16x32_bf16 v[236:239], v[72:75], v[92:95], v[236:239]
    s_waitcnt lgkmcnt(3)
    v_mfma_f32_16x16x32_bf16 v[252:255], v[76:79], v[92:95], v[252:255]
    ds_read_b128 v[72:75], v21 offset:4096
    v_mfma_f32_16x16x32_bf16 v[248:251], v[76:79], v[88:91], v[248:251]
    v_mfma_f32_16x16x32_bf16 v[244:247], v[76:79], v[84:87], v[244:247]
    v_mfma_f32_16x16x32_bf16 v[240:243], v[76:79], v[80:83], v[240:243]
    s_waitcnt lgkmcnt(2)
    v_mfma_f32_16x16x32_bf16 v[128:131], v[64:67], v[96:99], v[128:131]
    ds_read_b128 v[76:79], v21 offset:6144
    v_mfma_f32_16x16x32_bf16 v[132:135], v[64:67], v[100:103], v[132:135]
    v_mfma_f32_16x16x32_bf16 v[136:139], v[64:67], v[104:107], v[136:139]
    v_mfma_f32_16x16x32_bf16 v[140:143], v[64:67], v[108:111], v[140:143]
    s_waitcnt lgkmcnt(2)
    v_mfma_f32_16x16x32_bf16 v[156:159], v[68:71], v[108:111], v[156:159]
    ds_read_b128 v[64:67], v21 offset:8192
    v_mfma_f32_16x16x32_bf16 v[152:155], v[68:71], v[104:107], v[152:155]
    v_mfma_f32_16x16x32_bf16 v[148:151], v[68:71], v[100:103], v[148:151]
    v_mfma_f32_16x16x32_bf16 v[144:147], v[68:71], v[96:99], v[144:147]
    s_waitcnt lgkmcnt(2)
    v_mfma_f32_16x16x32_bf16 v[160:163], v[72:75], v[96:99], v[160:163]
    ds_read_b128 v[68:71], v21 offset:10240
    v_mfma_f32_16x16x32_bf16 v[164:167], v[72:75], v[100:103], v[164:167]
    v_mfma_f32_16x16x32_bf16 v[168:171], v[72:75], v[104:107], v[168:171]
    v_mfma_f32_16x16x32_bf16 v[172:175], v[72:75], v[108:111], v[172:175]
    s_waitcnt lgkmcnt(2)
    v_mfma_f32_16x16x32_bf16 v[188:191], v[76:79], v[108:111], v[188:191]
    ds_read_b128 v[72:75], v21 offset:12288
    v_mfma_f32_16x16x32_bf16 v[184:187], v[76:79], v[104:107], v[184:187]
    v_mfma_f32_16x16x32_bf16 v[180:183], v[76:79], v[100:103], v[180:183]
    v_mfma_f32_16x16x32_bf16 v[176:179], v[76:79], v[96:99], v[176:179]
    s_waitcnt lgkmcnt(2)
    v_mfma_f32_16x16x32_bf16 v[192:195], v[64:67], v[96:99], v[192:195]
    ds_read_b128 v[76:79], v21 offset:14336
    v_mfma_f32_16x16x32_bf16 v[196:199], v[64:67], v[100:103], v[196:199]
    v_mfma_f32_16x16x32_bf16 v[200:203], v[64:67], v[104:107], v[200:203]
    v_mfma_f32_16x16x32_bf16 v[204:207], v[64:67], v[108:111], v[204:207]
    s_waitcnt lgkmcnt(0)
    s_barrier
    v_mfma_f32_16x16x32_bf16 v[220:223], v[68:71], v[108:111], v[220:223]
    ds_read_b128 v[64:67], v16 offset:0
    v_mfma_f32_16x16x32_bf16 v[216:219], v[68:71], v[104:107], v[216:219]
    ds_read_b128 v[80:83], v22 offset:0
    v_mfma_f32_16x16x32_bf16 v[212:215], v[68:71], v[100:103], v[212:215]
    ds_read_b128 v[84:87], v22 offset:2048
    v_mfma_f32_16x16x32_bf16 v[208:211], v[68:71], v[96:99], v[208:211]
    v_mfma_f32_16x16x32_bf16 v[224:227], v[72:75], v[96:99], v[224:227]
    ds_read_b128 v[68:71], v16 offset:2048
    v_mfma_f32_16x16x32_bf16 v[228:231], v[72:75], v[100:103], v[228:231]
    ds_read_b128 v[88:91], v22 offset:4096
    v_mfma_f32_16x16x32_bf16 v[232:235], v[72:75], v[104:107], v[232:235]
    v_mfma_f32_16x16x32_bf16 v[236:239], v[72:75], v[108:111], v[236:239]
    v_mfma_f32_16x16x32_bf16 v[252:255], v[76:79], v[108:111], v[252:255]
    ds_read_b128 v[72:75], v16 offset:4096
    v_mfma_f32_16x16x32_bf16 v[248:251], v[76:79], v[104:107], v[248:251]
    ds_read_b128 v[92:95], v22 offset:6144
    v_mfma_f32_16x16x32_bf16 v[244:247], v[76:79], v[100:103], v[244:247]
    v_mfma_f32_16x16x32_bf16 v[240:243], v[76:79], v[96:99], v[240:243]
    s_waitcnt lgkmcnt(5)
    v_mfma_f32_16x16x32_bf16 v[128:131], v[64:67], v[80:83], v[128:131]
    ds_read_b128 v[76:79], v16 offset:6144
    s_waitcnt lgkmcnt(5)
    v_mfma_f32_16x16x32_bf16 v[132:135], v[64:67], v[84:87], v[132:135]
    s_waitcnt lgkmcnt(3)
    v_mfma_f32_16x16x32_bf16 v[136:139], v[64:67], v[88:91], v[136:139]
    s_waitcnt lgkmcnt(1)
    v_mfma_f32_16x16x32_bf16 v[140:143], v[64:67], v[92:95], v[140:143]
    v_mfma_f32_16x16x32_bf16 v[156:159], v[68:71], v[92:95], v[156:159]
    ds_read_b128 v[64:67], v16 offset:8192
    v_mfma_f32_16x16x32_bf16 v[152:155], v[68:71], v[88:91], v[152:155]
    ds_read_b128 v[96:99], v23 offset:0
    v_mfma_f32_16x16x32_bf16 v[148:151], v[68:71], v[84:87], v[148:151]
    v_mfma_f32_16x16x32_bf16 v[144:147], v[68:71], v[80:83], v[144:147]
    v_mfma_f32_16x16x32_bf16 v[160:163], v[72:75], v[80:83], v[160:163]
    ds_read_b128 v[68:71], v16 offset:10240
    v_mfma_f32_16x16x32_bf16 v[164:167], v[72:75], v[84:87], v[164:167]
    ds_read_b128 v[100:103], v23 offset:2048
    v_mfma_f32_16x16x32_bf16 v[168:171], v[72:75], v[88:91], v[168:171]
    v_mfma_f32_16x16x32_bf16 v[172:175], v[72:75], v[92:95], v[172:175]
    s_waitcnt lgkmcnt(4)
    v_mfma_f32_16x16x32_bf16 v[188:191], v[76:79], v[92:95], v[188:191]
    ds_read_b128 v[72:75], v16 offset:12288
    v_mfma_f32_16x16x32_bf16 v[184:187], v[76:79], v[88:91], v[184:187]
    ds_read_b128 v[104:107], v23 offset:4096
    v_mfma_f32_16x16x32_bf16 v[180:183], v[76:79], v[84:87], v[180:183]
    v_mfma_f32_16x16x32_bf16 v[176:179], v[76:79], v[80:83], v[176:179]
    s_waitcnt lgkmcnt(5)
    v_mfma_f32_16x16x32_bf16 v[192:195], v[64:67], v[80:83], v[192:195]
    ds_read_b128 v[76:79], v16 offset:14336
    v_mfma_f32_16x16x32_bf16 v[196:199], v[64:67], v[84:87], v[196:199]
    ds_read_b128 v[108:111], v23 offset:6144
    v_mfma_f32_16x16x32_bf16 v[200:203], v[64:67], v[88:91], v[200:203]
    v_mfma_f32_16x16x32_bf16 v[204:207], v[64:67], v[92:95], v[204:207]
    s_waitcnt lgkmcnt(5)
    v_mfma_f32_16x16x32_bf16 v[220:223], v[68:71], v[92:95], v[220:223]
    ds_read_b128 v[64:67], v17 offset:0
    v_mfma_f32_16x16x32_bf16 v[216:219], v[68:71], v[88:91], v[216:219]
    v_mfma_f32_16x16x32_bf16 v[212:215], v[68:71], v[84:87], v[212:215]
    v_mfma_f32_16x16x32_bf16 v[208:211], v[68:71], v[80:83], v[208:211]
    s_waitcnt lgkmcnt(4)
    v_mfma_f32_16x16x32_bf16 v[224:227], v[72:75], v[80:83], v[224:227]
    ds_read_b128 v[68:71], v17 offset:2048
    v_mfma_f32_16x16x32_bf16 v[228:231], v[72:75], v[84:87], v[228:231]
    v_mfma_f32_16x16x32_bf16 v[232:235], v[72:75], v[88:91], v[232:235]
    v_mfma_f32_16x16x32_bf16 v[236:239], v[72:75], v[92:95], v[236:239]
    s_waitcnt lgkmcnt(3)
    v_mfma_f32_16x16x32_bf16 v[252:255], v[76:79], v[92:95], v[252:255]
    ds_read_b128 v[72:75], v17 offset:4096
    v_mfma_f32_16x16x32_bf16 v[248:251], v[76:79], v[88:91], v[248:251]
    v_mfma_f32_16x16x32_bf16 v[244:247], v[76:79], v[84:87], v[244:247]
    v_mfma_f32_16x16x32_bf16 v[240:243], v[76:79], v[80:83], v[240:243]
    s_waitcnt lgkmcnt(2)
    v_mfma_f32_16x16x32_bf16 v[128:131], v[64:67], v[96:99], v[128:131]
    ds_read_b128 v[76:79], v17 offset:6144
    v_mfma_f32_16x16x32_bf16 v[132:135], v[64:67], v[100:103], v[132:135]
    v_mfma_f32_16x16x32_bf16 v[136:139], v[64:67], v[104:107], v[136:139]
    v_mfma_f32_16x16x32_bf16 v[140:143], v[64:67], v[108:111], v[140:143]
    s_waitcnt lgkmcnt(2)
    v_mfma_f32_16x16x32_bf16 v[156:159], v[68:71], v[108:111], v[156:159]
    ds_read_b128 v[64:67], v17 offset:8192
    v_mfma_f32_16x16x32_bf16 v[152:155], v[68:71], v[104:107], v[152:155]
    v_mfma_f32_16x16x32_bf16 v[148:151], v[68:71], v[100:103], v[148:151]
    v_mfma_f32_16x16x32_bf16 v[144:147], v[68:71], v[96:99], v[144:147]
    s_waitcnt lgkmcnt(2)
    v_mfma_f32_16x16x32_bf16 v[160:163], v[72:75], v[96:99], v[160:163]
    ds_read_b128 v[68:71], v17 offset:10240
    v_mfma_f32_16x16x32_bf16 v[164:167], v[72:75], v[100:103], v[164:167]
    v_mfma_f32_16x16x32_bf16 v[168:171], v[72:75], v[104:107], v[168:171]
    v_mfma_f32_16x16x32_bf16 v[172:175], v[72:75], v[108:111], v[172:175]
    s_waitcnt lgkmcnt(2)
    v_mfma_f32_16x16x32_bf16 v[188:191], v[76:79], v[108:111], v[188:191]
    ds_read_b128 v[72:75], v17 offset:12288
    v_mfma_f32_16x16x32_bf16 v[184:187], v[76:79], v[104:107], v[184:187]
    v_mfma_f32_16x16x32_bf16 v[180:183], v[76:79], v[100:103], v[180:183]
    v_mfma_f32_16x16x32_bf16 v[176:179], v[76:79], v[96:99], v[176:179]
    s_waitcnt lgkmcnt(2)
    v_mfma_f32_16x16x32_bf16 v[192:195], v[64:67], v[96:99], v[192:195]
    ds_read_b128 v[76:79], v17 offset:14336
    v_mfma_f32_16x16x32_bf16 v[196:199], v[64:67], v[100:103], v[196:199]
    v_mfma_f32_16x16x32_bf16 v[200:203], v[64:67], v[104:107], v[200:203]
    v_mfma_f32_16x16x32_bf16 v[204:207], v[64:67], v[108:111], v[204:207]
    s_waitcnt lgkmcnt(0)
    s_barrier
    v_mfma_f32_16x16x32_bf16 v[220:223], v[68:71], v[108:111], v[220:223]
    ds_read_b128 v[64:67], v18 offset:0
    v_mfma_f32_16x16x32_bf16 v[216:219], v[68:71], v[104:107], v[216:219]
    ds_read_b128 v[80:83], v24 offset:0
    v_mfma_f32_16x16x32_bf16 v[212:215], v[68:71], v[100:103], v[212:215]
    ds_read_b128 v[84:87], v24 offset:2048
    v_mfma_f32_16x16x32_bf16 v[208:211], v[68:71], v[96:99], v[208:211]
    v_mfma_f32_16x16x32_bf16 v[224:227], v[72:75], v[96:99], v[224:227]
    ds_read_b128 v[68:71], v18 offset:2048
    v_mfma_f32_16x16x32_bf16 v[228:231], v[72:75], v[100:103], v[228:231]
    ds_read_b128 v[88:91], v24 offset:4096
    v_mfma_f32_16x16x32_bf16 v[232:235], v[72:75], v[104:107], v[232:235]
    v_mfma_f32_16x16x32_bf16 v[236:239], v[72:75], v[108:111], v[236:239]
    v_mfma_f32_16x16x32_bf16 v[252:255], v[76:79], v[108:111], v[252:255]
    ds_read_b128 v[72:75], v18 offset:4096
    v_mfma_f32_16x16x32_bf16 v[248:251], v[76:79], v[104:107], v[248:251]
    ds_read_b128 v[92:95], v24 offset:6144
    v_mfma_f32_16x16x32_bf16 v[244:247], v[76:79], v[100:103], v[244:247]
    v_mfma_f32_16x16x32_bf16 v[240:243], v[76:79], v[96:99], v[240:243]
    s_waitcnt lgkmcnt(5)
    v_mfma_f32_16x16x32_bf16 v[128:131], v[64:67], v[80:83], v[128:131]
    ds_read_b128 v[76:79], v18 offset:6144
    s_waitcnt lgkmcnt(5)
    v_mfma_f32_16x16x32_bf16 v[132:135], v[64:67], v[84:87], v[132:135]
    s_waitcnt lgkmcnt(3)
    v_mfma_f32_16x16x32_bf16 v[136:139], v[64:67], v[88:91], v[136:139]
    s_waitcnt lgkmcnt(1)
    v_mfma_f32_16x16x32_bf16 v[140:143], v[64:67], v[92:95], v[140:143]
    v_mfma_f32_16x16x32_bf16 v[156:159], v[68:71], v[92:95], v[156:159]
    ds_read_b128 v[64:67], v18 offset:8192
    v_mfma_f32_16x16x32_bf16 v[152:155], v[68:71], v[88:91], v[152:155]
    ds_read_b128 v[96:99], v25 offset:0
    v_mfma_f32_16x16x32_bf16 v[148:151], v[68:71], v[84:87], v[148:151]
    v_mfma_f32_16x16x32_bf16 v[144:147], v[68:71], v[80:83], v[144:147]
    v_mfma_f32_16x16x32_bf16 v[160:163], v[72:75], v[80:83], v[160:163]
    ds_read_b128 v[68:71], v18 offset:10240
    v_mfma_f32_16x16x32_bf16 v[164:167], v[72:75], v[84:87], v[164:167]
    ds_read_b128 v[100:103], v25 offset:2048
    v_mfma_f32_16x16x32_bf16 v[168:171], v[72:75], v[88:91], v[168:171]
    v_mfma_f32_16x16x32_bf16 v[172:175], v[72:75], v[92:95], v[172:175]
    s_waitcnt lgkmcnt(4)
    v_mfma_f32_16x16x32_bf16 v[188:191], v[76:79], v[92:95], v[188:191]
    ds_read_b128 v[72:75], v18 offset:12288
    v_mfma_f32_16x16x32_bf16 v[184:187], v[76:79], v[88:91], v[184:187]
    ds_read_b128 v[104:107], v25 offset:4096
    v_mfma_f32_16x16x32_bf16 v[180:183], v[76:79], v[84:87], v[180:183]
    v_mfma_f32_16x16x32_bf16 v[176:179], v[76:79], v[80:83], v[176:179]
    s_waitcnt lgkmcnt(5)
    v_mfma_f32_16x16x32_bf16 v[192:195], v[64:67], v[80:83], v[192:195]
    ds_read_b128 v[76:79], v18 offset:14336
    v_mfma_f32_16x16x32_bf16 v[196:199], v[64:67], v[84:87], v[196:199]
    ds_read_b128 v[108:111], v25 offset:6144
    v_mfma_f32_16x16x32_bf16 v[200:203], v[64:67], v[88:91], v[200:203]
    v_mfma_f32_16x16x32_bf16 v[204:207], v[64:67], v[92:95], v[204:207]
    s_waitcnt lgkmcnt(5)
    v_mfma_f32_16x16x32_bf16 v[220:223], v[68:71], v[92:95], v[220:223]
    ds_read_b128 v[64:67], v19 offset:0
    v_mfma_f32_16x16x32_bf16 v[216:219], v[68:71], v[88:91], v[216:219]
    v_mfma_f32_16x16x32_bf16 v[212:215], v[68:71], v[84:87], v[212:215]
    v_mfma_f32_16x16x32_bf16 v[208:211], v[68:71], v[80:83], v[208:211]
    s_waitcnt lgkmcnt(4)
    v_mfma_f32_16x16x32_bf16 v[224:227], v[72:75], v[80:83], v[224:227]
    ds_read_b128 v[68:71], v19 offset:2048
    v_mfma_f32_16x16x32_bf16 v[228:231], v[72:75], v[84:87], v[228:231]
    v_mfma_f32_16x16x32_bf16 v[232:235], v[72:75], v[88:91], v[232:235]
    v_mfma_f32_16x16x32_bf16 v[236:239], v[72:75], v[92:95], v[236:239]
    s_waitcnt lgkmcnt(3)
    v_mfma_f32_16x16x32_bf16 v[252:255], v[76:79], v[92:95], v[252:255]
    ds_read_b128 v[72:75], v19 offset:4096
    v_mfma_f32_16x16x32_bf16 v[248:251], v[76:79], v[88:91], v[248:251]
    v_mfma_f32_16x16x32_bf16 v[244:247], v[76:79], v[84:87], v[244:247]
    v_mfma_f32_16x16x32_bf16 v[240:243], v[76:79], v[80:83], v[240:243]
    s_waitcnt lgkmcnt(2)
    v_mfma_f32_16x16x32_bf16 v[128:131], v[64:67], v[96:99], v[128:131]
    ds_read_b128 v[76:79], v19 offset:6144
    v_mfma_f32_16x16x32_bf16 v[132:135], v[64:67], v[100:103], v[132:135]
    v_mfma_f32_16x16x32_bf16 v[136:139], v[64:67], v[104:107], v[136:139]
    v_mfma_f32_16x16x32_bf16 v[140:143], v[64:67], v[108:111], v[140:143]
    s_waitcnt lgkmcnt(2)
    v_mfma_f32_16x16x32_bf16 v[156:159], v[68:71], v[108:111], v[156:159]
    ds_read_b128 v[64:67], v19 offset:8192
    v_mfma_f32_16x16x32_bf16 v[152:155], v[68:71], v[104:107], v[152:155]
    v_mfma_f32_16x16x32_bf16 v[148:151], v[68:71], v[100:103], v[148:151]
    v_mfma_f32_16x16x32_bf16 v[144:147], v[68:71], v[96:99], v[144:147]
    s_waitcnt lgkmcnt(2)
    v_mfma_f32_16x16x32_bf16 v[160:163], v[72:75], v[96:99], v[160:163]
    ds_read_b128 v[68:71], v19 offset:10240
    v_mfma_f32_16x16x32_bf16 v[164:167], v[72:75], v[100:103], v[164:167]
    v_mfma_f32_16x16x32_bf16 v[168:171], v[72:75], v[104:107], v[168:171]
    v_mfma_f32_16x16x32_bf16 v[172:175], v[72:75], v[108:111], v[172:175]
    s_waitcnt lgkmcnt(2)
    v_mfma_f32_16x16x32_bf16 v[188:191], v[76:79], v[108:111], v[188:191]
    ds_read_b128 v[72:75], v19 offset:12288
    v_mfma_f32_16x16x32_bf16 v[184:187], v[76:79], v[104:107], v[184:187]
    v_mfma_f32_16x16x32_bf16 v[180:183], v[76:79], v[100:103], v[180:183]
    v_mfma_f32_16x16x32_bf16 v[176:179], v[76:79], v[96:99], v[176:179]
    s_waitcnt lgkmcnt(2)
    v_mfma_f32_16x16x32_bf16 v[192:195], v[64:67], v[96:99], v[192:195]
    ds_read_b128 v[76:79], v19 offset:14336
    v_mfma_f32_16x16x32_bf16 v[196:199], v[64:67], v[100:103], v[196:199]
    v_mfma_f32_16x16x32_bf16 v[200:203], v[64:67], v[104:107], v[200:203]
    v_mfma_f32_16x16x32_bf16 v[204:207], v[64:67], v[108:111], v[204:207]
    s_waitcnt lgkmcnt(0)
    s_barrier
    v_mfma_f32_16x16x32_bf16 v[220:223], v[68:71], v[108:111], v[220:223]
    ds_read_b128 v[64:67], v20 offset:0
    v_mfma_f32_16x16x32_bf16 v[216:219], v[68:71], v[104:107], v[216:219]
    ds_read_b128 v[80:83], v26 offset:0
    v_mfma_f32_16x16x32_bf16 v[212:215], v[68:71], v[100:103], v[212:215]
    ds_read_b128 v[84:87], v26 offset:2048
    v_mfma_f32_16x16x32_bf16 v[208:211], v[68:71], v[96:99], v[208:211]
    v_mfma_f32_16x16x32_bf16 v[224:227], v[72:75], v[96:99], v[224:227]
    ds_read_b128 v[68:71], v20 offset:2048
    v_mfma_f32_16x16x32_bf16 v[228:231], v[72:75], v[100:103], v[228:231]
    ds_read_b128 v[88:91], v26 offset:4096
    v_mfma_f32_16x16x32_bf16 v[232:235], v[72:75], v[104:107], v[232:235]
    v_mfma_f32_16x16x32_bf16 v[236:239], v[72:75], v[108:111], v[236:239]
    v_mfma_f32_16x16x32_bf16 v[252:255], v[76:79], v[108:111], v[252:255]
    ds_read_b128 v[72:75], v20 offset:4096
    v_mfma_f32_16x16x32_bf16 v[248:251], v[76:79], v[104:107], v[248:251]
    ds_read_b128 v[92:95], v26 offset:6144
    v_mfma_f32_16x16x32_bf16 v[244:247], v[76:79], v[100:103], v[244:247]
    v_mfma_f32_16x16x32_bf16 v[240:243], v[76:79], v[96:99], v[240:243]
    s_waitcnt lgkmcnt(5)
    v_mfma_f32_16x16x32_bf16 v[128:131], v[64:67], v[80:83], v[128:131]
    ds_read_b128 v[76:79], v20 offset:6144
    s_waitcnt lgkmcnt(5)
    v_mfma_f32_16x16x32_bf16 v[132:135], v[64:67], v[84:87], v[132:135]
    s_waitcnt lgkmcnt(3)
    v_mfma_f32_16x16x32_bf16 v[136:139], v[64:67], v[88:91], v[136:139]
    s_waitcnt lgkmcnt(1)
    v_mfma_f32_16x16x32_bf16 v[140:143], v[64:67], v[92:95], v[140:143]
    v_mfma_f32_16x16x32_bf16 v[156:159], v[68:71], v[92:95], v[156:159]
    ds_read_b128 v[64:67], v20 offset:8192
    v_mfma_f32_16x16x32_bf16 v[152:155], v[68:71], v[88:91], v[152:155]
    ds_read_b128 v[96:99], v27 offset:0
    v_mfma_f32_16x16x32_bf16 v[148:151], v[68:71], v[84:87], v[148:151]
    v_mfma_f32_16x16x32_bf16 v[144:147], v[68:71], v[80:83], v[144:147]
    v_mfma_f32_16x16x32_bf16 v[160:163], v[72:75], v[80:83], v[160:163]
    ds_read_b128 v[68:71], v20 offset:10240
    v_mfma_f32_16x16x32_bf16 v[164:167], v[72:75], v[84:87], v[164:167]
    ds_read_b128 v[100:103], v27 offset:2048
    v_mfma_f32_16x16x32_bf16 v[168:171], v[72:75], v[88:91], v[168:171]
    v_mfma_f32_16x16x32_bf16 v[172:175], v[72:75], v[92:95], v[172:175]
    s_waitcnt lgkmcnt(4)
    v_mfma_f32_16x16x32_bf16 v[188:191], v[76:79], v[92:95], v[188:191]
    ds_read_b128 v[72:75], v20 offset:12288
    v_mfma_f32_16x16x32_bf16 v[184:187], v[76:79], v[88:91], v[184:187]
    ds_read_b128 v[104:107], v27 offset:4096
    v_mfma_f32_16x16x32_bf16 v[180:183], v[76:79], v[84:87], v[180:183]
    v_mfma_f32_16x16x32_bf16 v[176:179], v[76:79], v[80:83], v[176:179]
    s_waitcnt lgkmcnt(5)
    v_mfma_f32_16x16x32_bf16 v[192:195], v[64:67], v[80:83], v[192:195]
    ds_read_b128 v[76:79], v20 offset:14336
    v_mfma_f32_16x16x32_bf16 v[196:199], v[64:67], v[84:87], v[196:199]
    ds_read_b128 v[108:111], v27 offset:6144
    v_mfma_f32_16x16x32_bf16 v[200:203], v[64:67], v[88:91], v[200:203]
    v_mfma_f32_16x16x32_bf16 v[204:207], v[64:67], v[92:95], v[204:207]
    s_waitcnt lgkmcnt(5)
    v_mfma_f32_16x16x32_bf16 v[220:223], v[68:71], v[92:95], v[220:223]
    ds_read_b128 v[64:67], v21 offset:0
    v_mfma_f32_16x16x32_bf16 v[216:219], v[68:71], v[88:91], v[216:219]
    v_mfma_f32_16x16x32_bf16 v[212:215], v[68:71], v[84:87], v[212:215]
    v_mfma_f32_16x16x32_bf16 v[208:211], v[68:71], v[80:83], v[208:211]
    s_waitcnt lgkmcnt(4)
    v_mfma_f32_16x16x32_bf16 v[224:227], v[72:75], v[80:83], v[224:227]
    ds_read_b128 v[68:71], v21 offset:2048
    v_mfma_f32_16x16x32_bf16 v[228:231], v[72:75], v[84:87], v[228:231]
    v_mfma_f32_16x16x32_bf16 v[232:235], v[72:75], v[88:91], v[232:235]
    v_mfma_f32_16x16x32_bf16 v[236:239], v[72:75], v[92:95], v[236:239]
    s_waitcnt lgkmcnt(3)
    v_mfma_f32_16x16x32_bf16 v[252:255], v[76:79], v[92:95], v[252:255]
    ds_read_b128 v[72:75], v21 offset:4096
    v_mfma_f32_16x16x32_bf16 v[248:251], v[76:79], v[88:91], v[248:251]
    v_mfma_f32_16x16x32_bf16 v[244:247], v[76:79], v[84:87], v[244:247]
    v_mfma_f32_16x16x32_bf16 v[240:243], v[76:79], v[80:83], v[240:243]
    s_waitcnt lgkmcnt(2)
    v_mfma_f32_16x16x32_bf16 v[128:131], v[64:67], v[96:99], v[128:131]
    ds_read_b128 v[76:79], v21 offset:6144
    v_mfma_f32_16x16x32_bf16 v[132:135], v[64:67], v[100:103], v[132:135]
    v_mfma_f32_16x16x32_bf16 v[136:139], v[64:67], v[104:107], v[136:139]
    v_mfma_f32_16x16x32_bf16 v[140:143], v[64:67], v[108:111], v[140:143]
    s_waitcnt lgkmcnt(2)
    v_mfma_f32_16x16x32_bf16 v[156:159], v[68:71], v[108:111], v[156:159]
    ds_read_b128 v[64:67], v21 offset:8192
    v_mfma_f32_16x16x32_bf16 v[152:155], v[68:71], v[104:107], v[152:155]
    v_mfma_f32_16x16x32_bf16 v[148:151], v[68:71], v[100:103], v[148:151]
    v_mfma_f32_16x16x32_bf16 v[144:147], v[68:71], v[96:99], v[144:147]
    s_waitcnt lgkmcnt(2)
    v_mfma_f32_16x16x32_bf16 v[160:163], v[72:75], v[96:99], v[160:163]
    ds_read_b128 v[68:71], v21 offset:10240
    v_mfma_f32_16x16x32_bf16 v[164:167], v[72:75], v[100:103], v[164:167]
    v_mfma_f32_16x16x32_bf16 v[168:171], v[72:75], v[104:107], v[168:171]
    v_mfma_f32_16x16x32_bf16 v[172:175], v[72:75], v[108:111], v[172:175]
    s_waitcnt lgkmcnt(2)
    v_mfma_f32_16x16x32_bf16 v[188:191], v[76:79], v[108:111], v[188:191]
    ds_read_b128 v[72:75], v21 offset:12288
    v_mfma_f32_16x16x32_bf16 v[184:187], v[76:79], v[104:107], v[184:187]
    v_mfma_f32_16x16x32_bf16 v[180:183], v[76:79], v[100:103], v[180:183]
    v_mfma_f32_16x16x32_bf16 v[176:179], v[76:79], v[96:99], v[176:179]
    s_waitcnt lgkmcnt(2)
    v_mfma_f32_16x16x32_bf16 v[192:195], v[64:67], v[96:99], v[192:195]
    ds_read_b128 v[76:79], v21 offset:14336
    v_mfma_f32_16x16x32_bf16 v[196:199], v[64:67], v[100:103], v[196:199]
    v_mfma_f32_16x16x32_bf16 v[200:203], v[64:67], v[104:107], v[200:203]
    v_mfma_f32_16x16x32_bf16 v[204:207], v[64:67], v[108:111], v[204:207]
    s_waitcnt lgkmcnt(0)
    s_barrier
    v_mfma_f32_16x16x32_bf16 v[220:223], v[68:71], v[108:111], v[220:223]
    ds_read_b128 v[64:67], v16 offset:0
    v_mfma_f32_16x16x32_bf16 v[216:219], v[68:71], v[104:107], v[216:219]
    ds_read_b128 v[80:83], v22 offset:0
    v_mfma_f32_16x16x32_bf16 v[212:215], v[68:71], v[100:103], v[212:215]
    ds_read_b128 v[84:87], v22 offset:2048
    v_mfma_f32_16x16x32_bf16 v[208:211], v[68:71], v[96:99], v[208:211]
    v_mfma_f32_16x16x32_bf16 v[224:227], v[72:75], v[96:99], v[224:227]
    ds_read_b128 v[68:71], v16 offset:2048
    v_mfma_f32_16x16x32_bf16 v[228:231], v[72:75], v[100:103], v[228:231]
    ds_read_b128 v[88:91], v22 offset:4096
    v_mfma_f32_16x16x32_bf16 v[232:235], v[72:75], v[104:107], v[232:235]
    v_mfma_f32_16x16x32_bf16 v[236:239], v[72:75], v[108:111], v[236:239]
    v_mfma_f32_16x16x32_bf16 v[252:255], v[76:79], v[108:111], v[252:255]
    ds_read_b128 v[72:75], v16 offset:4096
    v_mfma_f32_16x16x32_bf16 v[248:251], v[76:79], v[104:107], v[248:251]
    ds_read_b128 v[92:95], v22 offset:6144
    v_mfma_f32_16x16x32_bf16 v[244:247], v[76:79], v[100:103], v[244:247]
    v_mfma_f32_16x16x32_bf16 v[240:243], v[76:79], v[96:99], v[240:243]
    s_waitcnt lgkmcnt(5)
    v_mfma_f32_16x16x32_bf16 v[128:131], v[64:67], v[80:83], v[128:131]
    ds_read_b128 v[76:79], v16 offset:6144
    s_waitcnt lgkmcnt(5)
    v_mfma_f32_16x16x32_bf16 v[132:135], v[64:67], v[84:87], v[132:135]
    s_waitcnt lgkmcnt(3)
    v_mfma_f32_16x16x32_bf16 v[136:139], v[64:67], v[88:91], v[136:139]
    s_waitcnt lgkmcnt(1)
    v_mfma_f32_16x16x32_bf16 v[140:143], v[64:67], v[92:95], v[140:143]
    v_mfma_f32_16x16x32_bf16 v[156:159], v[68:71], v[92:95], v[156:159]
    ds_read_b128 v[64:67], v16 offset:8192
    v_mfma_f32_16x16x32_bf16 v[152:155], v[68:71], v[88:91], v[152:155]
    ds_read_b128 v[96:99], v23 offset:0
    v_mfma_f32_16x16x32_bf16 v[148:151], v[68:71], v[84:87], v[148:151]
    v_mfma_f32_16x16x32_bf16 v[144:147], v[68:71], v[80:83], v[144:147]
    v_mfma_f32_16x16x32_bf16 v[160:163], v[72:75], v[80:83], v[160:163]
    ds_read_b128 v[68:71], v16 offset:10240
    v_mfma_f32_16x16x32_bf16 v[164:167], v[72:75], v[84:87], v[164:167]
    ds_read_b128 v[100:103], v23 offset:2048
    v_mfma_f32_16x16x32_bf16 v[168:171], v[72:75], v[88:91], v[168:171]
    v_mfma_f32_16x16x32_bf16 v[172:175], v[72:75], v[92:95], v[172:175]
    s_waitcnt lgkmcnt(4)
    v_mfma_f32_16x16x32_bf16 v[188:191], v[76:79], v[92:95], v[188:191]
    ds_read_b128 v[72:75], v16 offset:12288
    v_mfma_f32_16x16x32_bf16 v[184:187], v[76:79], v[88:91], v[184:187]
    ds_read_b128 v[104:107], v23 offset:4096
    v_mfma_f32_16x16x32_bf16 v[180:183], v[76:79], v[84:87], v[180:183]
    v_mfma_f32_16x16x32_bf16 v[176:179], v[76:79], v[80:83], v[176:179]
    s_waitcnt lgkmcnt(5)
    v_mfma_f32_16x16x32_bf16 v[192:195], v[64:67], v[80:83], v[192:195]
    ds_read_b128 v[76:79], v16 offset:14336
    v_mfma_f32_16x16x32_bf16 v[196:199], v[64:67], v[84:87], v[196:199]
    ds_read_b128 v[108:111], v23 offset:6144
    v_mfma_f32_16x16x32_bf16 v[200:203], v[64:67], v[88:91], v[200:203]
    v_mfma_f32_16x16x32_bf16 v[204:207], v[64:67], v[92:95], v[204:207]
    s_waitcnt lgkmcnt(5)
    v_mfma_f32_16x16x32_bf16 v[220:223], v[68:71], v[92:95], v[220:223]
    ds_read_b128 v[64:67], v17 offset:0
    v_mfma_f32_16x16x32_bf16 v[216:219], v[68:71], v[88:91], v[216:219]
    v_mfma_f32_16x16x32_bf16 v[212:215], v[68:71], v[84:87], v[212:215]
    v_mfma_f32_16x16x32_bf16 v[208:211], v[68:71], v[80:83], v[208:211]
    s_waitcnt lgkmcnt(4)
    v_mfma_f32_16x16x32_bf16 v[224:227], v[72:75], v[80:83], v[224:227]
    ds_read_b128 v[68:71], v17 offset:2048
    v_mfma_f32_16x16x32_bf16 v[228:231], v[72:75], v[84:87], v[228:231]
    v_mfma_f32_16x16x32_bf16 v[232:235], v[72:75], v[88:91], v[232:235]
    v_mfma_f32_16x16x32_bf16 v[236:239], v[72:75], v[92:95], v[236:239]
    s_waitcnt lgkmcnt(3)
    v_mfma_f32_16x16x32_bf16 v[252:255], v[76:79], v[92:95], v[252:255]
    ds_read_b128 v[72:75], v17 offset:4096
    v_mfma_f32_16x16x32_bf16 v[248:251], v[76:79], v[88:91], v[248:251]
    v_mfma_f32_16x16x32_bf16 v[244:247], v[76:79], v[84:87], v[244:247]
    v_mfma_f32_16x16x32_bf16 v[240:243], v[76:79], v[80:83], v[240:243]
    s_waitcnt lgkmcnt(2)
    v_mfma_f32_16x16x32_bf16 v[128:131], v[64:67], v[96:99], v[128:131]
    ds_read_b128 v[76:79], v17 offset:6144
    v_mfma_f32_16x16x32_bf16 v[132:135], v[64:67], v[100:103], v[132:135]
    v_mfma_f32_16x16x32_bf16 v[136:139], v[64:67], v[104:107], v[136:139]
    v_mfma_f32_16x16x32_bf16 v[140:143], v[64:67], v[108:111], v[140:143]
    s_waitcnt lgkmcnt(2)
    v_mfma_f32_16x16x32_bf16 v[156:159], v[68:71], v[108:111], v[156:159]
    ds_read_b128 v[64:67], v17 offset:8192
    v_mfma_f32_16x16x32_bf16 v[152:155], v[68:71], v[104:107], v[152:155]
    v_mfma_f32_16x16x32_bf16 v[148:151], v[68:71], v[100:103], v[148:151]
    v_mfma_f32_16x16x32_bf16 v[144:147], v[68:71], v[96:99], v[144:147]
    s_waitcnt lgkmcnt(2)
    v_mfma_f32_16x16x32_bf16 v[160:163], v[72:75], v[96:99], v[160:163]
    ds_read_b128 v[68:71], v17 offset:10240
    v_mfma_f32_16x16x32_bf16 v[164:167], v[72:75], v[100:103], v[164:167]
    v_mfma_f32_16x16x32_bf16 v[168:171], v[72:75], v[104:107], v[168:171]
    v_mfma_f32_16x16x32_bf16 v[172:175], v[72:75], v[108:111], v[172:175]
    s_waitcnt lgkmcnt(2)
    v_mfma_f32_16x16x32_bf16 v[188:191], v[76:79], v[108:111], v[188:191]
    ds_read_b128 v[72:75], v17 offset:12288
    v_mfma_f32_16x16x32_bf16 v[184:187], v[76:79], v[104:107], v[184:187]
    v_mfma_f32_16x16x32_bf16 v[180:183], v[76:79], v[100:103], v[180:183]
    v_mfma_f32_16x16x32_bf16 v[176:179], v[76:79], v[96:99], v[176:179]
    s_waitcnt lgkmcnt(2)
    v_mfma_f32_16x16x32_bf16 v[192:195], v[64:67], v[96:99], v[192:195]
    ds_read_b128 v[76:79], v17 offset:14336
    v_mfma_f32_16x16x32_bf16 v[196:199], v[64:67], v[100:103], v[196:199]
    v_mfma_f32_16x16x32_bf16 v[200:203], v[64:67], v[104:107], v[200:203]
    v_mfma_f32_16x16x32_bf16 v[204:207], v[64:67], v[108:111], v[204:207]
    s_waitcnt lgkmcnt(2)
    v_mfma_f32_16x16x32_bf16 v[220:223], v[68:71], v[108:111], v[220:223]
    v_mfma_f32_16x16x32_bf16 v[216:219], v[68:71], v[104:107], v[216:219]
    v_mfma_f32_16x16x32_bf16 v[212:215], v[68:71], v[100:103], v[212:215]
    v_mfma_f32_16x16x32_bf16 v[208:211], v[68:71], v[96:99], v[208:211]
    s_waitcnt lgkmcnt(1)
    v_mfma_f32_16x16x32_bf16 v[224:227], v[72:75], v[96:99], v[224:227]
    v_mfma_f32_16x16x32_bf16 v[228:231], v[72:75], v[100:103], v[228:231]
    v_mfma_f32_16x16x32_bf16 v[232:235], v[72:75], v[104:107], v[232:235]
    v_mfma_f32_16x16x32_bf16 v[236:239], v[72:75], v[108:111], v[236:239]
    s_waitcnt lgkmcnt(0)
    v_mfma_f32_16x16x32_bf16 v[252:255], v[76:79], v[108:111], v[252:255]
    v_mfma_f32_16x16x32_bf16 v[248:251], v[76:79], v[104:107], v[248:251]
    v_mfma_f32_16x16x32_bf16 v[244:247], v[76:79], v[100:103], v[244:247]
    v_mfma_f32_16x16x32_bf16 v[240:243], v[76:79], v[96:99], v[240:243]
    s_mov_b32 s44, s34
    s_mov_b32 s45, s35
    s_mov_b32 s46, 28311552
    s_mov_b32 s47, 0x00020000
    s_nop 7
    v_pk_fma_f32 v[116:117], v[40:41], v[128:129], v[130:131] op_sel:[0,0,0] op_sel_hi:[0,1,1]
    v_pk_fma_f32 v[124:125], v[52:53], v[132:133], v[134:135] op_sel:[0,0,0] op_sel_hi:[0,1,1]
    v_pk_fma_f32 v[118:119], v[40:41], v[136:137], v[138:139] op_sel:[0,0,0] op_sel_hi:[0,1,1]
    v_pk_fma_f32 v[126:127], v[52:53], v[140:141], v[142:143] op_sel:[0,0,0] op_sel_hi:[0,1,1]
    v_pk_fma_f32 v[116:117], v[40:41], v[136:137], v[116:117] op_sel:[1,0,0] op_sel_hi:[1,1,1] neg_lo:[1,0,0] neg_hi:[1,0,0]
    v_pk_fma_f32 v[124:125], v[52:53], v[140:141], v[124:125] op_sel:[1,0,0] op_sel_hi:[1,1,1] neg_lo:[1,0,0] neg_hi:[1,0,0]
    v_pk_fma_f32 v[118:119], v[40:41], v[128:129], v[118:119] op_sel:[1,0,0] op_sel_hi:[1,1,1]
    v_pk_fma_f32 v[126:127], v[52:53], v[132:133], v[126:127] op_sel:[1,0,0] op_sel_hi:[1,1,1]
    v_pk_fma_f32 v[112:113], v[40:41], v[116:117], v[144:145] op_sel:[0,0,0] op_sel_hi:[0,1,1]
    v_pk_fma_f32 v[120:121], v[52:53], v[124:125], v[148:149] op_sel:[0,0,0] op_sel_hi:[0,1,1]
    v_pk_fma_f32 v[114:115], v[40:41], v[118:119], v[152:153] op_sel:[0,0,0] op_sel_hi:[0,1,1]
    v_pk_fma_f32 v[122:123], v[52:53], v[126:127], v[156:157] op_sel:[0,0,0] op_sel_hi:[0,1,1]
    v_pk_fma_f32 v[112:113], v[40:41], v[118:119], v[112:113] op_sel:[1,0,0] op_sel_hi:[1,1,1] neg_lo:[1,0,0] neg_hi:[1,0,0]
    v_pk_fma_f32 v[120:121], v[52:53], v[126:127], v[120:121] op_sel:[1,0,0] op_sel_hi:[1,1,1] neg_lo:[1,0,0] neg_hi:[1,0,0]
    v_pk_fma_f32 v[114:115], v[40:41], v[116:117], v[114:115] op_sel:[1,0,0] op_sel_hi:[1,1,1]
    v_pk_fma_f32 v[122:123], v[52:53], v[124:125], v[122:123] op_sel:[1,0,0] op_sel_hi:[1,1,1]
    v_pk_fma_f32 v[116:117], v[40:41], v[112:113], v[146:147] op_sel:[0,0,0] op_sel_hi:[0,1,1]
    v_pk_fma_f32 v[124:125], v[52:53], v[120:121], v[150:151] op_sel:[0,0,0] op_sel_hi:[0,1,1]
    v_pk_fma_f32 v[118:119], v[40:41], v[114:115], v[154:155] op_sel:[0,0,0] op_sel_hi:[0,1,1]
    v_pk_fma_f32 v[126:127], v[52:53], v[122:123], v[158:159] op_sel:[0,0,0] op_sel_hi:[0,1,1]
    v_pk_fma_f32 v[116:117], v[40:41], v[114:115], v[116:117] op_sel:[1,0,0] op_sel_hi:[1,1,1] neg_lo:[1,0,0] neg_hi:[1,0,0]
    v_pk_fma_f32 v[124:125], v[52:53], v[122:123], v[124:125] op_sel:[1,0,0] op_sel_hi:[1,1,1] neg_lo:[1,0,0] neg_hi:[1,0,0]
    v_pk_fma_f32 v[118:119], v[40:41], v[112:113], v[118:119] op_sel:[1,0,0] op_sel_hi:[1,1,1]
    v_pk_fma_f32 v[126:127], v[52:53], v[120:121], v[126:127] op_sel:[1,0,0] op_sel_hi:[1,1,1]
    v_pk_fma_f32 v[112:113], v[40:41], v[116:117], v[160:161] op_sel:[0,0,0] op_sel_hi:[0,1,1]
    v_pk_fma_f32 v[120:121], v[52:53], v[124:125], v[164:165] op_sel:[0,0,0] op_sel_hi:[0,1,1]
    v_pk_fma_f32 v[114:115], v[40:41], v[118:119], v[168:169] op_sel:[0,0,0] op_sel_hi:[0,1,1]
    v_pk_fma_f32 v[122:123], v[52:53], v[126:127], v[172:173] op_sel:[0,0,0] op_sel_hi:[0,1,1]
    v_pk_fma_f32 v[112:113], v[40:41], v[118:119], v[112:113] op_sel:[1,0,0] op_sel_hi:[1,1,1] neg_lo:[1,0,0] neg_hi:[1,0,0]
    v_pk_fma_f32 v[120:121], v[52:53], v[126:127], v[120:121] op_sel:[1,0,0] op_sel_hi:[1,1,1] neg_lo:[1,0,0] neg_hi:[1,0,0]
    v_pk_fma_f32 v[114:115], v[40:41], v[116:117], v[114:115] op_sel:[1,0,0] op_sel_hi:[1,1,1]
    v_pk_fma_f32 v[122:123], v[52:53], v[124:125], v[122:123] op_sel:[1,0,0] op_sel_hi:[1,1,1]
    v_pk_fma_f32 v[116:117], v[40:41], v[112:113], v[162:163] op_sel:[0,0,0] op_sel_hi:[0,1,1]
    v_pk_fma_f32 v[124:125], v[52:53], v[120:121], v[166:167] op_sel:[0,0,0] op_sel_hi:[0,1,1]
    v_pk_fma_f32 v[118:119], v[40:41], v[114:115], v[170:171] op_sel:[0,0,0] op_sel_hi:[0,1,1]
    v_pk_fma_f32 v[126:127], v[52:53], v[122:123], v[174:175] op_sel:[0,0,0] op_sel_hi:[0,1,1]
    v_pk_fma_f32 v[116:117], v[40:41], v[114:115], v[116:117] op_sel:[1,0,0] op_sel_hi:[1,1,1] neg_lo:[1,0,0] neg_hi:[1,0,0]
    v_pk_fma_f32 v[124:125], v[52:53], v[122:123], v[124:125] op_sel:[1,0,0] op_sel_hi:[1,1,1] neg_lo:[1,0,0] neg_hi:[1,0,0]
    v_pk_fma_f32 v[118:119], v[40:41], v[112:113], v[118:119] op_sel:[1,0,0] op_sel_hi:[1,1,1]
    v_pk_fma_f32 v[126:127], v[52:53], v[120:121], v[126:127] op_sel:[1,0,0] op_sel_hi:[1,1,1]
    v_pk_fma_f32 v[112:113], v[40:41], v[116:117], v[176:177] op_sel:[0,0,0] op_sel_hi:[0,1,1]
    v_pk_fma_f32 v[120:121], v[52:53], v[124:125], v[180:181] op_sel:[0,0,0] op_sel_hi:[0,1,1]
    v_pk_fma_f32 v[114:115], v[40:41], v[118:119], v[184:185] op_sel:[0,0,0] op_sel_hi:[0,1,1]
    v_pk_fma_f32 v[122:123], v[52:53], v[126:127], v[188:189] op_sel:[0,0,0] op_sel_hi:[0,1,1]
    v_pk_fma_f32 v[112:113], v[40:41], v[118:119], v[112:113] op_sel:[1,0,0] op_sel_hi:[1,1,1] neg_lo:[1,0,0] neg_hi:[1,0,0]
    v_pk_fma_f32 v[120:121], v[52:53], v[126:127], v[120:121] op_sel:[1,0,0] op_sel_hi:[1,1,1] neg_lo:[1,0,0] neg_hi:[1,0,0]
    v_pk_fma_f32 v[114:115], v[40:41], v[116:117], v[114:115] op_sel:[1,0,0] op_sel_hi:[1,1,1]
    v_pk_fma_f32 v[122:123], v[52:53], v[124:125], v[122:123] op_sel:[1,0,0] op_sel_hi:[1,1,1]
    v_pk_fma_f32 v[116:117], v[40:41], v[112:113], v[178:179] op_sel:[0,0,0] op_sel_hi:[0,1,1]
    v_pk_fma_f32 v[124:125], v[52:53], v[120:121], v[182:183] op_sel:[0,0,0] op_sel_hi:[0,1,1]
    v_pk_fma_f32 v[118:119], v[40:41], v[114:115], v[186:187] op_sel:[0,0,0] op_sel_hi:[0,1,1]
    v_pk_fma_f32 v[126:127], v[52:53], v[122:123], v[190:191] op_sel:[0,0,0] op_sel_hi:[0,1,1]
    v_pk_fma_f32 v[116:117], v[40:41], v[114:115], v[116:117] op_sel:[1,0,0] op_sel_hi:[1,1,1] neg_lo:[1,0,0] neg_hi:[1,0,0]
    v_pk_fma_f32 v[124:125], v[52:53], v[122:123], v[124:125] op_sel:[1,0,0] op_sel_hi:[1,1,1] neg_lo:[1,0,0] neg_hi:[1,0,0]
    v_pk_fma_f32 v[118:119], v[40:41], v[112:113], v[118:119] op_sel:[1,0,0] op_sel_hi:[1,1,1]
    v_pk_fma_f32 v[126:127], v[52:53], v[120:121], v[126:127] op_sel:[1,0,0] op_sel_hi:[1,1,1]
    v_pk_fma_f32 v[112:113], v[40:41], v[116:117], v[192:193] op_sel:[0,0,0] op_sel_hi:[0,1,1]
    v_pk_fma_f32 v[120:121], v[52:53], v[124:125], v[196:197] op_sel:[0,0,0] op_sel_hi:[0,1,1]
    v_pk_fma_f32 v[114:115], v[40:41], v[118:119], v[200:201] op_sel:[0,0,0] op_sel_hi:[0,1,1]
    v_pk_fma_f32 v[122:123], v[52:53], v[126:127], v[204:205] op_sel:[0,0,0] op_sel_hi:[0,1,1]
    v_pk_fma_f32 v[112:113], v[40:41], v[118:119], v[112:113] op_sel:[1,0,0] op_sel_hi:[1,1,1] neg_lo:[1,0,0] neg_hi:[1,0,0]
    v_pk_fma_f32 v[120:121], v[52:53], v[126:127], v[120:121] op_sel:[1,0,0] op_sel_hi:[1,1,1] neg_lo:[1,0,0] neg_hi:[1,0,0]
    v_pk_fma_f32 v[114:115], v[40:41], v[116:117], v[114:115] op_sel:[1,0,0] op_sel_hi:[1,1,1]
    v_pk_fma_f32 v[122:123], v[52:53], v[124:125], v[122:123] op_sel:[1,0,0] op_sel_hi:[1,1,1]
    v_pk_fma_f32 v[116:117], v[40:41], v[112:113], v[194:195] op_sel:[0,0,0] op_sel_hi:[0,1,1]
    v_pk_fma_f32 v[124:125], v[52:53], v[120:121], v[198:199] op_sel:[0,0,0] op_sel_hi:[0,1,1]
    v_pk_fma_f32 v[118:119], v[40:41], v[114:115], v[202:203] op_sel:[0,0,0] op_sel_hi:[0,1,1]
    v_pk_fma_f32 v[126:127], v[52:53], v[122:123], v[206:207] op_sel:[0,0,0] op_sel_hi:[0,1,1]
    v_pk_fma_f32 v[116:117], v[40:41], v[114:115], v[116:117] op_sel:[1,0,0] op_sel_hi:[1,1,1] neg_lo:[1,0,0] neg_hi:[1,0,0]
    v_pk_fma_f32 v[124:125], v[52:53], v[122:123], v[124:125] op_sel:[1,0,0] op_sel_hi:[1,1,1] neg_lo:[1,0,0] neg_hi:[1,0,0]
    v_pk_fma_f32 v[118:119], v[40:41], v[112:113], v[118:119] op_sel:[1,0,0] op_sel_hi:[1,1,1]
    v_pk_fma_f32 v[126:127], v[52:53], v[120:121], v[126:127] op_sel:[1,0,0] op_sel_hi:[1,1,1]
    v_pk_fma_f32 v[112:113], v[40:41], v[116:117], v[208:209] op_sel:[0,0,0] op_sel_hi:[0,1,1]
    v_pk_fma_f32 v[120:121], v[52:53], v[124:125], v[212:213] op_sel:[0,0,0] op_sel_hi:[0,1,1]
    v_pk_fma_f32 v[114:115], v[40:41], v[118:119], v[216:217] op_sel:[0,0,0] op_sel_hi:[0,1,1]
    v_pk_fma_f32 v[122:123], v[52:53], v[126:127], v[220:221] op_sel:[0,0,0] op_sel_hi:[0,1,1]
    v_pk_fma_f32 v[112:113], v[40:41], v[118:119], v[112:113] op_sel:[1,0,0] op_sel_hi:[1,1,1] neg_lo:[1,0,0] neg_hi:[1,0,0]
    v_pk_fma_f32 v[120:121], v[52:53], v[126:127], v[120:121] op_sel:[1,0,0] op_sel_hi:[1,1,1] neg_lo:[1,0,0] neg_hi:[1,0,0]
    v_pk_fma_f32 v[114:115], v[40:41], v[116:117], v[114:115] op_sel:[1,0,0] op_sel_hi:[1,1,1]
    v_pk_fma_f32 v[122:123], v[52:53], v[124:125], v[122:123] op_sel:[1,0,0] op_sel_hi:[1,1,1]
    v_pk_fma_f32 v[116:117], v[40:41], v[112:113], v[210:211] op_sel:[0,0,0] op_sel_hi:[0,1,1]
    v_pk_fma_f32 v[124:125], v[52:53], v[120:121], v[214:215] op_sel:[0,0,0] op_sel_hi:[0,1,1]
    v_pk_fma_f32 v[118:119], v[40:41], v[114:115], v[218:219] op_sel:[0,0,0] op_sel_hi:[0,1,1]
    v_pk_fma_f32 v[126:127], v[52:53], v[122:123], v[222:223] op_sel:[0,0,0] op_sel_hi:[0,1,1]
    v_pk_fma_f32 v[116:117], v[40:41], v[114:115], v[116:117] op_sel:[1,0,0] op_sel_hi:[1,1,1] neg_lo:[1,0,0] neg_hi:[1,0,0]
    v_pk_fma_f32 v[124:125], v[52:53], v[122:123], v[124:125] op_sel:[1,0,0] op_sel_hi:[1,1,1] neg_lo:[1,0,0] neg_hi:[1,0,0]
    v_pk_fma_f32 v[118:119], v[40:41], v[112:113], v[118:119] op_sel:[1,0,0] op_sel_hi:[1,1,1]
    v_pk_fma_f32 v[126:127], v[52:53], v[120:121], v[126:127] op_sel:[1,0,0] op_sel_hi:[1,1,1]
    v_pk_fma_f32 v[112:113], v[40:41], v[116:117], v[224:225] op_sel:[0,0,0] op_sel_hi:[0,1,1]
    v_pk_fma_f32 v[120:121], v[52:53], v[124:125], v[228:229] op_sel:[0,0,0] op_sel_hi:[0,1,1]
    v_pk_fma_f32 v[114:115], v[40:41], v[118:119], v[232:233] op_sel:[0,0,0] op_sel_hi:[0,1,1]
    v_pk_fma_f32 v[122:123], v[52:53], v[126:127], v[236:237] op_sel:[0,0,0] op_sel_hi:[0,1,1]
    v_pk_fma_f32 v[112:113], v[40:41], v[118:119], v[112:113] op_sel:[1,0,0] op_sel_hi:[1,1,1] neg_lo:[1,0,0] neg_hi:[1,0,0]
    v_pk_fma_f32 v[120:121], v[52:53], v[126:127], v[120:121] op_sel:[1,0,0] op_sel_hi:[1,1,1] neg_lo:[1,0,0] neg_hi:[1,0,0]
    v_pk_fma_f32 v[114:115], v[40:41], v[116:117], v[114:115] op_sel:[1,0,0] op_sel_hi:[1,1,1]
    v_pk_fma_f32 v[122:123], v[52:53], v[124:125], v[122:123] op_sel:[1,0,0] op_sel_hi:[1,1,1]
    v_pk_fma_f32 v[116:117], v[40:41], v[112:113], v[226:227] op_sel:[0,0,0] op_sel_hi:[0,1,1]
    v_pk_fma_f32 v[124:125], v[52:53], v[120:121], v[230:231] op_sel:[0,0,0] op_sel_hi:[0,1,1]
    v_pk_fma_f32 v[118:119], v[40:41], v[114:115], v[234:235] op_sel:[0,0,0] op_sel_hi:[0,1,1]
    v_pk_fma_f32 v[126:127], v[52:53], v[122:123], v[238:239] op_sel:[0,0,0] op_sel_hi:[0,1,1]
    v_pk_fma_f32 v[116:117], v[40:41], v[114:115], v[116:117] op_sel:[1,0,0] op_sel_hi:[1,1,1] neg_lo:[1,0,0] neg_hi:[1,0,0]
    v_pk_fma_f32 v[124:125], v[52:53], v[122:123], v[124:125] op_sel:[1,0,0] op_sel_hi:[1,1,1] neg_lo:[1,0,0] neg_hi:[1,0,0]
    v_pk_fma_f32 v[118:119], v[40:41], v[112:113], v[118:119] op_sel:[1,0,0] op_sel_hi:[1,1,1]
    v_pk_fma_f32 v[126:127], v[52:53], v[120:121], v[126:127] op_sel:[1,0,0] op_sel_hi:[1,1,1]
    v_pk_fma_f32 v[112:113], v[40:41], v[116:117], v[240:241] op_sel:[0,0,0] op_sel_hi:[0,1,1]
    v_pk_fma_f32 v[120:121], v[52:53], v[124:125], v[244:245] op_sel:[0,0,0] op_sel_hi:[0,1,1]
    v_pk_fma_f32 v[114:115], v[40:41], v[118:119], v[248:249] op_sel:[0,0,0] op_sel_hi:[0,1,1]
    v_pk_fma_f32 v[122:123], v[52:53], v[126:127], v[252:253] op_sel:[0,0,0] op_sel_hi:[0,1,1]
    v_pk_fma_f32 v[112:113], v[40:41], v[118:119], v[112:113] op_sel:[1,0,0] op_sel_hi:[1,1,1] neg_lo:[1,0,0] neg_hi:[1,0,0]
    v_pk_fma_f32 v[120:121], v[52:53], v[126:127], v[120:121] op_sel:[1,0,0] op_sel_hi:[1,1,1] neg_lo:[1,0,0] neg_hi:[1,0,0]
    v_pk_fma_f32 v[114:115], v[40:41], v[116:117], v[114:115] op_sel:[1,0,0] op_sel_hi:[1,1,1]
    v_pk_fma_f32 v[122:123], v[52:53], v[124:125], v[122:123] op_sel:[1,0,0] op_sel_hi:[1,1,1]
    v_pk_fma_f32 v[116:117], v[40:41], v[112:113], v[242:243] op_sel:[0,0,0] op_sel_hi:[0,1,1]
    v_pk_fma_f32 v[124:125], v[52:53], v[120:121], v[246:247] op_sel:[0,0,0] op_sel_hi:[0,1,1]
    v_pk_fma_f32 v[118:119], v[40:41], v[114:115], v[250:251] op_sel:[0,0,0] op_sel_hi:[0,1,1]
    v_pk_fma_f32 v[126:127], v[52:53], v[122:123], v[254:255] op_sel:[0,0,0] op_sel_hi:[0,1,1]
    v_pk_fma_f32 v[116:117], v[40:41], v[114:115], v[116:117] op_sel:[1,0,0] op_sel_hi:[1,1,1] neg_lo:[1,0,0] neg_hi:[1,0,0]
    v_pk_fma_f32 v[124:125], v[52:53], v[122:123], v[124:125] op_sel:[1,0,0] op_sel_hi:[1,1,1] neg_lo:[1,0,0] neg_hi:[1,0,0]
    v_pk_fma_f32 v[118:119], v[40:41], v[112:113], v[118:119] op_sel:[1,0,0] op_sel_hi:[1,1,1]
    v_pk_fma_f32 v[126:127], v[52:53], v[120:121], v[126:127] op_sel:[1,0,0] op_sel_hi:[1,1,1]
    v_fma_f32 v28, v44, v116, v117
    v_fma_f32 v29, v44, v118, v119
    v_fma_f32 v28, -v45, v118, v28
    v_fma_f32 v29, v45, v116, v29
    v_fma_f32 v30, v56, v124, v125
    v_fma_f32 v31, v56, v126, v127
    v_fma_f32 v30, -v57, v126, v30
    v_fma_f32 v31, v57, v124, v31
    v_mul_u32_u24 v5, 80, v9
    s_lshl_b32 s22, s20, 5
    s_add_u32 s22, s22, 147456
    v_lshl_add_u32 v6, v4, 3, v5
    v_add_u32 v6, s22, v6
    ds_write_b64 v6, v[28:29]
    ds_write_b64 v6, v[30:31] offset:1280
    s_mov_b32 s98, 0
LC_nn:
    s_add_u32 s98, s98, 1
    s_cmp_gt_u32 s98, 262144
    s_cbranch_scc1 L_end
    s_waitcnt vmcnt(0)
    v_cmp_eq_u32 vcc, 0, v15
    s_nop 4
    s_cbranch_vccz LC_nn2
    s_sleep 2
    global_load_dword v15, v14, s[32:33] sc1
    s_branch LC_nn
LC_nn2:
    v_mov_b32 v7, 152576
    ds_write_b32 v7, v15
    s_waitcnt lgkmcnt(0)
    s_barrier
    v_add_u32 v5, 147456, v5
    ds_read_b128 v[64:67], v5 offset:0
    ds_read_b128 v[68:71], v5 offset:16
    ds_read_b128 v[72:75], v5 offset:32
    ds_read_b128 v[76:79], v5 offset:48
    ds_read_b128 v[80:83], v5 offset:1280
    ds_read_b128 v[84:87], v5 offset:1296
    ds_read_b128 v[88:91], v5 offset:1312
    ds_read_b128 v[92:95], v5 offset:1328
    s_waitcnt lgkmcnt(0)
    v_pk_fma_f32 v[98:99], v[46:47], v[64:65], v[66:67] op_sel:[0,0,0] op_sel_hi:[0,1,1]
    v_pk_fma_f32 v[98:99], v[46:47], v[64:65], v[98:99] op_sel:[1,1,0] op_sel_hi:[1,0,1] neg_lo:[1,0,0]
    v_pk_fma_f32 v[102:103], v[58:59], v[80:81], v[82:83] op_sel:[0,0,0] op_sel_hi:[0,1,1]
    v_pk_fma_f32 v[102:103], v[58:59], v[80:81], v[102:103] op_sel:[1,1,0] op_sel_hi:[1,0,1] neg_lo:[1,0,0]
    v_pk_fma_f32 v[96:97], v[46:47], v[98:99], v[68:69] op_sel:[0,0,0] op_sel_hi:[0,1,1]
    v_pk_fma_f32 v[96:97], v[46:47], v[98:99], v[96:97] op_sel:[1,1,0] op_sel_hi:[1,0,1] neg_lo:[1,0,0]
    v_pk_fma_f32 v[100:101], v[58:59], v[102:103], v[84:85] op_sel:[0,0,0] op_sel_hi:[0,1,1]
    v_pk_fma_f32 v[100:101], v[58:59], v[102:103], v[100:101] op_sel:[1,1,0] op_sel_hi:[1,0,1] neg_lo:[1,0,0]
    v_pk_fma_f32 v[98:99], v[46:47], v[96:97], v[70:71] op_sel:[0,0,0] op_sel_hi:[0,1,1]
    v_pk_fma_f32 v[98:99], v[46:47], v[96:97], v[98:99] op_sel:[1,1,0] op_sel_hi:[1,0,1] neg_lo:[1,0,0]
    v_pk_fma_f32 v[102:103], v[58:59], v[100:101], v[86:87] op_sel:[0,0,0] op_sel_hi:[0,1,1]
    v_pk_fma_f32 v[102:103], v[58:59], v[100:101], v[102:103] op_sel:[1,1,0] op_sel_hi:[1,0,1] neg_lo:[1,0,0]
    v_pk_fma_f32 v[96:97], v[46:47], v[98:99], v[72:73] op_sel:[0,0,0] op_sel_hi:[0,1,1]
    v_pk_fma_f32 v[96:97], v[46:47], v[98:99], v[96:97] op_sel:[1,1,0] op_sel_hi:[1,0,1] neg_lo:[1,0,0]
    v_pk_fma_f32 v[100:101], v[58:59], v[102:103], v[88:89] op_sel:[0,0,0] op_sel_hi:[0,1,1]
    v_pk_fma_f32 v[100:101], v[58:59], v[102:103], v[100:101] op_sel:[1,1,0] op_sel_hi:[1,0,1] neg_lo:[1,0,0]
    v_pk_fma_f32 v[98:99], v[46:47], v[96:97], v[74:75] op_sel:[0,0,0] op_sel_hi:[0,1,1]
    v_pk_fma_f32 v[98:99], v[46:47], v[96:97], v[98:99] op_sel:[1,1,0] op_sel_hi:[1,0,1] neg_lo:[1,0,0]
    v_pk_fma_f32 v[102:103], v[58:59], v[100:101], v[90:91] op_sel:[0,0,0] op_sel_hi:[0,1,1]
    v_pk_fma_f32 v[102:103], v[58:59], v[100:101], v[102:103] op_sel:[1,1,0] op_sel_hi:[1,0,1] neg_lo:[1,0,0]
    v_pk_fma_f32 v[96:97], v[46:47], v[98:99], v[76:77] op_sel:[0,0,0] op_sel_hi:[0,1,1]
    v_pk_fma_f32 v[96:97], v[46:47], v[98:99], v[96:97] op_sel:[1,1,0] op_sel_hi:[1,0,1] neg_lo:[1,0,0]
    v_pk_fma_f32 v[100:101], v[58:59], v[102:103], v[92:93] op_sel:[0,0,0] op_sel_hi:[0,1,1]
    v_pk_fma_f32 v[100:101], v[58:59], v[102:103], v[100:101] op_sel:[1,1,0] op_sel_hi:[1,0,1] neg_lo:[1,0,0]
    v_pk_fma_f32 v[98:99], v[46:47], v[96:97], v[78:79] op_sel:[0,0,0] op_sel_hi:[0,1,1]
    v_pk_fma_f32 v[98:99], v[46:47], v[96:97], v[98:99] op_sel:[1,1,0] op_sel_hi:[1,0,1] neg_lo:[1,0,0]
    v_pk_fma_f32 v[102:103], v[58:59], v[100:101], v[94:95] op_sel:[0,0,0] op_sel_hi:[0,1,1]
    v_pk_fma_f32 v[102:103], v[58:59], v[100:101], v[102:103] op_sel:[1,1,0] op_sel_hi:[1,0,1] neg_lo:[1,0,0]
    v_and_b32 v7, 1, v4
    v_cmp_ne_u32 vcc, 0, v7
    s_nop 1
    v_cndmask_b32 v104, v98, v102, vcc
    v_cndmask_b32 v106, v99, v103, vcc
    v_cndmask_b32 v32, v48, v60, vcc
    v_cndmask_b32 v33, v49, v61, vcc
    v_mov_b32 v105, v15
    v_mov_b32 v107, v15
    s_lshl_b32 s22, s14, 3
    s_add_u32 s22, s22, s13
    s_lshl_b32 s22, s22, 10
    s_add_u32 s22, s22, 17891328
    v_and_b32 v11, 31, v2
    s_lshl_b32 s23, s21, 5
    v_add_u32 v11, s23, v11
    v_lshlrev_b32 v11, 4, v11
    s_cmp_lg_u32 s20, 0
    s_cbranch_scc1 LC_nopub
    s_mov_b64 s[56:57], exec
    s_mov_b32 exec_hi, 0
    buffer_store_dwordx4 v[104:107], v11, s[44:47], s22 offen sc1
    s_mov_b64 exec, s[56:57]
LC_nopub:
    s_lshl_b32 s23, s14, 13
    s_add_u32 s23, s23, 17891328
    v_pk_mul_f32 v[120:121], v[42:43], v[128:129] op_sel:[0,0] op_sel_hi:[0,1]
    v_pk_mul_f32 v[122:123], v[54:55], v[132:133] op_sel:[0,0] op_sel_hi:[0,1]
    v_pk_mul_f32 v[128:129], v[42:43], v[128:129] op_sel:[1,0] op_sel_hi:[1,1]
    v_pk_mul_f32 v[132:133], v[54:55], v[132:133] op_sel:[1,0] op_sel_hi:[1,1]
    v_pk_fma_f32 v[128:129], v[42:43], v[136:137], v[128:129] op_sel:[0,0,0] op_sel_hi:[0,1,1]
    v_pk_fma_f32 v[132:133], v[54:55], v[140:141], v[132:133] op_sel:[0,0,0] op_sel_hi:[0,1,1]
    v_pk_fma_f32 v[136:137], v[42:43], v[136:137], v[120:121] op_sel:[1,0,0] op_sel_hi:[1,1,1] neg_lo:[1,0,0] neg_hi:[1,0,0]
    v_pk_fma_f32 v[140:141], v[54:55], v[140:141], v[122:123] op_sel:[1,0,0] op_sel_hi:[1,1,1] neg_lo:[1,0,0] neg_hi:[1,0,0]
    v_pk_mul_f32 v[120:121], v[42:43], v[130:131] op_sel:[0,0] op_sel_hi:[0,1]
    v_pk_mul_f32 v[122:123], v[54:55], v[134:135] op_sel:[0,0] op_sel_hi:[0,1]
    v_pk_mul_f32 v[130:131], v[42:43], v[130:131] op_sel:[1,0] op_sel_hi:[1,1]
    v_pk_mul_f32 v[134:135], v[54:55], v[134:135] op_sel:[1,0] op_sel_hi:[1,1]
    v_pk_fma_f32 v[130:131], v[42:43], v[138:139], v[130:131] op_sel:[0,0,0] op_sel_hi:[0,1,1]
    v_pk_fma_f32 v[134:135], v[54:55], v[142:143], v[134:135] op_sel:[0,0,0] op_sel_hi:[0,1,1]
    v_pk_fma_f32 v[138:139], v[42:43], v[138:139], v[120:121] op_sel:[1,0,0] op_sel_hi:[1,1,1] neg_lo:[1,0,0] neg_hi:[1,0,0]
    v_pk_fma_f32 v[142:143], v[54:55], v[142:143], v[122:123] op_sel:[1,0,0] op_sel_hi:[1,1,1] neg_lo:[1,0,0] neg_hi:[1,0,0]
    v_pk_mul_f32 v[120:121], v[42:43], v[144:145] op_sel:[0,0] op_sel_hi:[0,1]
    v_pk_mul_f32 v[122:123], v[54:55], v[148:149] op_sel:[0,0] op_sel_hi:[0,1]
    v_pk_mul_f32 v[144:145], v[42:43], v[144:145] op_sel:[1,0] op_sel_hi:[1,1]
    v_pk_mul_f32 v[148:149], v[54:55], v[148:149] op_sel:[1,0] op_sel_hi:[1,1]
    v_pk_fma_f32 v[144:145], v[42:43], v[152:153], v[144:145] op_sel:[0,0,0] op_sel_hi:[0,1,1]
    v_pk_fma_f32 v[148:149], v[54:55], v[156:157], v[148:149] op_sel:[0,0,0] op_sel_hi:[0,1,1]
    v_pk_fma_f32 v[152:153], v[42:43], v[152:153], v[120:121] op_sel:[1,0,0] op_sel_hi:[1,1,1] neg_lo:[1,0,0] neg_hi:[1,0,0]
    v_pk_fma_f32 v[156:157], v[54:55], v[156:157], v[122:123] op_sel:[1,0,0] op_sel_hi:[1,1,1] neg_lo:[1,0,0] neg_hi:[1,0,0]
    v_pk_mul_f32 v[120:121], v[42:43], v[146:147] op_sel:[0,0] op_sel_hi:[0,1]
    v_pk_mul_f32 v[122:123], v[54:55], v[150:151] op_sel:[0,0] op_sel_hi:[0,1]
    v_pk_mul_f32 v[146:147], v[42:43], v[146:147] op_sel:[1,0] op_sel_hi:[1,1]
    v_pk_mul_f32 v[150:151], v[54:55], v[150:151] op_sel:[1,0] op_sel_hi:[1,1]
    v_pk_fma_f32 v[146:147], v[42:43], v[154:155], v[146:147] op_sel:[0,0,0] op_sel_hi:[0,1,1]
    v_pk_fma_f32 v[150:151], v[54:55], v[158:159], v[150:151] op_sel:[0,0,0] op_sel_hi:[0,1,1]
    v_pk_fma_f32 v[154:155], v[42:43], v[154:155], v[120:121] op_sel:[1,0,0] op_sel_hi:[1,1,1] neg_lo:[1,0,0] neg_hi:[1,0,0]
    v_pk_fma_f32 v[158:159], v[54:55], v[158:159], v[122:123] op_sel:[1,0,0] op_sel_hi:[1,1,1] neg_lo:[1,0,0] neg_hi:[1,0,0]
    v_pk_mul_f32 v[120:121], v[42:43], v[160:161] op_sel:[0,0] op_sel_hi:[0,1]
    v_pk_mul_f32 v[122:123], v[54:55], v[164:165] op_sel:[0,0] op_sel_hi:[0,1]
    v_pk_mul_f32 v[160:161], v[42:43], v[160:161] op_sel:[1,0] op_sel_hi:[1,1]
    v_pk_mul_f32 v[164:165], v[54:55], v[164:165] op_sel:[1,0] op_sel_hi:[1,1]
    v_pk_fma_f32 v[160:161], v[42:43], v[168:169], v[160:161] op_sel:[0,0,0] op_sel_hi:[0,1,1]
    v_pk_fma_f32 v[164:165], v[54:55], v[172:173], v[164:165] op_sel:[0,0,0] op_sel_hi:[0,1,1]
    v_pk_fma_f32 v[168:169], v[42:43], v[168:169], v[120:121] op_sel:[1,0,0] op_sel_hi:[1,1,1] neg_lo:[1,0,0] neg_hi:[1,0,0]
    v_pk_fma_f32 v[172:173], v[54:55], v[172:173], v[122:123] op_sel:[1,0,0] op_sel_hi:[1,1,1] neg_lo:[1,0,0] neg_hi:[1,0,0]
    v_pk_mul_f32 v[120:121], v[42:43], v[162:163] op_sel:[0,0] op_sel_hi:[0,1]
    v_pk_mul_f32 v[122:123], v[54:55], v[166:167] op_sel:[0,0] op_sel_hi:[0,1]
    v_pk_mul_f32 v[162:163], v[42:43], v[162:163] op_sel:[1,0] op_sel_hi:[1,1]
    v_pk_mul_f32 v[166:167], v[54:55], v[166:167] op_sel:[1,0] op_sel_hi:[1,1]
    v_pk_fma_f32 v[162:163], v[42:43], v[170:171], v[162:163] op_sel:[0,0,0] op_sel_hi:[0,1,1]
    v_pk_fma_f32 v[166:167], v[54:55], v[174:175], v[166:167] op_sel:[0,0,0] op_sel_hi:[0,1,1]
    v_pk_fma_f32 v[170:171], v[42:43], v[170:171], v[120:121] op_sel:[1,0,0] op_sel_hi:[1,1,1] neg_lo:[1,0,0] neg_hi:[1,0,0]
    v_pk_fma_f32 v[174:175], v[54:55], v[174:175], v[122:123] op_sel:[1,0,0] op_sel_hi:[1,1,1] neg_lo:[1,0,0] neg_hi:[1,0,0]
    v_pk_mul_f32 v[120:121], v[42:43], v[176:177] op_sel:[0,0] op_sel_hi:[0,1]
    v_pk_mul_f32 v[122:123], v[54:55], v[180:181] op_sel:[0,0] op_sel_hi:[0,1]
    v_pk_mul_f32 v[176:177], v[42:43], v[176:177] op_sel:[1,0] op_sel_hi:[1,1]
    v_pk_mul_f32 v[180:181], v[54:55], v[180:181] op_sel:[1,0] op_sel_hi:[1,1]
    v_pk_fma_f32 v[176:177], v[42:43], v[184:185], v[176:177] op_sel:[0,0,0] op_sel_hi:[0,1,1]
    v_pk_fma_f32 v[180:181], v[54:55], v[188:189], v[180:181] op_sel:[0,0,0] op_sel_hi:[0,1,1]
    v_pk_fma_f32 v[184:185], v[42:43], v[184:185], v[120:121] op_sel:[1,0,0] op_sel_hi:[1,1,1] neg_lo:[1,0,0] neg_hi:[1,0,0]
    v_pk_fma_f32 v[188:189], v[54:55], v[188:189], v[122:123] op_sel:[1,0,0] op_sel_hi:[1,1,1] neg_lo:[1,0,0] neg_hi:[1,0,0]
    v_pk_mul_f32 v[120:121], v[42:43], v[178:179] op_sel:[0,0] op_sel_hi:[0,1]
    v_pk_mul_f32 v[122:123], v[54:55], v[182:183] op_sel:[0,0] op_sel_hi:[0,1]
    v_pk_mul_f32 v[178:179], v[42:43], v[178:179] op_sel:[1,0] op_sel_hi:[1,1]
    v_pk_mul_f32 v[182:183], v[54:55], v[182:183] op_sel:[1,0] op_sel_hi:[1,1]
    v_pk_fma_f32 v[178:179], v[42:43], v[186:187], v[178:179] op_sel:[0,0,0] op_sel_hi:[0,1,1]
    v_pk_fma_f32 v[182:183], v[54:55], v[190:191], v[182:183] op_sel:[0,0,0] op_sel_hi:[0,1,1]
    v_pk_fma_f32 v[186:187], v[42:43], v[186:187], v[120:121] op_sel:[1,0,0] op_sel_hi:[1,1,1] neg_lo:[1,0,0] neg_hi:[1,0,0]
    v_pk_fma_f32 v[190:191], v[54:55], v[190:191], v[122:123] op_sel:[1,0,0] op_sel_hi:[1,1,1] neg_lo:[1,0,0] neg_hi:[1,0,0]
    v_pk_mul_f32 v[120:121], v[42:43], v[192:193] op_sel:[0,0] op_sel_hi:[0,1]
    v_pk_mul_f32 v[122:123], v[54:55], v[196:197] op_sel:[0,0] op_sel_hi:[0,1]
    v_pk_mul_f32 v[192:193], v[42:43], v[192:193] op_sel:[1,0] op_sel_hi:[1,1]
    v_pk_mul_f32 v[196:197], v[54:55], v[196:197] op_sel:[1,0] op_sel_hi:[1,1]
    v_pk_fma_f32 v[192:193], v[42:43], v[200:201], v[192:193] op_sel:[0,0,0] op_sel_hi:[0,1,1]
    v_pk_fma_f32 v[196:197], v[54:55], v[204:205], v[196:197] op_sel:[0,0,0] op_sel_hi:[0,1,1]
    v_pk_fma_f32 v[200:201], v[42:43], v[200:201], v[120:121] op_sel:[1,0,0] op_sel_hi:[1,1,1] neg_lo:[1,0,0] neg_hi:[1,0,0]
    v_pk_fma_f32 v[204:205], v[54:55], v[204:205], v[122:123] op_sel:[1,0,0] op_sel_hi:[1,1,1] neg_lo:[1,0,0] neg_hi:[1,0,0]
    v_pk_mul_f32 v[120:121], v[42:43], v[194:195] op_sel:[0,0] op_sel_hi:[0,1]
    v_pk_mul_f32 v[122:123], v[54:55], v[198:199] op_sel:[0,0] op_sel_hi:[0,1]
    v_pk_mul_f32 v[194:195], v[42:43], v[194:195] op_sel:[1,0] op_sel_hi:[1,1]
    v_pk_mul_f32 v[198:199], v[54:55], v[198:199] op_sel:[1,0] op_sel_hi:[1,1]
    v_pk_fma_f32 v[194:195], v[42:43], v[202:203], v[194:195] op_sel:[0,0,0] op_sel_hi:[0,1,1]
    v_pk_fma_f32 v[198:199], v[54:55], v[206:207], v[198:199] op_sel:[0,0,0] op_sel_hi:[0,1,1]
    v_pk_fma_f32 v[202:203], v[42:43], v[202:203], v[120:121] op_sel:[1,0,0] op_sel_hi:[1,1,1] neg_lo:[1,0,0] neg_hi:[1,0,0]
    v_pk_fma_f32 v[206:207], v[54:55], v[206:207], v[122:123] op_sel:[1,0,0] op_sel_hi:[1,1,1] neg_lo:[1,0,0] neg_hi:[1,0,0]
    v_pk_mul_f32 v[120:121], v[42:43], v[208:209] op_sel:[0,0] op_sel_hi:[0,1]
    v_pk_mul_f32 v[122:123], v[54:55], v[212:213] op_sel:[0,0] op_sel_hi:[0,1]
    v_pk_mul_f32 v[208:209], v[42:43], v[208:209] op_sel:[1,0] op_sel_hi:[1,1]
    v_pk_mul_f32 v[212:213], v[54:55], v[212:213] op_sel:[1,0] op_sel_hi:[1,1]
    v_pk_fma_f32 v[208:209], v[42:43], v[216:217], v[208:209] op_sel:[0,0,0] op_sel_hi:[0,1,1]
    v_pk_fma_f32 v[212:213], v[54:55], v[220:221], v[212:213] op_sel:[0,0,0] op_sel_hi:[0,1,1]
    v_pk_fma_f32 v[216:217], v[42:43], v[216:217], v[120:121] op_sel:[1,0,0] op_sel_hi:[1,1,1] neg_lo:[1,0,0] neg_hi:[1,0,0]
    v_pk_fma_f32 v[220:221], v[54:55], v[220:221], v[122:123] op_sel:[1,0,0] op_sel_hi:[1,1,1] neg_lo:[1,0,0] neg_hi:[1,0,0]
    v_pk_mul_f32 v[120:121], v[42:43], v[210:211] op_sel:[0,0] op_sel_hi:[0,1]
    v_pk_mul_f32 v[122:123], v[54:55], v[214:215] op_sel:[0,0] op_sel_hi:[0,1]
    v_pk_mul_f32 v[210:211], v[42:43], v[210:211] op_sel:[1,0] op_sel_hi:[1,1]
    v_pk_mul_f32 v[214:215], v[54:55], v[214:215] op_sel:[1,0] op_sel_hi:[1,1]
    v_pk_fma_f32 v[210:211], v[42:43], v[218:219], v[210:211] op_sel:[0,0,0] op_sel_hi:[0,1,1]
    v_pk_fma_f32 v[214:215], v[54:55], v[222:223], v[214:215] op_sel:[0,0,0] op_sel_hi:[0,1,1]
    v_pk_fma_f32 v[218:219], v[42:43], v[218:219], v[120:121] op_sel:[1,0,0] op_sel_hi:[1,1,1] neg_lo:[1,0,0] neg_hi:[1,0,0]
    v_pk_fma_f32 v[222:223], v[54:55], v[222:223], v[122:123] op_sel:[1,0,0] op_sel_hi:[1,1,1] neg_lo:[1,0,0] neg_hi:[1,0,0]
    s_cmp_le_u32 s13, 0
    s_cbranch_scc1 LC_pla
    s_add_u32 s24, s23, 0
    buffer_load_dwordx4 v[16:19], v11, s[44:47], s24 offen sc1
    s_cmp_le_u32 s13, 1
    s_cbranch_scc1 LC_pla
    s_add_u32 s24, s23, 1024
    buffer_load_dwordx4 v[20:23], v11, s[44:47], s24 offen sc1
    s_cmp_le_u32 s13, 2
    s_cbranch_scc1 LC_pla
    s_add_u32 s24, s23, 2048
    buffer_load_dwordx4 v[24:27], v11, s[44:47], s24 offen sc1
    s_cmp_le_u32 s13, 3
    s_cbranch_scc1 LC_pla
    s_add_u32 s24, s23, 3072
    buffer_load_dwordx4 v[28:31], v11, s[44:47], s24 offen sc1
    s_cmp_le_u32 s13, 4
    s_cbranch_scc1 LC_pla
    s_add_u32 s24, s23, 4096
    buffer_load_dwordx4 v[36:39], v11, s[44:47], s24 offen sc1
    s_cmp_le_u32 s13, 5
    s_cbranch_scc1 LC_pla
    s_add_u32 s24, s23, 5120
    buffer_load_dwordx4 v[108:111], v11, s[44:47], s24 offen sc1
    s_cmp_le_u32 s13, 6
    s_cbranch_scc1 LC_pla
    s_add_u32 s24, s23, 6144
    buffer_load_dwordx4 v[112:115], v11, s[44:47], s24 offen sc1
LC_pla:
    v_pk_mul_f32 v[120:121], v[42:43], v[224:225] op_sel:[0,0] op_sel_hi:[0,1]
    v_pk_mul_f32 v[122:123], v[54:55], v[228:229] op_sel:[0,0] op_sel_hi:[0,1]
    v_pk_mul_f32 v[224:225], v[42:43], v[224:225] op_sel:[1,0] op_sel_hi:[1,1]
    v_pk_mul_f32 v[228:229], v[54:55], v[228:229] op_sel:[1,0] op_sel_hi:[1,1]
    v_pk_fma_f32 v[224:225], v[42:43], v[232:233], v[224:225] op_sel:[0,0,0] op_sel_hi:[0,1,1]
    v_pk_fma_f32 v[228:229], v[54:55], v[236:237], v[228:229] op_sel:[0,0,0] op_sel_hi:[0,1,1]
    v_pk_fma_f32 v[232:233], v[42:43], v[232:233], v[120:121] op_sel:[1,0,0] op_sel_hi:[1,1,1] neg_lo:[1,0,0] neg_hi:[1,0,0]
    v_pk_fma_f32 v[236:237], v[54:55], v[236:237], v[122:123] op_sel:[1,0,0] op_sel_hi:[1,1,1] neg_lo:[1,0,0] neg_hi:[1,0,0]
    v_pk_mul_f32 v[120:121], v[42:43], v[226:227] op_sel:[0,0] op_sel_hi:[0,1]
    v_pk_mul_f32 v[122:123], v[54:55], v[230:231] op_sel:[0,0] op_sel_hi:[0,1]
    v_pk_mul_f32 v[226:227], v[42:43], v[226:227] op_sel:[1,0] op_sel_hi:[1,1]
    v_pk_mul_f32 v[230:231], v[54:55], v[230:231] op_sel:[1,0] op_sel_hi:[1,1]
    v_pk_fma_f32 v[226:227], v[42:43], v[234:235], v[226:227] op_sel:[0,0,0] op_sel_hi:[0,1,1]
    v_pk_fma_f32 v[230:231], v[54:55], v[238:239], v[230:231] op_sel:[0,0,0] op_sel_hi:[0,1,1]
    v_pk_fma_f32 v[234:235], v[42:43], v[234:235], v[120:121] op_sel:[1,0,0] op_sel_hi:[1,1,1] neg_lo:[1,0,0] neg_hi:[1,0,0]
    v_pk_fma_f32 v[238:239], v[54:55], v[238:239], v[122:123] op_sel:[1,0,0] op_sel_hi:[1,1,1] neg_lo:[1,0,0] neg_hi:[1,0,0]
    v_pk_mul_f32 v[120:121], v[42:43], v[240:241] op_sel:[0,0] op_sel_hi:[0,1]
    v_pk_mul_f32 v[122:123], v[54:55], v[244:245] op_sel:[0,0] op_sel_hi:[0,1]
    v_pk_mul_f32 v[240:241], v[42:43], v[240:241] op_sel:[1,0] op_sel_hi:[1,1]
    v_pk_mul_f32 v[244:245], v[54:55], v[244:245] op_sel:[1,0] op_sel_hi:[1,1]
    v_pk_fma_f32 v[240:241], v[42:43], v[248:249], v[240:241] op_sel:[0,0,0] op_sel_hi:[0,1,1]
    v_pk_fma_f32 v[244:245], v[54:55], v[252:253], v[244:245] op_sel:[0,0,0] op_sel_hi:[0,1,1]
    v_pk_fma_f32 v[248:249], v[42:43], v[248:249], v[120:121] op_sel:[1,0,0] op_sel_hi:[1,1,1] neg_lo:[1,0,0] neg_hi:[1,0,0]
    v_pk_fma_f32 v[252:253], v[54:55], v[252:253], v[122:123] op_sel:[1,0,0] op_sel_hi:[1,1,1] neg_lo:[1,0,0] neg_hi:[1,0,0]
    v_pk_mul_f32 v[120:121], v[42:43], v[242:243] op_sel:[0,0] op_sel_hi:[0,1]
    v_pk_mul_f32 v[122:123], v[54:55], v[246:247] op_sel:[0,0] op_sel_hi:[0,1]
    v_pk_mul_f32 v[242:243], v[42:43], v[242:243] op_sel:[1,0] op_sel_hi:[1,1]
    v_pk_mul_f32 v[246:247], v[54:55], v[246:247] op_sel:[1,0] op_sel_hi:[1,1]
    v_pk_fma_f32 v[242:243], v[42:43], v[250:251], v[242:243] op_sel:[0,0,0] op_sel_hi:[0,1,1]
    v_pk_fma_f32 v[246:247], v[54:55], v[254:255], v[246:247] op_sel:[0,0,0] op_sel_hi:[0,1,1]
    v_pk_fma_f32 v[250:251], v[42:43], v[250:251], v[120:121] op_sel:[1,0,0] op_sel_hi:[1,1,1] neg_lo:[1,0,0] neg_hi:[1,0,0]
    v_pk_fma_f32 v[254:255], v[54:55], v[254:255], v[122:123] op_sel:[1,0,0] op_sel_hi:[1,1,1] neg_lo:[1,0,0] neg_hi:[1,0,0]
    s_mov_b32 s60, 0xffff
    s_mov_b32 s61, 0x0
    s_mov_b32 s62, 0xffff0000
    s_mov_b32 s63, 0x0
    s_mov_b32 s64, 0x0
    s_mov_b32 s65, 0xffff
    s_mov_b32 s66, 0x0
    s_mov_b32 s67, 0xffff0000
    s_cmp_eq_u32 s20, 0
    s_cbranch_scc0 LC_p0w1
    v_mov_b32 v104, 0
    v_mov_b32 v105, 0
    v_mov_b32 v120, 1.0
    v_mov_b32 v121, 0
    v_mov_b32 v106, 0
    v_mov_b32 v107, 0
    v_mov_b32 v122, 1.0
    v_mov_b32 v123, 0
    v_cndmask_b32 v104, v104, v64, s[62:63]
    v_cndmask_b32 v105, v105, v65, s[62:63]
    v_cndmask_b32 v120, v120, v46, s[62:63]
    v_cndmask_b32 v121, v121, v47, s[62:63]
    v_cndmask_b32 v106, v106, v80, s[62:63]
    v_cndmask_b32 v107, v107, v81, s[62:63]
    v_cndmask_b32 v122, v122, v58, s[62:63]
    v_cndmask_b32 v123, v123, v59, s[62:63]
    v_pk_fma_f32 v[98:99], v[46:47], v[64:65], v[66:67] op_sel:[0,0,0] op_sel_hi:[0,1,1]
    v_pk_fma_f32 v[98:99], v[46:47], v[64:65], v[98:99] op_sel:[1,1,0] op_sel_hi:[1,0,1] neg_lo:[1,0,0]
    v_pk_mul_f32 v[12:13], v[46:47], v[46:47] op_sel:[0,0] op_sel_hi:[0,1]
    v_pk_fma_f32 v[12:13], v[46:47], v[46:47], v[12:13] op_sel:[1,1,0] op_sel_hi:[1,0,1] neg_lo:[1,0,0]
    v_pk_fma_f32 v[102:103], v[58:59], v[80:81], v[82:83] op_sel:[0,0,0] op_sel_hi:[0,1,1]
    v_pk_fma_f32 v[102:103], v[58:59], v[80:81], v[102:103] op_sel:[1,1,0] op_sel_hi:[1,0,1] neg_lo:[1,0,0]
    v_pk_mul_f32 v[50:51], v[58:59], v[58:59] op_sel:[0,0] op_sel_hi:[0,1]
    v_pk_fma_f32 v[50:51], v[58:59], v[58:59], v[50:51] op_sel:[1,1,0] op_sel_hi:[1,0,1] neg_lo:[1,0,0]
    v_cndmask_b32 v104, v104, v98, s[64:65]
    v_cndmask_b32 v105, v105, v99, s[64:65]
    v_cndmask_b32 v120, v120, v12, s[64:65]
    v_cndmask_b32 v121, v121, v13, s[64:65]
    v_cndmask_b32 v106, v106, v102, s[64:65]
    v_cndmask_b32 v107, v107, v103, s[64:65]
    v_cndmask_b32 v122, v122, v50, s[64:65]
    v_cndmask_b32 v123, v123, v51, s[64:65]
    v_pk_fma_f32 v[96:97], v[46:47], v[98:99], v[68:69] op_sel:[0,0,0] op_sel_hi:[0,1,1]
    v_pk_fma_f32 v[96:97], v[46:47], v[98:99], v[96:97] op_sel:[1,1,0] op_sel_hi:[1,0,1] neg_lo:[1,0,0]
    v_pk_mul_f32 v[6:7], v[46:47], v[12:13] op_sel:[0,0] op_sel_hi:[0,1]
    v_pk_fma_f32 v[6:7], v[46:47], v[12:13], v[6:7] op_sel:[1,1,0] op_sel_hi:[1,0,1] neg_lo:[1,0,0]
    v_pk_fma_f32 v[100:101], v[58:59], v[102:103], v[84:85] op_sel:[0,0,0] op_sel_hi:[0,1,1]
    v_pk_fma_f32 v[100:101], v[58:59], v[102:103], v[100:101] op_sel:[1,1,0] op_sel_hi:[1,0,1] neg_lo:[1,0,0]
    v_pk_mul_f32 v[34:35], v[58:59], v[50:51] op_sel:[0,0] op_sel_hi:[0,1]
    v_pk_fma_f32 v[34:35], v[58:59], v[50:51], v[34:35] op_sel:[1,1,0] op_sel_hi:[1,0,1] neg_lo:[1,0,0]
    v_cndmask_b32 v104, v104, v96, s[66:67]
    v_cndmask_b32 v105, v105, v97, s[66:67]
    v_cndmask_b32 v120, v120, v6, s[66:67]
    v_cndmask_b32 v121, v121, v7, s[66:67]
    v_cndmask_b32 v106, v106, v100, s[66:67]
    v_cndmask_b32 v107, v107, v101, s[66:67]
    v_cndmask_b32 v122, v122, v34, s[66:67]
    v_cndmask_b32 v123, v123, v35, s[66:67]
    s_branch LC_p0j
LC_p0w1:
    v_pk_fma_f32 v[98:99], v[46:47], v[64:65], v[66:67] op_sel:[0,0,0] op_sel_hi:[0,1,1]
    v_pk_fma_f32 v[98:99], v[46:47], v[64:65], v[98:99] op_sel:[1,1,0] op_sel_hi:[1,0,1] neg_lo:[1,0,0]
    v_pk_mul_f32 v[12:13], v[46:47], v[46:47] op_sel:[0,0] op_sel_hi:[0,1]
    v_pk_fma_f32 v[12:13], v[46:47], v[46:47], v[12:13] op_sel:[1,1,0] op_sel_hi:[1,0,1] neg_lo:[1,0,0]
    v_pk_fma_f32 v[102:103], v[58:59], v[80:81], v[82:83] op_sel:[0,0,0] op_sel_hi:[0,1,1]
    v_pk_fma_f32 v[102:103], v[58:59], v[80:81], v[102:103] op_sel:[1,1,0] op_sel_hi:[1,0,1] neg_lo:[1,0,0]
    v_pk_mul_f32 v[50:51], v[58:59], v[58:59] op_sel:[0,0] op_sel_hi:[0,1]
    v_pk_fma_f32 v[50:51], v[58:59], v[58:59], v[50:51] op_sel:[1,1,0] op_sel_hi:[1,0,1] neg_lo:[1,0,0]
    v_pk_fma_f32 v[96:97], v[46:47], v[98:99], v[68:69] op_sel:[0,0,0] op_sel_hi:[0,1,1]
    v_pk_fma_f32 v[96:97], v[46:47], v[98:99], v[96:97] op_sel:[1,1,0] op_sel_hi:[1,0,1] neg_lo:[1,0,0]
    v_pk_mul_f32 v[6:7], v[46:47], v[12:13] op_sel:[0,0] op_sel_hi:[0,1]
    v_pk_fma_f32 v[6:7], v[46:47], v[12:13], v[6:7] op_sel:[1,1,0] op_sel_hi:[1,0,1] neg_lo:[1,0,0]
    v_pk_fma_f32 v[100:101], v[58:59], v[102:103], v[84:85] op_sel:[0,0,0] op_sel_hi:[0,1,1]
    v_pk_fma_f32 v[100:101], v[58:59], v[102:103], v[100:101] op_sel:[1,1,0] op_sel_hi:[1,0,1] neg_lo:[1,0,0]
    v_pk_mul_f32 v[34:35], v[58:59], v[50:51] op_sel:[0,0] op_sel_hi:[0,1]
    v_pk_fma_f32 v[34:35], v[58:59], v[50:51], v[34:35] op_sel:[1,1,0] op_sel_hi:[1,0,1] neg_lo:[1,0,0]
    v_pk_fma_f32 v[98:99], v[46:47], v[96:97], v[70:71] op_sel:[0,0,0] op_sel_hi:[0,1,1]
    v_pk_fma_f32 v[98:99], v[46:47], v[96:97], v[98:99] op_sel:[1,1,0] op_sel_hi:[1,0,1] neg_lo:[1,0,0]
    v_pk_mul_f32 v[12:13], v[46:47], v[6:7] op_sel:[0,0] op_sel_hi:[0,1]
    v_pk_fma_f32 v[12:13], v[46:47], v[6:7], v[12:13] op_sel:[1,1,0] op_sel_hi:[1,0,1] neg_lo:[1,0,0]
    v_pk_fma_f32 v[102:103], v[58:59], v[100:101], v[86:87] op_sel:[0,0,0] op_sel_hi:[0,1,1]
    v_pk_fma_f32 v[102:103], v[58:59], v[100:101], v[102:103] op_sel:[1,1,0] op_sel_hi:[1,0,1] neg_lo:[1,0,0]
    v_pk_mul_f32 v[50:51], v[58:59], v[34:35] op_sel:[0,0] op_sel_hi:[0,1]
    v_pk_fma_f32 v[50:51], v[58:59], v[34:35], v[50:51] op_sel:[1,1,0] op_sel_hi:[1,0,1] neg_lo:[1,0,0]
    v_mov_b32 v104, v98
    v_mov_b32 v105, v99
    v_mov_b32 v120, v12
    v_mov_b32 v121, v13
    v_mov_b32 v106, v102
    v_mov_b32 v107, v103
    v_mov_b32 v122, v50
    v_mov_b32 v123, v51
    v_pk_fma_f32 v[96:97], v[46:47], v[98:99], v[72:73] op_sel:[0,0,0] op_sel_hi:[0,1,1]
    v_pk_fma_f32 v[96:97], v[46:47], v[98:99], v[96:97] op_sel:[1,1,0] op_sel_hi:[1,0,1] neg_lo:[1,0,0]
    v_pk_mul_f32 v[6:7], v[46:47], v[12:13] op_sel:[0,0] op_sel_hi:[0,1]
    v_pk_fma_f32 v[6:7], v[46:47], v[12:13], v[6:7] op_sel:[1,1,0] op_sel_hi:[1,0,1] neg_lo:[1,0,0]
    v_pk_fma_f32 v[100:101], v[58:59], v[102:103], v[88:89] op_sel:[0,0,0] op_sel_hi:[0,1,1]
    v_pk_fma_f32 v[100:101], v[58:59], v[102:103], v[100:101] op_sel:[1,1,0] op_sel_hi:[1,0,1] neg_lo:[1,0,0]
    v_pk_mul_f32 v[34:35], v[58:59], v[50:51] op_sel:[0,0] op_sel_hi:[0,1]
    v_pk_fma_f32 v[34:35], v[58:59], v[50:51], v[34:35] op_sel:[1,1,0] op_sel_hi:[1,0,1] neg_lo:[1,0,0]
    v_cndmask_b32 v104, v104, v96, s[62:63]
    v_cndmask_b32 v105, v105, v97, s[62:63]
    v_cndmask_b32 v120, v120, v6, s[62:63]
    v_cndmask_b32 v121, v121, v7, s[62:63]
    v_cndmask_b32 v106, v106, v100, s[62:63]
    v_cndmask_b32 v107, v107, v101, s[62:63]
    v_cndmask_b32 v122, v122, v34, s[62:63]
    v_cndmask_b32 v123, v123, v35, s[62:63]
    v_pk_fma_f32 v[98:99], v[46:47], v[96:97], v[74:75] op_sel:[0,0,0] op_sel_hi:[0,1,1]
    v_pk_fma_f32 v[98:99], v[46:47], v[96:97], v[98:99] op_sel:[1,1,0] op_sel_hi:[1,0,1] neg_lo:[1,0,0]
    v_pk_mul_f32 v[12:13], v[46:47], v[6:7] op_sel:[0,0] op_sel_hi:[0,1]
    v_pk_fma_f32 v[12:13], v[46:47], v[6:7], v[12:13] op_sel:[1,1,0] op_sel_hi:[1,0,1] neg_lo:[1,0,0]
    v_pk_fma_f32 v[102:103], v[58:59], v[100:101], v[90:91] op_sel:[0,0,0] op_sel_hi:[0,1,1]
    v_pk_fma_f32 v[102:103], v[58:59], v[100:101], v[102:103] op_sel:[1,1,0] op_sel_hi:[1,0,1] neg_lo:[1,0,0]
    v_pk_mul_f32 v[50:51], v[58:59], v[34:35] op_sel:[0,0] op_sel_hi:[0,1]
    v_pk_fma_f32 v[50:51], v[58:59], v[34:35], v[50:51] op_sel:[1,1,0] op_sel_hi:[1,0,1] neg_lo:[1,0,0]
    v_cndmask_b32 v104, v104, v98, s[64:65]
    v_cndmask_b32 v105, v105, v99, s[64:65]
    v_cndmask_b32 v120, v120, v12, s[64:65]
    v_cndmask_b32 v121, v121, v13, s[64:65]
    v_cndmask_b32 v106, v106, v102, s[64:65]
    v_cndmask_b32 v107, v107, v103, s[64:65]
    v_cndmask_b32 v122, v122, v50, s[64:65]
    v_cndmask_b32 v123, v123, v51, s[64:65]
    v_pk_fma_f32 v[96:97], v[46:47], v[98:99], v[76:77] op_sel:[0,0,0] op_sel_hi:[0,1,1]
    v_pk_fma_f32 v[96:97], v[46:47], v[98:99], v[96:97] op_sel:[1,1,0] op_sel_hi:[1,0,1] neg_lo:[1,0,0]
    v_pk_mul_f32 v[6:7], v[46:47], v[12:13] op_sel:[0,0] op_sel_hi:[0,1]
    v_pk_fma_f32 v[6:7], v[46:47], v[12:13], v[6:7] op_sel:[1,1,0] op_sel_hi:[1,0,1] neg_lo:[1,0,0]
    v_pk_fma_f32 v[100:101], v[58:59], v[102:103], v[92:93] op_sel:[0,0,0] op_sel_hi:[0,1,1]
    v_pk_fma_f32 v[100:101], v[58:59], v[102:103], v[100:101] op_sel:[1,1,0] op_sel_hi:[1,0,1] neg_lo:[1,0,0]
    v_pk_mul_f32 v[34:35], v[58:59], v[50:51] op_sel:[0,0] op_sel_hi:[0,1]
    v_pk_fma_f32 v[34:35], v[58:59], v[50:51], v[34:35] op_sel:[1,1,0] op_sel_hi:[1,0,1] neg_lo:[1,0,0]
    v_cndmask_b32 v104, v104, v96, s[66:67]
    v_cndmask_b32 v105, v105, v97, s[66:67]
    v_cndmask_b32 v120, v120, v6, s[66:67]
    v_cndmask_b32 v121, v121, v7, s[66:67]
    v_cndmask_b32 v106, v106, v100, s[66:67]
    v_cndmask_b32 v107, v107, v101, s[66:67]
    v_cndmask_b32 v122, v122, v34, s[66:67]
    v_cndmask_b32 v123, v123, v35, s[66:67]
LC_p0j:
    s_cmp_eq_u32 s13, 0
    s_cbranch_scc1 LC_got
    s_mov_b32 s98, 0
LC_poll:
    s_add_u32 s98, s98, 1
    s_cmp_gt_u32 s98, 262144
    s_cbranch_scc1 L_end
    s_waitcnt vmcnt(0)
    s_mov_b64 s[56:57], 0
    s_cmp_le_u32 s13, 0
    s_cbranch_scc1 LC_chk
    v_cmp_ne_u32 vcc, v17, v15
    s_or_b64 s[56:57], s[56:57], vcc
    v_cmp_ne_u32 vcc, v19, v15
    s_or_b64 s[56:57], s[56:57], vcc
    s_cmp_le_u32 s13, 1
    s_cbranch_scc1 LC_chk
    v_cmp_ne_u32 vcc, v21, v15
    s_or_b64 s[56:57], s[56:57], vcc
    v_cmp_ne_u32 vcc, v23, v15
    s_or_b64 s[56:57], s[56:57], vcc
    s_cmp_le_u32 s13, 2
    s_cbranch_scc1 LC_chk
    v_cmp_ne_u32 vcc, v25, v15
    s_or_b64 s[56:57], s[56:57], vcc
    v_cmp_ne_u32 vcc, v27, v15
    s_or_b64 s[56:57], s[56:57], vcc
    s_cmp_le_u32 s13, 3
    s_cbranch_scc1 LC_chk
    v_cmp_ne_u32 vcc, v29, v15
    s_or_b64 s[56:57], s[56:57], vcc
    v_cmp_ne_u32 vcc, v31, v15
    s_or_b64 s[56:57], s[56:57], vcc
    s_cmp_le_u32 s13, 4
    s_cbranch_scc1 LC_chk
    v_cmp_ne_u32 vcc, v37, v15
    s_or_b64 s[56:57], s[56:57], vcc
    v_cmp_ne_u32 vcc, v39, v15
    s_or_b64 s[56:57], s[56:57], vcc
    s_cmp_le_u32 s13, 5
    s_cbranch_scc1 LC_chk
    v_cmp_ne_u32 vcc, v109, v15
    s_or_b64 s[56:57], s[56:57], vcc
    v_cmp_ne_u32 vcc, v111, v15
    s_or_b64 s[56:57], s[56:57], vcc
    s_cmp_le_u32 s13, 6
    s_cbranch_scc1 LC_chk
    v_cmp_ne_u32 vcc, v113, v15
    s_or_b64 s[56:57], s[56:57], vcc
    v_cmp_ne_u32 vcc, v115, v15
    s_or_b64 s[56:57], s[56:57], vcc
LC_chk:
    s_cmp_eq_u64 s[56:57], 0
    s_cbranch_scc1 LC_got
    s_sleep 1
    s_cmp_le_u32 s13, 0
    s_cbranch_scc1 LC_plb
    s_add_u32 s24, s23, 0
    buffer_load_dwordx4 v[16:19], v11, s[44:47], s24 offen sc1
    s_cmp_le_u32 s13, 1
    s_cbranch_scc1 LC_plb
    s_add_u32 s24, s23, 1024
    buffer_load_dwordx4 v[20:23], v11, s[44:47], s24 offen sc1
    s_cmp_le_u32 s13, 2
    s_cbranch_scc1 LC_plb
    s_add_u32 s24, s23, 2048
    buffer_load_dwordx4 v[24:27], v11, s[44:47], s24 offen sc1
    s_cmp_le_u32 s13, 3
    s_cbranch_scc1 LC_plb
    s_add_u32 s24, s23, 3072
    buffer_load_dwordx4 v[28:31], v11, s[44:47], s24 offen sc1
    s_cmp_le_u32 s13, 4
    s_cbranch_scc1 LC_plb
    s_add_u32 s24, s23, 4096
    buffer_load_dwordx4 v[36:39], v11, s[44:47], s24 offen sc1
    s_cmp_le_u32 s13, 5
    s_cbranch_scc1 LC_plb
    s_add_u32 s24, s23, 5120
    buffer_load_dwordx4 v[108:111], v11, s[44:47], s24 offen sc1
    s_cmp_le_u32 s13, 6
    s_cbranch_scc1 LC_plb
    s_add_u32 s24, s23, 6144
    buffer_load_dwordx4 v[112:115], v11, s[44:47], s24 offen sc1
LC_plb:
    s_branch LC_poll
LC_got:
    s_barrier
    v_mov_b32 v96, 0
    v_mov_b32 v97, 0
    s_cmp_le_u32 s13, 0
    s_cbranch_scc1 LC_hin
    v_mov_b32 v17, v18
    v_pk_fma_f32 v[98:99], v[32:33], v[96:97], v[16:17] op_sel:[0,0,0] op_sel_hi:[0,1,1]
    v_pk_fma_f32 v[98:99], v[32:33], v[96:97], v[98:99] op_sel:[1,1,0] op_sel_hi:[1,0,1] neg_lo:[1,0,0]
    v_mov_b32 v96, v98
    v_mov_b32 v97, v99
    s_cmp_le_u32 s13, 1
    s_cbranch_scc1 LC_hin
    v_mov_b32 v21, v22
    v_pk_fma_f32 v[98:99], v[32:33], v[96:97], v[20:21] op_sel:[0,0,0] op_sel_hi:[0,1,1]
    v_pk_fma_f32 v[98:99], v[32:33], v[96:97], v[98:99] op_sel:[1,1,0] op_sel_hi:[1,0,1] neg_lo:[1,0,0]
    v_mov_b32 v96, v98
    v_mov_b32 v97, v99
    s_cmp_le_u32 s13, 2
    s_cbranch_scc1 LC_hin
    v_mov_b32 v25, v26
    v_pk_fma_f32 v[98:99], v[32:33], v[96:97], v[24:25] op_sel:[0,0,0] op_sel_hi:[0,1,1]
    v_pk_fma_f32 v[98:99], v[32:33], v[96:97], v[98:99] op_sel:[1,1,0] op_sel_hi:[1,0,1] neg_lo:[1,0,0]
    v_mov_b32 v96, v98
    v_mov_b32 v97, v99
    s_cmp_le_u32 s13, 3
    s_cbranch_scc1 LC_hin
    v_mov_b32 v29, v30
    v_pk_fma_f32 v[98:99], v[32:33], v[96:97], v[28:29] op_sel:[0,0,0] op_sel_hi:[0,1,1]
    v_pk_fma_f32 v[98:99], v[32:33], v[96:97], v[98:99] op_sel:[1,1,0] op_sel_hi:[1,0,1] neg_lo:[1,0,0]
    v_mov_b32 v96, v98
    v_mov_b32 v97, v99
    s_cmp_le_u32 s13, 4
    s_cbranch_scc1 LC_hin
    v_mov_b32 v37, v38
    v_pk_fma_f32 v[98:99], v[32:33], v[96:97], v[36:37] op_sel:[0,0,0] op_sel_hi:[0,1,1]
    v_pk_fma_f32 v[98:99], v[32:33], v[96:97], v[98:99] op_sel:[1,1,0] op_sel_hi:[1,0,1] neg_lo:[1,0,0]
    v_mov_b32 v96, v98
    v_mov_b32 v97, v99
    s_cmp_le_u32 s13, 5
    s_cbranch_scc1 LC_hin
    v_mov_b32 v109, v110
    v_pk_fma_f32 v[98:99], v[32:33], v[96:97], v[108:109] op_sel:[0,0,0] op_sel_hi:[0,1,1]
    v_pk_fma_f32 v[98:99], v[32:33], v[96:97], v[98:99] op_sel:[1,1,0] op_sel_hi:[1,0,1] neg_lo:[1,0,0]
    v_mov_b32 v96, v98
    v_mov_b32 v97, v99
    s_cmp_le_u32 s13, 6
    s_cbranch_scc1 LC_hin
    v_mov_b32 v113, v114
    v_pk_fma_f32 v[98:99], v[32:33], v[96:97], v[112:113] op_sel:[0,0,0] op_sel_hi:[0,1,1]
    v_pk_fma_f32 v[98:99], v[32:33], v[96:97], v[98:99] op_sel:[1,1,0] op_sel_hi:[1,0,1] neg_lo:[1,0,0]
    v_mov_b32 v96, v98
    v_mov_b32 v97, v99
LC_hin:
    v_and_b32 v5, 47, v2
    v_lshlrev_b32 v5, 2, v5
    v_or_b32 v6, 64, v5
    ds_bpermute_b32 v100, v5, v96
    ds_bpermute_b32 v101, v5, v97
    ds_bpermute_b32 v102, v6, v96
    ds_bpermute_b32 v103, v6, v97
    s_waitcnt lgkmcnt(0)
    v_pk_fma_f32 v[104:105], v[120:121], v[100:101], v[104:105] op_sel:[0,0,0] op_sel_hi:[0,1,1]
    v_pk_fma_f32 v[104:105], v[120:121], v[100:101], v[104:105] op_sel:[1,1,0] op_sel_hi:[1,0,1] neg_lo:[1,0,0]
    v_pk_fma_f32 v[106:107], v[122:123], v[102:103], v[106:107] op_sel:[0,0,0] op_sel_hi:[0,1,1]
    v_pk_fma_f32 v[106:107], v[122:123], v[102:103], v[106:107] op_sel:[1,1,0] op_sel_hi:[1,0,1] neg_lo:[1,0,0]
    v_fma_f32 v24, v44, v104, v116
    v_fma_f32 v25, v44, v105, v118
    v_fma_f32 v24, -v45, v105, v24
    v_fma_f32 v25, v45, v104, v25
    v_fma_f32 v16, v42, v104, 0
    v_fma_f32 v18, v42, v105, 0
    v_fma_f32 v16, -v43, v105, v16
    v_fma_f32 v18, v43, v104, v18
    v_fma_f32 v17, v42, v24, 0
    v_fma_f32 v19, v42, v25, 0
    v_fma_f32 v17, -v43, v25, v17
    v_fma_f32 v19, v43, v24, v19
    v_fma_f32 v24, v56, v106, v124
    v_fma_f32 v25, v56, v107, v126
    v_fma_f32 v24, -v57, v107, v24
    v_fma_f32 v25, v57, v106, v25
    v_fma_f32 v20, v54, v106, 0
    v_fma_f32 v22, v54, v107, 0
    v_fma_f32 v20, -v55, v107, v20
    v_fma_f32 v22, v55, v106, v22
    v_fma_f32 v21, v54, v24, 0
    v_fma_f32 v23, v54, v25, 0
    v_fma_f32 v21, -v55, v25, v21
    v_fma_f32 v23, v55, v24, v23
    s_lshl_b32 s22, s13, 1
    s_add_u32 s22, s22, s20
    s_lshl_b32 s22, s22, 6
    s_lshl_b32 s23, s77, 5
    s_add_u32 s22, s22, s23
    s_and_b32 s23, s14, 15
    s_add_u32 s22, s22, s23
    s_mul_i32 s22, s22, 16896
    s_add_u32 s23, s22, 270336
    v_lshlrev_b32 v5, 12, v4
    v_lshl_add_u32 v5, v9, 4, v5
    v_pk_fma_f32 v[136:137], v[40:41], v[16:17], v[136:137] op_sel:[0,0,0] op_sel_hi:[0,1,1]
    v_pk_fma_f32 v[140:141], v[52:53], v[20:21], v[140:141] op_sel:[0,0,0] op_sel_hi:[0,1,1]
    v_pk_fma_f32 v[128:129], v[40:41], v[18:19], v[128:129] op_sel:[0,0,0] op_sel_hi:[0,1,1]
    v_pk_fma_f32 v[132:133], v[52:53], v[22:23], v[132:133] op_sel:[0,0,0] op_sel_hi:[0,1,1]
    v_pk_fma_f32 v[136:137], v[40:41], v[18:19], v[136:137] op_sel:[1,0,0] op_sel_hi:[1,1,1] neg_lo:[1,0,0] neg_hi:[1,0,0]
    v_pk_fma_f32 v[140:141], v[52:53], v[22:23], v[140:141] op_sel:[1,0,0] op_sel_hi:[1,1,1] neg_lo:[1,0,0] neg_hi:[1,0,0]
    v_pk_fma_f32 v[128:129], v[40:41], v[16:17], v[128:129] op_sel:[1,0,0] op_sel_hi:[1,1,1]
    v_pk_fma_f32 v[132:133], v[52:53], v[20:21], v[132:133] op_sel:[1,0,0] op_sel_hi:[1,1,1]
    v_pk_fma_f32 v[138:139], v[40:41], v[136:137], v[138:139] op_sel:[0,0,0] op_sel_hi:[0,1,1]
    v_pk_fma_f32 v[142:143], v[52:53], v[140:141], v[142:143] op_sel:[0,0,0] op_sel_hi:[0,1,1]
    v_pk_fma_f32 v[130:131], v[40:41], v[128:129], v[130:131] op_sel:[0,0,0] op_sel_hi:[0,1,1]
    v_pk_fma_f32 v[134:135], v[52:53], v[132:133], v[134:135] op_sel:[0,0,0] op_sel_hi:[0,1,1]
    v_pk_fma_f32 v[138:139], v[40:41], v[128:129], v[138:139] op_sel:[1,0,0] op_sel_hi:[1,1,1] neg_lo:[1,0,0] neg_hi:[1,0,0]
    v_pk_fma_f32 v[142:143], v[52:53], v[132:133], v[142:143] op_sel:[1,0,0] op_sel_hi:[1,1,1] neg_lo:[1,0,0] neg_hi:[1,0,0]
    v_pk_fma_f32 v[130:131], v[40:41], v[136:137], v[130:131] op_sel:[1,0,0] op_sel_hi:[1,1,1]
    v_pk_fma_f32 v[134:135], v[52:53], v[140:141], v[134:135] op_sel:[1,0,0] op_sel_hi:[1,1,1]
    v_pk_fma_f32 v[152:153], v[40:41], v[138:139], v[152:153] op_sel:[0,0,0] op_sel_hi:[0,1,1]
    v_pk_fma_f32 v[156:157], v[52:53], v[142:143], v[156:157] op_sel:[0,0,0] op_sel_hi:[0,1,1]
    v_pk_fma_f32 v[144:145], v[40:41], v[130:131], v[144:145] op_sel:[0,0,0] op_sel_hi:[0,1,1]
    v_pk_fma_f32 v[148:149], v[52:53], v[134:135], v[148:149] op_sel:[0,0,0] op_sel_hi:[0,1,1]
    v_pk_fma_f32 v[152:153], v[40:41], v[130:131], v[152:153] op_sel:[1,0,0] op_sel_hi:[1,1,1] neg_lo:[1,0,0] neg_hi:[1,0,0]
    v_pk_fma_f32 v[156:157], v[52:53], v[134:135], v[156:157] op_sel:[1,0,0] op_sel_hi:[1,1,1] neg_lo:[1,0,0] neg_hi:[1,0,0]
    v_pk_fma_f32 v[144:145], v[40:41], v[138:139], v[144:145] op_sel:[1,0,0] op_sel_hi:[1,1,1]
    v_pk_fma_f32 v[148:149], v[52:53], v[142:143], v[148:149] op_sel:[1,0,0] op_sel_hi:[1,1,1]
    v_pk_fma_f32 v[154:155], v[40:41], v[152:153], v[154:155] op_sel:[0,0,0] op_sel_hi:[0,1,1]
    v_pk_fma_f32 v[158:159], v[52:53], v[156:157], v[158:159] op_sel:[0,0,0] op_sel_hi:[0,1,1]
    v_pk_fma_f32 v[146:147], v[40:41], v[144:145], v[146:147] op_sel:[0,0,0] op_sel_hi:[0,1,1]
    v_pk_fma_f32 v[150:151], v[52:53], v[148:149], v[150:151] op_sel:[0,0,0] op_sel_hi:[0,1,1]
    v_pk_fma_f32 v[154:155], v[40:41], v[144:145], v[154:155] op_sel:[1,0,0] op_sel_hi:[1,1,1] neg_lo:[1,0,0] neg_hi:[1,0,0]
    v_pk_fma_f32 v[158:159], v[52:53], v[148:149], v[158:159] op_sel:[1,0,0] op_sel_hi:[1,1,1] neg_lo:[1,0,0] neg_hi:[1,0,0]
    v_pk_fma_f32 v[146:147], v[40:41], v[152:153], v[146:147] op_sel:[1,0,0] op_sel_hi:[1,1,1]
    v_pk_fma_f32 v[150:151], v[52:53], v[156:157], v[150:151] op_sel:[1,0,0] op_sel_hi:[1,1,1]
    v_pk_fma_f32 v[168:169], v[40:41], v[154:155], v[168:169] op_sel:[0,0,0] op_sel_hi:[0,1,1]
    v_pk_fma_f32 v[172:173], v[52:53], v[158:159], v[172:173] op_sel:[0,0,0] op_sel_hi:[0,1,1]
    v_pk_fma_f32 v[160:161], v[40:41], v[146:147], v[160:161] op_sel:[0,0,0] op_sel_hi:[0,1,1]
    v_pk_fma_f32 v[164:165], v[52:53], v[150:151], v[164:165] op_sel:[0,0,0] op_sel_hi:[0,1,1]
    v_pk_fma_f32 v[168:169], v[40:41], v[146:147], v[168:169] op_sel:[1,0,0] op_sel_hi:[1,1,1] neg_lo:[1,0,0] neg_hi:[1,0,0]
    v_pk_fma_f32 v[172:173], v[52:53], v[150:151], v[172:173] op_sel:[1,0,0] op_sel_hi:[1,1,1] neg_lo:[1,0,0] neg_hi:[1,0,0]
    v_pk_fma_f32 v[160:161], v[40:41], v[154:155], v[160:161] op_sel:[1,0,0] op_sel_hi:[1,1,1]
    v_pk_fma_f32 v[164:165], v[52:53], v[158:159], v[164:165] op_sel:[1,0,0] op_sel_hi:[1,1,1]
    v_pk_fma_f32 v[170:171], v[40:41], v[168:169], v[170:171] op_sel:[0,0,0] op_sel_hi:[0,1,1]
    v_pk_fma_f32 v[174:175], v[52:53], v[172:173], v[174:175] op_sel:[0,0,0] op_sel_hi:[0,1,1]
    v_pk_fma_f32 v[162:163], v[40:41], v[160:161], v[162:163] op_sel:[0,0,0] op_sel_hi:[0,1,1]
    v_pk_fma_f32 v[166:167], v[52:53], v[164:165], v[166:167] op_sel:[0,0,0] op_sel_hi:[0,1,1]
    v_pk_fma_f32 v[170:171], v[40:41], v[160:161], v[170:171] op_sel:[1,0,0] op_sel_hi:[1,1,1] neg_lo:[1,0,0] neg_hi:[1,0,0]
    v_pk_fma_f32 v[174:175], v[52:53], v[164:165], v[174:175] op_sel:[1,0,0] op_sel_hi:[1,1,1] neg_lo:[1,0,0] neg_hi:[1,0,0]
    v_pk_fma_f32 v[162:163], v[40:41], v[168:169], v[162:163] op_sel:[1,0,0] op_sel_hi:[1,1,1]
    v_pk_fma_f32 v[166:167], v[52:53], v[172:173], v[166:167] op_sel:[1,0,0] op_sel_hi:[1,1,1]
    v_pk_fma_f32 v[184:185], v[40:41], v[170:171], v[184:185] op_sel:[0,0,0] op_sel_hi:[0,1,1]
    v_pk_fma_f32 v[188:189], v[52:53], v[174:175], v[188:189] op_sel:[0,0,0] op_sel_hi:[0,1,1]
    v_pk_fma_f32 v[176:177], v[40:41], v[162:163], v[176:177] op_sel:[0,0,0] op_sel_hi:[0,1,1]
    v_pk_fma_f32 v[180:181], v[52:53], v[166:167], v[180:181] op_sel:[0,0,0] op_sel_hi:[0,1,1]
    v_pk_fma_f32 v[184:185], v[40:41], v[162:163], v[184:185] op_sel:[1,0,0] op_sel_hi:[1,1,1] neg_lo:[1,0,0] neg_hi:[1,0,0]
    v_pk_fma_f32 v[188:189], v[52:53], v[166:167], v[188:189] op_sel:[1,0,0] op_sel_hi:[1,1,1] neg_lo:[1,0,0] neg_hi:[1,0,0]
    v_pk_fma_f32 v[176:177], v[40:41], v[170:171], v[176:177] op_sel:[1,0,0] op_sel_hi:[1,1,1]
    v_pk_fma_f32 v[180:181], v[52:53], v[174:175], v[180:181] op_sel:[1,0,0] op_sel_hi:[1,1,1]
    v_pk_fma_f32 v[186:187], v[40:41], v[184:185], v[186:187] op_sel:[0,0,0] op_sel_hi:[0,1,1]
    v_pk_fma_f32 v[190:191], v[52:53], v[188:189], v[190:191] op_sel:[0,0,0] op_sel_hi:[0,1,1]
    v_pk_fma_f32 v[178:179], v[40:41], v[176:177], v[178:179] op_sel:[0,0,0] op_sel_hi:[0,1,1]
    v_pk_fma_f32 v[182:183], v[52:53], v[180:181], v[182:183] op_sel:[0,0,0] op_sel_hi:[0,1,1]
    v_pk_fma_f32 v[186:187], v[40:41], v[176:177], v[186:187] op_sel:[1,0,0] op_sel_hi:[1,1,1] neg_lo:[1,0,0] neg_hi:[1,0,0]
    v_pk_fma_f32 v[190:191], v[52:53], v[180:181], v[190:191] op_sel:[1,0,0] op_sel_hi:[1,1,1] neg_lo:[1,0,0] neg_hi:[1,0,0]
    v_pk_fma_f32 v[178:179], v[40:41], v[184:185], v[178:179] op_sel:[1,0,0] op_sel_hi:[1,1,1]
    v_pk_fma_f32 v[182:183], v[52:53], v[188:189], v[182:183] op_sel:[1,0,0] op_sel_hi:[1,1,1]
    v_cvt_pk_bf16_f32 v64, v136, v138
    v_cvt_pk_bf16_f32 v65, v152, v154
    v_cvt_pk_bf16_f32 v66, v168, v170
    v_cvt_pk_bf16_f32 v67, v184, v186
    buffer_store_dwordx4 v[64:67], v5, s[44:47], s22 offen offset:0 sc1
    v_cvt_pk_bf16_f32 v68, v137, v139
    v_cvt_pk_bf16_f32 v69, v153, v155
    v_cvt_pk_bf16_f32 v70, v169, v171
    v_cvt_pk_bf16_f32 v71, v185, v187
    buffer_store_dwordx4 v[68:71], v5, s[44:47], s22 offen offset:2048 sc1
    v_cvt_pk_bf16_f32 v72, v140, v142
    v_cvt_pk_bf16_f32 v73, v156, v158
    v_cvt_pk_bf16_f32 v74, v172, v174
    v_cvt_pk_bf16_f32 v75, v188, v190
    buffer_store_dwordx4 v[72:75], v5, s[44:47], s22 offen offset:256 sc1
    v_cvt_pk_bf16_f32 v76, v141, v143
    v_cvt_pk_bf16_f32 v77, v157, v159
    v_cvt_pk_bf16_f32 v78, v173, v175
    v_cvt_pk_bf16_f32 v79, v189, v191
    buffer_store_dwordx4 v[76:79], v5, s[44:47], s22 offen offset:2304 sc1
    v_cvt_pk_bf16_f32 v80, -v128, -v130
    v_cvt_pk_bf16_f32 v81, -v144, -v146
    v_cvt_pk_bf16_f32 v82, -v160, -v162
    v_cvt_pk_bf16_f32 v83, -v176, -v178
    v_cvt_pk_bf16_f32 v84, -v129, -v131
    v_cvt_pk_bf16_f32 v85, -v145, -v147
    v_cvt_pk_bf16_f32 v86, -v161, -v163
    v_cvt_pk_bf16_f32 v87, -v177, -v179
    v_cvt_pk_bf16_f32 v88, -v132, -v134
    v_cvt_pk_bf16_f32 v89, -v148, -v150
    v_cvt_pk_bf16_f32 v90, -v164, -v166
    v_cvt_pk_bf16_f32 v91, -v180, -v182
    v_cvt_pk_bf16_f32 v92, -v133, -v135
    v_cvt_pk_bf16_f32 v93, -v149, -v151
    v_cvt_pk_bf16_f32 v94, -v165, -v167
    v_cvt_pk_bf16_f32 v95, -v181, -v183
    v_pk_fma_f32 v[200:201], v[40:41], v[186:187], v[200:201] op_sel:[0,0,0] op_sel_hi:[0,1,1]
    v_pk_fma_f32 v[204:205], v[52:53], v[190:191], v[204:205] op_sel:[0,0,0] op_sel_hi:[0,1,1]
    v_pk_fma_f32 v[192:193], v[40:41], v[178:179], v[192:193] op_sel:[0,0,0] op_sel_hi:[0,1,1]
    v_pk_fma_f32 v[196:197], v[52:53], v[182:183], v[196:197] op_sel:[0,0,0] op_sel_hi:[0,1,1]
    v_pk_fma_f32 v[200:201], v[40:41], v[178:179], v[200:201] op_sel:[1,0,0] op_sel_hi:[1,1,1] neg_lo:[1,0,0] neg_hi:[1,0,0]
    v_pk_fma_f32 v[204:205], v[52:53], v[182:183], v[204:205] op_sel:[1,0,0] op_sel_hi:[1,1,1] neg_lo:[1,0,0] neg_hi:[1,0,0]
    v_pk_fma_f32 v[192:193], v[40:41], v[186:187], v[192:193] op_sel:[1,0,0] op_sel_hi:[1,1,1]
    v_pk_fma_f32 v[196:197], v[52:53], v[190:191], v[196:197] op_sel:[1,0,0] op_sel_hi:[1,1,1]
    v_pk_fma_f32 v[202:203], v[40:41], v[200:201], v[202:203] op_sel:[0,0,0] op_sel_hi:[0,1,1]
    v_pk_fma_f32 v[206:207], v[52:53], v[204:205], v[206:207] op_sel:[0,0,0] op_sel_hi:[0,1,1]
    v_pk_fma_f32 v[194:195], v[40:41], v[192:193], v[194:195] op_sel:[0,0,0] op_sel_hi:[0,1,1]
    v_pk_fma_f32 v[198:199], v[52:53], v[196:197], v[198:199] op_sel:[0,0,0] op_sel_hi:[0,1,1]
    v_pk_fma_f32 v[202:203], v[40:41], v[192:193], v[202:203] op_sel:[1,0,0] op_sel_hi:[1,1,1] neg_lo:[1,0,0] neg_hi:[1,0,0]
    v_pk_fma_f32 v[206:207], v[52:53], v[196:197], v[206:207] op_sel:[1,0,0] op_sel_hi:[1,1,1] neg_lo:[1,0,0] neg_hi:[1,0,0]
    v_pk_fma_f32 v[194:195], v[40:41], v[200:201], v[194:195] op_sel:[1,0,0] op_sel_hi:[1,1,1]
    v_pk_fma_f32 v[198:199], v[52:53], v[204:205], v[198:199] op_sel:[1,0,0] op_sel_hi:[1,1,1]
    v_pk_fma_f32 v[216:217], v[40:41], v[202:203], v[216:217] op_sel:[0,0,0] op_sel_hi:[0,1,1]
    v_pk_fma_f32 v[220:221], v[52:53], v[206:207], v[220:221] op_sel:[0,0,0] op_sel_hi:[0,1,1]
    v_pk_fma_f32 v[208:209], v[40:41], v[194:195], v[208:209] op_sel:[0,0,0] op_sel_hi:[0,1,1]
    v_pk_fma_f32 v[212:213], v[52:53], v[198:199], v[212:213] op_sel:[0,0,0] op_sel_hi:[0,1,1]
    v_pk_fma_f32 v[216:217], v[40:41], v[194:195], v[216:217] op_sel:[1,0,0] op_sel_hi:[1,1,1] neg_lo:[1,0,0] neg_hi:[1,0,0]
    v_pk_fma_f32 v[220:221], v[52:53], v[198:199], v[220:221] op_sel:[1,0,0] op_sel_hi:[1,1,1] neg_lo:[1,0,0] neg_hi:[1,0,0]
    v_pk_fma_f32 v[208:209], v[40:41], v[202:203], v[208:209] op_sel:[1,0,0] op_sel_hi:[1,1,1]
    v_pk_fma_f32 v[212:213], v[52:53], v[206:207], v[212:213] op_sel:[1,0,0] op_sel_hi:[1,1,1]
    v_pk_fma_f32 v[218:219], v[40:41], v[216:217], v[218:219] op_sel:[0,0,0] op_sel_hi:[0,1,1]
    v_pk_fma_f32 v[222:223], v[52:53], v[220:221], v[222:223] op_sel:[0,0,0] op_sel_hi:[0,1,1]
    v_pk_fma_f32 v[210:211], v[40:41], v[208:209], v[210:211] op_sel:[0,0,0] op_sel_hi:[0,1,1]
    v_pk_fma_f32 v[214:215], v[52:53], v[212:213], v[214:215] op_sel:[0,0,0] op_sel_hi:[0,1,1]
    v_pk_fma_f32 v[218:219], v[40:41], v[208:209], v[218:219] op_sel:[1,0,0] op_sel_hi:[1,1,1] neg_lo:[1,0,0] neg_hi:[1,0,0]
    v_pk_fma_f32 v[222:223], v[52:53], v[212:213], v[222:223] op_sel:[1,0,0] op_sel_hi:[1,1,1] neg_lo:[1,0,0] neg_hi:[1,0,0]
    v_pk_fma_f32 v[210:211], v[40:41], v[216:217], v[210:211] op_sel:[1,0,0] op_sel_hi:[1,1,1]
    v_pk_fma_f32 v[214:215], v[52:53], v[220:221], v[214:215] op_sel:[1,0,0] op_sel_hi:[1,1,1]
    v_pk_fma_f32 v[232:233], v[40:41], v[218:219], v[232:233] op_sel:[0,0,0] op_sel_hi:[0,1,1]
    v_pk_fma_f32 v[236:237], v[52:53], v[222:223], v[236:237] op_sel:[0,0,0] op_sel_hi:[0,1,1]
    v_pk_fma_f32 v[224:225], v[40:41], v[210:211], v[224:225] op_sel:[0,0,0] op_sel_hi:[0,1,1]
    v_pk_fma_f32 v[228:229], v[52:53], v[214:215], v[228:229] op_sel:[0,0,0] op_sel_hi:[0,1,1]
    v_pk_fma_f32 v[232:233], v[40:41], v[210:211], v[232:233] op_sel:[1,0,0] op_sel_hi:[1,1,1] neg_lo:[1,0,0] neg_hi:[1,0,0]
    v_pk_fma_f32 v[236:237], v[52:53], v[214:215], v[236:237] op_sel:[1,0,0] op_sel_hi:[1,1,1] neg_lo:[1,0,0] neg_hi:[1,0,0]
    v_pk_fma_f32 v[224:225], v[40:41], v[218:219], v[224:225] op_sel:[1,0,0] op_sel_hi:[1,1,1]
    v_pk_fma_f32 v[228:229], v[52:53], v[222:223], v[228:229] op_sel:[1,0,0] op_sel_hi:[1,1,1]
    v_pk_fma_f32 v[234:235], v[40:41], v[232:233], v[234:235] op_sel:[0,0,0] op_sel_hi:[0,1,1]
    v_pk_fma_f32 v[238:239], v[52:53], v[236:237], v[238:239] op_sel:[0,0,0] op_sel_hi:[0,1,1]
    v_pk_fma_f32 v[226:227], v[40:41], v[224:225], v[226:227] op_sel:[0,0,0] op_sel_hi:[0,1,1]
    v_pk_fma_f32 v[230:231], v[52:53], v[228:229], v[230:231] op_sel:[0,0,0] op_sel_hi:[0,1,1]
    v_pk_fma_f32 v[234:235], v[40:41], v[224:225], v[234:235] op_sel:[1,0,0] op_sel_hi:[1,1,1] neg_lo:[1,0,0] neg_hi:[1,0,0]
    v_pk_fma_f32 v[238:239], v[52:53], v[228:229], v[238:239] op_sel:[1,0,0] op_sel_hi:[1,1,1] neg_lo:[1,0,0] neg_hi:[1,0,0]
    v_pk_fma_f32 v[226:227], v[40:41], v[232:233], v[226:227] op_sel:[1,0,0] op_sel_hi:[1,1,1]
    v_pk_fma_f32 v[230:231], v[52:53], v[236:237], v[230:231] op_sel:[1,0,0] op_sel_hi:[1,1,1]
    v_pk_fma_f32 v[248:249], v[40:41], v[234:235], v[248:249] op_sel:[0,0,0] op_sel_hi:[0,1,1]
    v_pk_fma_f32 v[252:253], v[52:53], v[238:239], v[252:253] op_sel:[0,0,0] op_sel_hi:[0,1,1]
    v_pk_fma_f32 v[240:241], v[40:41], v[226:227], v[240:241] op_sel:[0,0,0] op_sel_hi:[0,1,1]
    v_pk_fma_f32 v[244:245], v[52:53], v[230:231], v[244:245] op_sel:[0,0,0] op_sel_hi:[0,1,1]
    v_pk_fma_f32 v[248:249], v[40:41], v[226:227], v[248:249] op_sel:[1,0,0] op_sel_hi:[1,1,1] neg_lo:[1,0,0] neg_hi:[1,0,0]
    v_pk_fma_f32 v[252:253], v[52:53], v[230:231], v[252:253] op_sel:[1,0,0] op_sel_hi:[1,1,1] neg_lo:[1,0,0] neg_hi:[1,0,0]
    v_pk_fma_f32 v[240:241], v[40:41], v[234:235], v[240:241] op_sel:[1,0,0] op_sel_hi:[1,1,1]
    v_pk_fma_f32 v[244:245], v[52:53], v[238:239], v[244:245] op_sel:[1,0,0] op_sel_hi:[1,1,1]
    v_pk_fma_f32 v[250:251], v[40:41], v[248:249], v[250:251] op_sel:[0,0,0] op_sel_hi:[0,1,1]
    v_pk_fma_f32 v[254:255], v[52:53], v[252:253], v[254:255] op_sel:[0,0,0] op_sel_hi:[0,1,1]
    v_pk_fma_f32 v[242:243], v[40:41], v[240:241], v[242:243] op_sel:[0,0,0] op_sel_hi:[0,1,1]
    v_pk_fma_f32 v[246:247], v[52:53], v[244:245], v[246:247] op_sel:[0,0,0] op_sel_hi:[0,1,1]
    v_pk_fma_f32 v[250:251], v[40:41], v[240:241], v[250:251] op_sel:[1,0,0] op_sel_hi:[1,1,1] neg_lo:[1,0,0] neg_hi:[1,0,0]
    v_pk_fma_f32 v[254:255], v[52:53], v[244:245], v[254:255] op_sel:[1,0,0] op_sel_hi:[1,1,1] neg_lo:[1,0,0] neg_hi:[1,0,0]
    v_pk_fma_f32 v[242:243], v[40:41], v[248:249], v[242:243] op_sel:[1,0,0] op_sel_hi:[1,1,1]
    v_pk_fma_f32 v[246:247], v[52:53], v[252:253], v[246:247] op_sel:[1,0,0] op_sel_hi:[1,1,1]
    v_cvt_pk_bf16_f32 v96, v200, v202
    v_cvt_pk_bf16_f32 v97, v216, v218
    v_cvt_pk_bf16_f32 v98, v232, v234
    v_cvt_pk_bf16_f32 v99, v248, v250
    buffer_store_dwordx4 v[96:99], v5, s[44:47], s22 offen offset:1024 sc1
    v_cvt_pk_bf16_f32 v100, v201, v203
    v_cvt_pk_bf16_f32 v101, v217, v219
    v_cvt_pk_bf16_f32 v102, v233, v235
    v_cvt_pk_bf16_f32 v103, v249, v251
    buffer_store_dwordx4 v[100:103], v5, s[44:47], s22 offen offset:3072 sc1
    v_cvt_pk_bf16_f32 v104, v204, v206
    v_cvt_pk_bf16_f32 v105, v220, v222
    v_cvt_pk_bf16_f32 v106, v236, v238
    v_cvt_pk_bf16_f32 v107, v252, v254
    buffer_store_dwordx4 v[104:107], v5, s[44:47], s22 offen offset:1280 sc1
    v_cvt_pk_bf16_f32 v108, v205, v207
    v_cvt_pk_bf16_f32 v109, v221, v223
    v_cvt_pk_bf16_f32 v110, v237, v239
    v_cvt_pk_bf16_f32 v111, v253, v255
    buffer_store_dwordx4 v[108:111], v5, s[44:47], s22 offen offset:3328 sc1
    v_cvt_pk_bf16_f32 v112, -v192, -v194
    v_cvt_pk_bf16_f32 v113, -v208, -v210
    v_cvt_pk_bf16_f32 v114, -v224, -v226
    v_cvt_pk_bf16_f32 v115, -v240, -v242
    v_cvt_pk_bf16_f32 v116, -v193, -v195
    v_cvt_pk_bf16_f32 v117, -v209, -v211
    v_cvt_pk_bf16_f32 v118, -v225, -v227
    v_cvt_pk_bf16_f32 v119, -v241, -v243
    v_cvt_pk_bf16_f32 v120, -v196, -v198
    v_cvt_pk_bf16_f32 v121, -v212, -v214
    v_cvt_pk_bf16_f32 v122, -v228, -v230
    v_cvt_pk_bf16_f32 v123, -v244, -v246
    v_cvt_pk_bf16_f32 v124, -v197, -v199
    v_cvt_pk_bf16_f32 v125, -v213, -v215
    v_cvt_pk_bf16_f32 v126, -v229, -v231
    v_cvt_pk_bf16_f32 v127, -v245, -v247
    buffer_store_dwordx4 v[80:83], v5, s[44:47], s23 offen offset:0 sc1
    buffer_store_dwordx4 v[84:87], v5, s[44:47], s23 offen offset:2048 sc1
    buffer_store_dwordx4 v[88:91], v5, s[44:47], s23 offen offset:256 sc1
    buffer_store_dwordx4 v[92:95], v5, s[44:47], s23 offen offset:2304 sc1
    buffer_store_dwordx4 v[112:115], v5, s[44:47], s23 offen offset:1024 sc1
    buffer_store_dwordx4 v[116:119], v5, s[44:47], s23 offen offset:3072 sc1
    buffer_store_dwordx4 v[120:123], v5, s[44:47], s23 offen offset:1280 sc1
    buffer_store_dwordx4 v[124:127], v5, s[44:47], s23 offen offset:3328 sc1
    s_lshl_b32 s24, s13, 1
    s_add_u32 s24, s24, s20
    s_lshl_b32 s24, s24, 1
    s_add_u32 s24, s24, s77
    s_lshl_b32 s24, s24, 8
    s_and_b32 s25, s14, 15
    s_lshl_b32 s25, s25, 1
    s_add_u32 s25, s25, s21
    s_lshl_b32 s25, s25, 2
    s_add_u32 s24, s24, s25
    s_add_u32 s24, s24, 18284544
    s_waitcnt vmcnt(8)
    v_mov_b32 v6, 0
    s_mov_b64 s[56:57], exec
    s_mov_b64 exec, 1
    buffer_store_dword v15, v6, s[44:47], s24 offen sc1
    s_mov_b64 exec, s[56:57]
    s_barrier
    s_mov_b32 s99, s24
    s_load_dwordx2 s[4:5], s[0:1], 0
    s_load_dwordx2 s[36:37], s[0:1], 64
    s_load_dwordx2 s[38:39], s[0:1], 136
    s_load_dwordx2 s[40:41], s[0:1], 152
    s_lshl_b32 s22, s72, 7
    s_lshl_b32 s23, s20, 6
    s_add_u32 s22, s22, s23
    v_lshlrev_b32 v5, 2, v4
    v_add_u32 v5, s22, v5
    s_lshl_b32 s22, s71, 7
    s_lshl_b32 s23, s21, 6
    s_add_u32 s22, s22, s23
    s_lshl_b32 s23, s70, 5
    s_add_u32 s22, s22, s23
    v_add_u32 v6, s22, v3
    v_lshlrev_b32 v7, 1, v5
    v_lshl_add_u32 v8, v6, 11, v7
    v_lshlrev_b32 v9, 4, v6
    v_add_u32 v9, 17825792, v9
    v_lshlrev_b32 v10, 2, v5
    v_lshl_add_u32 v10, v6, 12, v10
    v_bfe_u32 v12, v2, 1, 3
    v_xor_b32 v12, v12, v4
    v_lshlrev_b32 v12, 4, v12
    v_lshl_add_u32 v12, v3, 7, v12
    s_lshl_b32 s22, s20, 13
    s_add_u32 s22, s22, 17408
    v_xor_b32 v13, 0, v12
    v_add_u32 v13, 0, v13
    v_add_u32 v16, s22, v13
    v_xor_b32 v13, 64, v12
    v_add_u32 v13, 0, v13
    v_add_u32 v17, s22, v13
    v_xor_b32 v13, 0, v12
    v_add_u32 v13, 67584, v13
    v_add_u32 v18, s22, v13
    v_xor_b32 v13, 64, v12
    v_add_u32 v13, 67584, v13
    v_add_u32 v19, s22, v13
    v_bfe_u32 v12, v2, 1, 1
    v_mul_u32_u24 v12, 1088, v12
    v_bfe_u32 v13, v2, 2, 2
    v_lshl_add_u32 v13, v4, 3, v13
    v_lshl_add_u32 v12, v13, 4, v12
    v_and_b32 v13, 1, v2
    v_lshl_add_u32 v12, v13, 3, v12
    s_mul_i32 s22, s21, 8704
    v_add_u32 v20, s22, v12
    v_add_u32 v21, 67584, v20
    v_mov_b32 v128, 0
    v_mov_b32 v129, 0
    v_mov_b32 v130, 0
    v_mov_b32 v131, 0
    v_mov_b32 v132, 0
    v_mov_b32 v133, 0
    v_mov_b32 v134, 0
    v_mov_b32 v135, 0
    v_mov_b32 v136, 0
    v_mov_b32 v137, 0
    v_mov_b32 v138, 0
    v_mov_b32 v139, 0
    v_mov_b32 v140, 0
    v_mov_b32 v141, 0
    v_mov_b32 v142, 0
    v_mov_b32 v143, 0
    v_mov_b32 v144, 0
    v_mov_b32 v145, 0
    v_mov_b32 v146, 0
    v_mov_b32 v147, 0
    v_mov_b32 v148, 0
    v_mov_b32 v149, 0
    v_mov_b32 v150, 0
    v_mov_b32 v151, 0
    v_mov_b32 v152, 0
    v_mov_b32 v153, 0
    v_mov_b32 v154, 0
    v_mov_b32 v155, 0
    v_mov_b32 v156, 0
    v_mov_b32 v157, 0
    v_mov_b32 v158, 0
    v_mov_b32 v159, 0
    v_mov_b32 v160, 0
    v_mov_b32 v161, 0
    v_mov_b32 v162, 0
    v_mov_b32 v163, 0
    v_mov_b32 v164, 0
    v_mov_b32 v165, 0
    v_mov_b32 v166, 0
    v_mov_b32 v167, 0
    v_mov_b32 v168, 0
    v_mov_b32 v169, 0
    v_mov_b32 v170, 0
    v_mov_b32 v171, 0
    v_mov_b32 v172, 0
    v_mov_b32 v173, 0
    v_mov_b32 v174, 0
    v_mov_b32 v175, 0
    v_mov_b32 v176, 0
    v_mov_b32 v177, 0
    v_mov_b32 v178, 0
    v_mov_b32 v179, 0
    v_mov_b32 v180, 0
    v_mov_b32 v181, 0
    v_mov_b32 v182, 0
    v_mov_b32 v183, 0
    v_mov_b32 v184, 0
    v_mov_b32 v185, 0
    v_mov_b32 v186, 0
    v_mov_b32 v187, 0
    v_mov_b32 v188, 0
    v_mov_b32 v189, 0
    v_mov_b32 v190, 0
    v_mov_b32 v191, 0
    s_waitcnt lgkmcnt(0)
    s_barrier
    ds_read_b128 v[64:67], v16 offset:0
    ds_read_b64_tr_b16 v[80:81], v20 offset:0
    ds_read_b64_tr_b16 v[82:83], v20 offset:64
    ds_read_b64_tr_b16 v[84:85], v20 offset:2176
    ds_read_b64_tr_b16 v[86:87], v20 offset:2240
    ds_read_b64_tr_b16 v[88:89], v20 offset:4352
    ds_read_b64_tr_b16 v[90:91], v20 offset:4416
    ds_read_b64_tr_b16 v[92:93], v20 offset:6528
    ds_read_b64_tr_b16 v[94:95], v20 offset:6592
    ds_read_b128 v[68:71], v16 offset:2048
    ds_read_b128 v[72:75], v16 offset:4096
    ds_read_b128 v[76:79], v16 offset:6144
    s_waitcnt lgkmcnt(9)
    v_mfma_f32_16x16x32_bf16 v[128:131], v[64:67], v[80:83], v[128:131]
    ds_read_b128 v[96:99], v17 offset:0
    s_waitcnt lgkmcnt(8)
    v_mfma_f32_16x16x32_bf16 v[132:135], v[64:67], v[84:87], v[132:135]
    ds_read_b64_tr_b16 v[112:113], v20 offset:512
    s_waitcnt lgkmcnt(7)
    v_mfma_f32_16x16x32_bf16 v[136:139], v[64:67], v[88:91], v[136:139]
    ds_read_b64_tr_b16 v[114:115], v20 offset:576
    s_waitcnt lgkmcnt(6)
    v_mfma_f32_16x16x32_bf16 v[140:143], v[64:67], v[92:95], v[140:143]
    ds_read_b64_tr_b16 v[116:117], v20 offset:2688
    s_waitcnt lgkmcnt(6)
    v_mfma_f32_16x16x32_bf16 v[156:159], v[68:71], v[92:95], v[156:159]
    ds_read_b64_tr_b16 v[118:119], v20 offset:2752
    v_mfma_f32_16x16x32_bf16 v[152:155], v[68:71], v[88:91], v[152:155]
    ds_read_b64_tr_b16 v[120:121], v20 offset:4864
    v_mfma_f32_16x16x32_bf16 v[148:151], v[68:71], v[84:87], v[148:151]
    ds_read_b64_tr_b16 v[122:123], v20 offset:4928
    v_mfma_f32_16x16x32_bf16 v[144:147], v[68:71], v[80:83], v[144:147]
    ds_read_b64_tr_b16 v[124:125], v20 offset:7040
    s_waitcnt lgkmcnt(9)
    v_mfma_f32_16x16x32_bf16 v[160:163], v[72:75], v[80:83], v[160:163]
    ds_read_b64_tr_b16 v[126:127], v20 offset:7104
    v_mfma_f32_16x16x32_bf16 v[164:167], v[72:75], v[84:87], v[164:167]
    ds_read_b128 v[100:103], v17 offset:2048
    v_mfma_f32_16x16x32_bf16 v[168:171], v[72:75], v[88:91], v[168:171]
    ds_read_b128 v[104:107], v17 offset:4096
    v_mfma_f32_16x16x32_bf16 v[172:175], v[72:75], v[92:95], v[172:175]
    ds_read_b128 v[108:111], v17 offset:6144
    s_waitcnt lgkmcnt(12)
    v_mfma_f32_16x16x32_bf16 v[188:191], v[76:79], v[92:95], v[188:191]
    v_mfma_f32_16x16x32_bf16 v[184:187], v[76:79], v[88:91], v[184:187]
    v_mfma_f32_16x16x32_bf16 v[180:183], v[76:79], v[84:87], v[180:183]
    v_mfma_f32_16x16x32_bf16 v[176:179], v[76:79], v[80:83], v[176:179]
    s_waitcnt lgkmcnt(0)
    s_barrier
    v_mfma_f32_16x16x32_bf16 v[128:131], v[96:99], v[112:115], v[128:131]
    ds_read_b128 v[64:67], v16 offset:33792
    v_mfma_f32_16x16x32_bf16 v[132:135], v[96:99], v[116:119], v[132:135]
    ds_read_b64_tr_b16 v[80:81], v20 offset:33792
    v_mfma_f32_16x16x32_bf16 v[136:139], v[96:99], v[120:123], v[136:139]
    ds_read_b64_tr_b16 v[82:83], v20 offset:33856
    v_mfma_f32_16x16x32_bf16 v[140:143], v[96:99], v[124:127], v[140:143]
    ds_read_b64_tr_b16 v[84:85], v20 offset:35968
    v_mfma_f32_16x16x32_bf16 v[156:159], v[100:103], v[124:127], v[156:159]
    ds_read_b64_tr_b16 v[86:87], v20 offset:36032
    v_mfma_f32_16x16x32_bf16 v[152:155], v[100:103], v[120:123], v[152:155]
    ds_read_b64_tr_b16 v[88:89], v20 offset:38144
    v_mfma_f32_16x16x32_bf16 v[148:151], v[100:103], v[116:119], v[148:151]
    ds_read_b64_tr_b16 v[90:91], v20 offset:38208
    v_mfma_f32_16x16x32_bf16 v[144:147], v[100:103], v[112:115], v[144:147]
    ds_read_b64_tr_b16 v[92:93], v20 offset:40320
    v_mfma_f32_16x16x32_bf16 v[160:163], v[104:107], v[112:115], v[160:163]
    ds_read_b64_tr_b16 v[94:95], v20 offset:40384
    v_mfma_f32_16x16x32_bf16 v[164:167], v[104:107], v[116:119], v[164:167]
    ds_read_b128 v[68:71], v16 offset:35840
    v_mfma_f32_16x16x32_bf16 v[168:171], v[104:107], v[120:123], v[168:171]
    ds_read_b128 v[72:75], v16 offset:37888
    v_mfma_f32_16x16x32_bf16 v[172:175], v[104:107], v[124:127], v[172:175]
    ds_read_b128 v[76:79], v16 offset:39936
    v_mfma_f32_16x16x32_bf16 v[188:191], v[108:111], v[124:127], v[188:191]
    v_mfma_f32_16x16x32_bf16 v[184:187], v[108:111], v[120:123], v[184:187]
    v_mfma_f32_16x16x32_bf16 v[180:183], v[108:111], v[116:119], v[180:183]
    v_mfma_f32_16x16x32_bf16 v[176:179], v[108:111], v[112:115], v[176:179]
    s_waitcnt lgkmcnt(9)
    v_mfma_f32_16x16x32_bf16 v[128:131], v[64:67], v[80:83], v[128:131]
    ds_read_b128 v[96:99], v17 offset:33792
    s_waitcnt lgkmcnt(8)
    v_mfma_f32_16x16x32_bf16 v[132:135], v[64:67], v[84:87], v[132:135]
    ds_read_b64_tr_b16 v[112:113], v20 offset:34304
    s_waitcnt lgkmcnt(7)
    v_mfma_f32_16x16x32_bf16 v[136:139], v[64:67], v[88:91], v[136:139]
    ds_read_b64_tr_b16 v[114:115], v20 offset:34368
    s_waitcnt lgkmcnt(6)
    v_mfma_f32_16x16x32_bf16 v[140:143], v[64:67], v[92:95], v[140:143]
    ds_read_b64_tr_b16 v[116:117], v20 offset:36480
    s_waitcnt lgkmcnt(6)
    v_mfma_f32_16x16x32_bf16 v[156:159], v[68:71], v[92:95], v[156:159]
    ds_read_b64_tr_b16 v[118:119], v20 offset:36544
    v_mfma_f32_16x16x32_bf16 v[152:155], v[68:71], v[88:91], v[152:155]
    ds_read_b64_tr_b16 v[120:121], v20 offset:38656
    v_mfma_f32_16x16x32_bf16 v[148:151], v[68:71], v[84:87], v[148:151]
    ds_read_b64_tr_b16 v[122:123], v20 offset:38720
    v_mfma_f32_16x16x32_bf16 v[144:147], v[68:71], v[80:83], v[144:147]
    ds_read_b64_tr_b16 v[124:125], v20 offset:40832
    s_waitcnt lgkmcnt(9)
    v_mfma_f32_16x16x32_bf16 v[160:163], v[72:75], v[80:83], v[160:163]
    ds_read_b64_tr_b16 v[126:127], v20 offset:40896
    v_mfma_f32_16x16x32_bf16 v[164:167], v[72:75], v[84:87], v[164:167]
    ds_read_b128 v[100:103], v17 offset:35840
    v_mfma_f32_16x16x32_bf16 v[168:171], v[72:75], v[88:91], v[168:171]
    ds_read_b128 v[104:107], v17 offset:37888
    v_mfma_f32_16x16x32_bf16 v[172:175], v[72:75], v[92:95], v[172:175]
    ds_read_b128 v[108:111], v17 offset:39936
    s_waitcnt lgkmcnt(12)
    v_mfma_f32_16x16x32_bf16 v[188:191], v[76:79], v[92:95], v[188:191]
    v_mfma_f32_16x16x32_bf16 v[184:187], v[76:79], v[88:91], v[184:187]
    v_mfma_f32_16x16x32_bf16 v[180:183], v[76:79], v[84:87], v[180:183]
    v_mfma_f32_16x16x32_bf16 v[176:179], v[76:79], v[80:83], v[176:179]
    s_waitcnt lgkmcnt(0)
    s_barrier
    v_mfma_f32_16x16x32_bf16 v[128:131], v[96:99], v[112:115], v[128:131]
    ds_read_b128 v[64:67], v18 offset:0
    v_mfma_f32_16x16x32_bf16 v[132:135], v[96:99], v[116:119], v[132:135]
    ds_read_b64_tr_b16 v[80:81], v21 offset:0
    v_mfma_f32_16x16x32_bf16 v[136:139], v[96:99], v[120:123], v[136:139]
    ds_read_b64_tr_b16 v[82:83], v21 offset:64
    v_mfma_f32_16x16x32_bf16 v[140:143], v[96:99], v[124:127], v[140:143]
    ds_read_b64_tr_b16 v[84:85], v21 offset:2176
    v_mfma_f32_16x16x32_bf16 v[156:159], v[100:103], v[124:127], v[156:159]
    ds_read_b64_tr_b16 v[86:87], v21 offset:2240
    v_mfma_f32_16x16x32_bf16 v[152:155], v[100:103], v[120:123], v[152:155]
    ds_read_b64_tr_b16 v[88:89], v21 offset:4352
    v_mfma_f32_16x16x32_bf16 v[148:151], v[100:103], v[116:119], v[148:151]
    ds_read_b64_tr_b16 v[90:91], v21 offset:4416
    v_mfma_f32_16x16x32_bf16 v[144:147], v[100:103], v[112:115], v[144:147]
    ds_read_b64_tr_b16 v[92:93], v21 offset:6528
    v_mfma_f32_16x16x32_bf16 v[160:163], v[104:107], v[112:115], v[160:163]
    ds_read_b64_tr_b16 v[94:95], v21 offset:6592
    v_mfma_f32_16x16x32_bf16 v[164:167], v[104:107], v[116:119], v[164:167]
    ds_read_b128 v[68:71], v18 offset:2048
    v_mfma_f32_16x16x32_bf16 v[168:171], v[104:107], v[120:123], v[168:171]
    ds_read_b128 v[72:75], v18 offset:4096
    v_mfma_f32_16x16x32_bf16 v[172:175], v[104:107], v[124:127], v[172:175]
    ds_read_b128 v[76:79], v18 offset:6144
    v_mfma_f32_16x16x32_bf16 v[188:191], v[108:111], v[124:127], v[188:191]
    v_mfma_f32_16x16x32_bf16 v[184:187], v[108:111], v[120:123], v[184:187]
    v_mfma_f32_16x16x32_bf16 v[180:183], v[108:111], v[116:119], v[180:183]
    v_mfma_f32_16x16x32_bf16 v[176:179], v[108:111], v[112:115], v[176:179]
    s_waitcnt lgkmcnt(9)
    v_mfma_f32_16x16x32_bf16 v[128:131], v[64:67], v[80:83], v[128:131]
    ds_read_b128 v[96:99], v19 offset:0
    s_waitcnt lgkmcnt(8)
    v_mfma_f32_16x16x32_bf16 v[132:135], v[64:67], v[84:87], v[132:135]
    ds_read_b64_tr_b16 v[112:113], v21 offset:512
    s_waitcnt lgkmcnt(7)
    v_mfma_f32_16x16x32_bf16 v[136:139], v[64:67], v[88:91], v[136:139]
    ds_read_b64_tr_b16 v[114:115], v21 offset:576
    s_waitcnt lgkmcnt(6)
    v_mfma_f32_16x16x32_bf16 v[140:143], v[64:67], v[92:95], v[140:143]
    ds_read_b64_tr_b16 v[116:117], v21 offset:2688
    s_waitcnt lgkmcnt(6)
    v_mfma_f32_16x16x32_bf16 v[156:159], v[68:71], v[92:95], v[156:159]
    ds_read_b64_tr_b16 v[118:119], v21 offset:2752
    v_mfma_f32_16x16x32_bf16 v[152:155], v[68:71], v[88:91], v[152:155]
    ds_read_b64_tr_b16 v[120:121], v21 offset:4864
    v_mfma_f32_16x16x32_bf16 v[148:151], v[68:71], v[84:87], v[148:151]
    ds_read_b64_tr_b16 v[122:123], v21 offset:4928
    v_mfma_f32_16x16x32_bf16 v[144:147], v[68:71], v[80:83], v[144:147]
    ds_read_b64_tr_b16 v[124:125], v21 offset:7040
    s_waitcnt lgkmcnt(9)
    v_mfma_f32_16x16x32_bf16 v[160:163], v[72:75], v[80:83], v[160:163]
    ds_read_b64_tr_b16 v[126:127], v21 offset:7104
    v_mfma_f32_16x16x32_bf16 v[164:167], v[72:75], v[84:87], v[164:167]
    ds_read_b128 v[100:103], v19 offset:2048
    v_mfma_f32_16x16x32_bf16 v[168:171], v[72:75], v[88:91], v[168:171]
    ds_read_b128 v[104:107], v19 offset:4096
    v_mfma_f32_16x16x32_bf16 v[172:175], v[72:75], v[92:95], v[172:175]
    ds_read_b128 v[108:111], v19 offset:6144
    s_waitcnt lgkmcnt(12)
    v_mfma_f32_16x16x32_bf16 v[188:191], v[76:79], v[92:95], v[188:191]
    v_mfma_f32_16x16x32_bf16 v[184:187], v[76:79], v[88:91], v[184:187]
    v_mfma_f32_16x16x32_bf16 v[180:183], v[76:79], v[84:87], v[180:183]
    v_mfma_f32_16x16x32_bf16 v[176:179], v[76:79], v[80:83], v[176:179]
    s_waitcnt lgkmcnt(0)
    s_barrier
    v_mfma_f32_16x16x32_bf16 v[128:131], v[96:99], v[112:115], v[128:131]
    ds_read_b128 v[64:67], v18 offset:33792
    v_mfma_f32_16x16x32_bf16 v[132:135], v[96:99], v[116:119], v[132:135]
    ds_read_b64_tr_b16 v[80:81], v21 offset:33792
    v_mfma_f32_16x16x32_bf16 v[136:139], v[96:99], v[120:123], v[136:139]
    ds_read_b64_tr_b16 v[82:83], v21 offset:33856
    v_mfma_f32_16x16x32_bf16 v[140:143], v[96:99], v[124:127], v[140:143]
    ds_read_b64_tr_b16 v[84:85], v21 offset:35968
    v_mfma_f32_16x16x32_bf16 v[156:159], v[100:103], v[124:127], v[156:159]
    ds_read_b64_tr_b16 v[86:87], v21 offset:36032
    v_mfma_f32_16x16x32_bf16 v[152:155], v[100:103], v[120:123], v[152:155]
    ds_read_b64_tr_b16 v[88:89], v21 offset:38144
    v_mfma_f32_16x16x32_bf16 v[148:151], v[100:103], v[116:119], v[148:151]
    ds_read_b64_tr_b16 v[90:91], v21 offset:38208
    v_mfma_f32_16x16x32_bf16 v[144:147], v[100:103], v[112:115], v[144:147]
    ds_read_b64_tr_b16 v[92:93], v21 offset:40320
    v_mfma_f32_16x16x32_bf16 v[160:163], v[104:107], v[112:115], v[160:163]
    ds_read_b64_tr_b16 v[94:95], v21 offset:40384
    v_mfma_f32_16x16x32_bf16 v[164:167], v[104:107], v[116:119], v[164:167]
    ds_read_b128 v[68:71], v18 offset:35840
    v_mfma_f32_16x16x32_bf16 v[168:171], v[104:107], v[120:123], v[168:171]
    ds_read_b128 v[72:75], v18 offset:37888
    v_mfma_f32_16x16x32_bf16 v[172:175], v[104:107], v[124:127], v[172:175]
    ds_read_b128 v[76:79], v18 offset:39936
    v_mfma_f32_16x16x32_bf16 v[188:191], v[108:111], v[124:127], v[188:191]
    v_mfma_f32_16x16x32_bf16 v[184:187], v[108:111], v[120:123], v[184:187]
    v_mfma_f32_16x16x32_bf16 v[180:183], v[108:111], v[116:119], v[180:183]
    v_mfma_f32_16x16x32_bf16 v[176:179], v[108:111], v[112:115], v[176:179]
    s_waitcnt lgkmcnt(9)
    v_mfma_f32_16x16x32_bf16 v[128:131], v[64:67], v[80:83], v[128:131]
    ds_read_b128 v[96:99], v19 offset:33792
    s_waitcnt lgkmcnt(8)
    v_mfma_f32_16x16x32_bf16 v[132:135], v[64:67], v[84:87], v[132:135]
    ds_read_b64_tr_b16 v[112:113], v21 offset:34304
    s_waitcnt lgkmcnt(7)
    v_mfma_f32_16x16x32_bf16 v[136:139], v[64:67], v[88:91], v[136:139]
    ds_read_b64_tr_b16 v[114:115], v21 offset:34368
    s_waitcnt lgkmcnt(6)
    v_mfma_f32_16x16x32_bf16 v[140:143], v[64:67], v[92:95], v[140:143]
    ds_read_b64_tr_b16 v[116:117], v21 offset:36480
    s_waitcnt lgkmcnt(6)
    v_mfma_f32_16x16x32_bf16 v[156:159], v[68:71], v[92:95], v[156:159]
    ds_read_b64_tr_b16 v[118:119], v21 offset:36544
    v_mfma_f32_16x16x32_bf16 v[152:155], v[68:71], v[88:91], v[152:155]
    ds_read_b64_tr_b16 v[120:121], v21 offset:38656
    v_mfma_f32_16x16x32_bf16 v[148:151], v[68:71], v[84:87], v[148:151]
    ds_read_b64_tr_b16 v[122:123], v21 offset:38720
    v_mfma_f32_16x16x32_bf16 v[144:147], v[68:71], v[80:83], v[144:147]
    ds_read_b64_tr_b16 v[124:125], v21 offset:40832
    s_waitcnt lgkmcnt(9)
    v_mfma_f32_16x16x32_bf16 v[160:163], v[72:75], v[80:83], v[160:163]
    ds_read_b64_tr_b16 v[126:127], v21 offset:40896
    v_mfma_f32_16x16x32_bf16 v[164:167], v[72:75], v[84:87], v[164:167]
    ds_read_b128 v[100:103], v19 offset:35840
    v_mfma_f32_16x16x32_bf16 v[168:171], v[72:75], v[88:91], v[168:171]
    ds_read_b128 v[104:107], v19 offset:37888
    v_mfma_f32_16x16x32_bf16 v[172:175], v[72:75], v[92:95], v[172:175]
    ds_read_b128 v[108:111], v19 offset:39936
    s_waitcnt lgkmcnt(12)
    v_mfma_f32_16x16x32_bf16 v[188:191], v[76:79], v[92:95], v[188:191]
    v_mfma_f32_16x16x32_bf16 v[184:187], v[76:79], v[88:91], v[184:187]
    v_mfma_f32_16x16x32_bf16 v[180:183], v[76:79], v[84:87], v[180:183]
    v_mfma_f32_16x16x32_bf16 v[176:179], v[76:79], v[80:83], v[176:179]
    s_waitcnt lgkmcnt(0)
    s_barrier
    v_mfma_f32_16x16x32_bf16 v[128:131], v[96:99], v[112:115], v[128:131]
    ds_read_b128 v[64:67], v16 offset:0
    v_mfma_f32_16x16x32_bf16 v[132:135], v[96:99], v[116:119], v[132:135]
    ds_read_b64_tr_b16 v[80:81], v20 offset:0
    v_mfma_f32_16x16x32_bf16 v[136:139], v[96:99], v[120:123], v[136:139]
    ds_read_b64_tr_b16 v[82:83], v20 offset:64
    v_mfma_f32_16x16x32_bf16 v[140:143], v[96:99], v[124:127], v[140:143]
    ds_read_b64_tr_b16 v[84:85], v20 offset:2176
    v_mfma_f32_16x16x32_bf16 v[156:159], v[100:103], v[124:127], v[156:159]
    ds_read_b64_tr_b16 v[86:87], v20 offset:2240
    v_mfma_f32_16x16x32_bf16 v[152:155], v[100:103], v[120:123], v[152:155]
    ds_read_b64_tr_b16 v[88:89], v20 offset:4352
    v_mfma_f32_16x16x32_bf16 v[148:151], v[100:103], v[116:119], v[148:151]
    ds_read_b64_tr_b16 v[90:91], v20 offset:4416
    v_mfma_f32_16x16x32_bf16 v[144:147], v[100:103], v[112:115], v[144:147]
    ds_read_b64_tr_b16 v[92:93], v20 offset:6528
    v_mfma_f32_16x16x32_bf16 v[160:163], v[104:107], v[112:115], v[160:163]
    ds_read_b64_tr_b16 v[94:95], v20 offset:6592
    v_mfma_f32_16x16x32_bf16 v[164:167], v[104:107], v[116:119], v[164:167]
    ds_read_b128 v[68:71], v16 offset:2048
    v_mfma_f32_16x16x32_bf16 v[168:171], v[104:107], v[120:123], v[168:171]
    ds_read_b128 v[72:75], v16 offset:4096
    v_mfma_f32_16x16x32_bf16 v[172:175], v[104:107], v[124:127], v[172:175]
    ds_read_b128 v[76:79], v16 offset:6144
    v_mfma_f32_16x16x32_bf16 v[188:191], v[108:111], v[124:127], v[188:191]
    v_mfma_f32_16x16x32_bf16 v[184:187], v[108:111], v[120:123], v[184:187]
    v_mfma_f32_16x16x32_bf16 v[180:183], v[108:111], v[116:119], v[180:183]
    v_mfma_f32_16x16x32_bf16 v[176:179], v[108:111], v[112:115], v[176:179]
    s_waitcnt vmcnt(1)
    v_mov_b32 v30, 0
    s_mov_b64 s[56:57], exec
    s_mov_b64 exec, 1
    buffer_store_dword v15, v30, s[44:47], s99 offen offset:128 sc1
    s_mov_b64 exec, s[56:57]
    s_waitcnt lgkmcnt(9)
    v_mfma_f32_16x16x32_bf16 v[128:131], v[64:67], v[80:83], v[128:131]
    ds_read_b128 v[96:99], v17 offset:0
    s_waitcnt lgkmcnt(8)
    v_mfma_f32_16x16x32_bf16 v[132:135], v[64:67], v[84:87], v[132:135]
    ds_read_b64_tr_b16 v[112:113], v20 offset:512
    s_waitcnt lgkmcnt(7)
    v_mfma_f32_16x16x32_bf16 v[136:139], v[64:67], v[88:91], v[136:139]
    ds_read_b64_tr_b16 v[114:115], v20 offset:576
    s_waitcnt lgkmcnt(6)
    v_mfma_f32_16x16x32_bf16 v[140:143], v[64:67], v[92:95], v[140:143]
    ds_read_b64_tr_b16 v[116:117], v20 offset:2688
    s_waitcnt lgkmcnt(6)
    v_mfma_f32_16x16x32_bf16 v[156:159], v[68:71], v[92:95], v[156:159]
    ds_read_b64_tr_b16 v[118:119], v20 offset:2752
    v_mfma_f32_16x16x32_bf16 v[152:155], v[68:71], v[88:91], v[152:155]
    ds_read_b64_tr_b16 v[120:121], v20 offset:4864
    v_mfma_f32_16x16x32_bf16 v[148:151], v[68:71], v[84:87], v[148:151]
    ds_read_b64_tr_b16 v[122:123], v20 offset:4928
    v_mfma_f32_16x16x32_bf16 v[144:147], v[68:71], v[80:83], v[144:147]
    ds_read_b64_tr_b16 v[124:125], v20 offset:7040
    s_waitcnt lgkmcnt(9)
    v_mfma_f32_16x16x32_bf16 v[160:163], v[72:75], v[80:83], v[160:163]
    ds_read_b64_tr_b16 v[126:127], v20 offset:7104
    v_mfma_f32_16x16x32_bf16 v[164:167], v[72:75], v[84:87], v[164:167]
    ds_read_b128 v[100:103], v17 offset:2048
    v_mfma_f32_16x16x32_bf16 v[168:171], v[72:75], v[88:91], v[168:171]
    ds_read_b128 v[104:107], v17 offset:4096
    v_mfma_f32_16x16x32_bf16 v[172:175], v[72:75], v[92:95], v[172:175]
    ds_read_b128 v[108:111], v17 offset:6144
    s_waitcnt lgkmcnt(12)
    v_mfma_f32_16x16x32_bf16 v[188:191], v[76:79], v[92:95], v[188:191]
    v_mfma_f32_16x16x32_bf16 v[184:187], v[76:79], v[88:91], v[184:187]
    v_mfma_f32_16x16x32_bf16 v[180:183], v[76:79], v[84:87], v[180:183]
    v_mfma_f32_16x16x32_bf16 v[176:179], v[76:79], v[80:83], v[176:179]
    s_waitcnt lgkmcnt(0)
    s_barrier
    v_mfma_f32_16x16x32_bf16 v[128:131], v[96:99], v[112:115], v[128:131]
    ds_read_b128 v[64:67], v16 offset:33792
    v_mfma_f32_16x16x32_bf16 v[132:135], v[96:99], v[116:119], v[132:135]
    ds_read_b64_tr_b16 v[80:81], v20 offset:33792
    v_mfma_f32_16x16x32_bf16 v[136:139], v[96:99], v[120:123], v[136:139]
    ds_read_b64_tr_b16 v[82:83], v20 offset:33856
    v_mfma_f32_16x16x32_bf16 v[140:143], v[96:99], v[124:127], v[140:143]
    ds_read_b64_tr_b16 v[84:85], v20 offset:35968
    v_mfma_f32_16x16x32_bf16 v[156:159], v[100:103], v[124:127], v[156:159]
    ds_read_b64_tr_b16 v[86:87], v20 offset:36032
    v_mfma_f32_16x16x32_bf16 v[152:155], v[100:103], v[120:123], v[152:155]
    ds_read_b64_tr_b16 v[88:89], v20 offset:38144
    v_mfma_f32_16x16x32_bf16 v[148:151], v[100:103], v[116:119], v[148:151]
    ds_read_b64_tr_b16 v[90:91], v20 offset:38208
    v_mfma_f32_16x16x32_bf16 v[144:147], v[100:103], v[112:115], v[144:147]
    ds_read_b64_tr_b16 v[92:93], v20 offset:40320
    v_mfma_f32_16x16x32_bf16 v[160:163], v[104:107], v[112:115], v[160:163]
    ds_read_b64_tr_b16 v[94:95], v20 offset:40384
    v_mfma_f32_16x16x32_bf16 v[164:167], v[104:107], v[116:119], v[164:167]
    ds_read_b128 v[68:71], v16 offset:35840
    v_mfma_f32_16x16x32_bf16 v[168:171], v[104:107], v[120:123], v[168:171]
    ds_read_b128 v[72:75], v16 offset:37888
    v_mfma_f32_16x16x32_bf16 v[172:175], v[104:107], v[124:127], v[172:175]
    ds_read_b128 v[76:79], v16 offset:39936
    v_mfma_f32_16x16x32_bf16 v[188:191], v[108:111], v[124:127], v[188:191]
    v_mfma_f32_16x16x32_bf16 v[184:187], v[108:111], v[120:123], v[184:187]
    v_mfma_f32_16x16x32_bf16 v[180:183], v[108:111], v[116:119], v[180:183]
    v_mfma_f32_16x16x32_bf16 v[176:179], v[108:111], v[112:115], v[176:179]
    s_waitcnt lgkmcnt(9)
    v_mfma_f32_16x16x32_bf16 v[128:131], v[64:67], v[80:83], v[128:131]
    ds_read_b128 v[96:99], v17 offset:33792
    s_waitcnt lgkmcnt(8)
    v_mfma_f32_16x16x32_bf16 v[132:135], v[64:67], v[84:87], v[132:135]
    ds_read_b64_tr_b16 v[112:113], v20 offset:34304
    s_waitcnt lgkmcnt(7)
    v_mfma_f32_16x16x32_bf16 v[136:139], v[64:67], v[88:91], v[136:139]
    ds_read_b64_tr_b16 v[114:115], v20 offset:34368
    s_waitcnt lgkmcnt(6)
    v_mfma_f32_16x16x32_bf16 v[140:143], v[64:67], v[92:95], v[140:143]
    ds_read_b64_tr_b16 v[116:117], v20 offset:36480
    s_waitcnt lgkmcnt(6)
    v_mfma_f32_16x16x32_bf16 v[156:159], v[68:71], v[92:95], v[156:159]
    ds_read_b64_tr_b16 v[118:119], v20 offset:36544
    v_mfma_f32_16x16x32_bf16 v[152:155], v[68:71], v[88:91], v[152:155]
    ds_read_b64_tr_b16 v[120:121], v20 offset:38656
    v_mfma_f32_16x16x32_bf16 v[148:151], v[68:71], v[84:87], v[148:151]
    ds_read_b64_tr_b16 v[122:123], v20 offset:38720
    v_mfma_f32_16x16x32_bf16 v[144:147], v[68:71], v[80:83], v[144:147]
    ds_read_b64_tr_b16 v[124:125], v20 offset:40832
    s_waitcnt lgkmcnt(9)
    v_mfma_f32_16x16x32_bf16 v[160:163], v[72:75], v[80:83], v[160:163]
    ds_read_b64_tr_b16 v[126:127], v20 offset:40896
    v_mfma_f32_16x16x32_bf16 v[164:167], v[72:75], v[84:87], v[164:167]
    ds_read_b128 v[100:103], v17 offset:35840
    v_mfma_f32_16x16x32_bf16 v[168:171], v[72:75], v[88:91], v[168:171]
    ds_read_b128 v[104:107], v17 offset:37888
    v_mfma_f32_16x16x32_bf16 v[172:175], v[72:75], v[92:95], v[172:175]
    ds_read_b128 v[108:111], v17 offset:39936
    s_waitcnt lgkmcnt(12)
    v_mfma_f32_16x16x32_bf16 v[188:191], v[76:79], v[92:95], v[188:191]
    v_mfma_f32_16x16x32_bf16 v[184:187], v[76:79], v[88:91], v[184:187]
    v_mfma_f32_16x16x32_bf16 v[180:183], v[76:79], v[84:87], v[180:183]
    v_mfma_f32_16x16x32_bf16 v[176:179], v[76:79], v[80:83], v[176:179]
    s_waitcnt lgkmcnt(0)
    s_barrier
    v_mfma_f32_16x16x32_bf16 v[128:131], v[96:99], v[112:115], v[128:131]
    ds_read_b128 v[64:67], v18 offset:0
    v_mfma_f32_16x16x32_bf16 v[132:135], v[96:99], v[116:119], v[132:135]
    ds_read_b64_tr_b16 v[80:81], v21 offset:0
    v_mfma_f32_16x16x32_bf16 v[136:139], v[96:99], v[120:123], v[136:139]
    ds_read_b64_tr_b16 v[82:83], v21 offset:64
    v_mfma_f32_16x16x32_bf16 v[140:143], v[96:99], v[124:127], v[140:143]
    ds_read_b64_tr_b16 v[84:85], v21 offset:2176
    v_mfma_f32_16x16x32_bf16 v[156:159], v[100:103], v[124:127], v[156:159]
    ds_read_b64_tr_b16 v[86:87], v21 offset:2240
    v_mfma_f32_16x16x32_bf16 v[152:155], v[100:103], v[120:123], v[152:155]
    ds_read_b64_tr_b16 v[88:89], v21 offset:4352
    v_mfma_f32_16x16x32_bf16 v[148:151], v[100:103], v[116:119], v[148:151]
    ds_read_b64_tr_b16 v[90:91], v21 offset:4416
    v_mfma_f32_16x16x32_bf16 v[144:147], v[100:103], v[112:115], v[144:147]
    ds_read_b64_tr_b16 v[92:93], v21 offset:6528
    v_mfma_f32_16x16x32_bf16 v[160:163], v[104:107], v[112:115], v[160:163]
    ds_read_b64_tr_b16 v[94:95], v21 offset:6592
    v_mfma_f32_16x16x32_bf16 v[164:167], v[104:107], v[116:119], v[164:167]
    ds_read_b128 v[68:71], v18 offset:2048
    v_mfma_f32_16x16x32_bf16 v[168:171], v[104:107], v[120:123], v[168:171]
    ds_read_b128 v[72:75], v18 offset:4096
    v_mfma_f32_16x16x32_bf16 v[172:175], v[104:107], v[124:127], v[172:175]
    ds_read_b128 v[76:79], v18 offset:6144
    v_mfma_f32_16x16x32_bf16 v[188:191], v[108:111], v[124:127], v[188:191]
    v_mfma_f32_16x16x32_bf16 v[184:187], v[108:111], v[120:123], v[184:187]
    v_mfma_f32_16x16x32_bf16 v[180:183], v[108:111], v[116:119], v[180:183]
    v_mfma_f32_16x16x32_bf16 v[176:179], v[108:111], v[112:115], v[176:179]
    s_waitcnt lgkmcnt(9)
    v_mfma_f32_16x16x32_bf16 v[128:131], v[64:67], v[80:83], v[128:131]
    ds_read_b128 v[96:99], v19 offset:0
    s_waitcnt lgkmcnt(8)
    v_mfma_f32_16x16x32_bf16 v[132:135], v[64:67], v[84:87], v[132:135]
    ds_read_b64_tr_b16 v[112:113], v21 offset:512
    s_waitcnt lgkmcnt(7)
    v_mfma_f32_16x16x32_bf16 v[136:139], v[64:67], v[88:91], v[136:139]
    ds_read_b64_tr_b16 v[114:115], v21 offset:576
    s_waitcnt lgkmcnt(6)
    v_mfma_f32_16x16x32_bf16 v[140:143], v[64:67], v[92:95], v[140:143]
    ds_read_b64_tr_b16 v[116:117], v21 offset:2688
    s_waitcnt lgkmcnt(6)
    v_mfma_f32_16x16x32_bf16 v[156:159], v[68:71], v[92:95], v[156:159]
    ds_read_b64_tr_b16 v[118:119], v21 offset:2752
    v_mfma_f32_16x16x32_bf16 v[152:155], v[68:71], v[88:91], v[152:155]
    ds_read_b64_tr_b16 v[120:121], v21 offset:4864
    v_mfma_f32_16x16x32_bf16 v[148:151], v[68:71], v[84:87], v[148:151]
    ds_read_b64_tr_b16 v[122:123], v21 offset:4928
    v_mfma_f32_16x16x32_bf16 v[144:147], v[68:71], v[80:83], v[144:147]
    ds_read_b64_tr_b16 v[124:125], v21 offset:7040
    s_waitcnt lgkmcnt(9)
    v_mfma_f32_16x16x32_bf16 v[160:163], v[72:75], v[80:83], v[160:163]
    ds_read_b64_tr_b16 v[126:127], v21 offset:7104
    v_mfma_f32_16x16x32_bf16 v[164:167], v[72:75], v[84:87], v[164:167]
    ds_read_b128 v[100:103], v19 offset:2048
    v_mfma_f32_16x16x32_bf16 v[168:171], v[72:75], v[88:91], v[168:171]
    ds_read_b128 v[104:107], v19 offset:4096
    v_mfma_f32_16x16x32_bf16 v[172:175], v[72:75], v[92:95], v[172:175]
    ds_read_b128 v[108:111], v19 offset:6144
    s_waitcnt lgkmcnt(12)
    v_mfma_f32_16x16x32_bf16 v[188:191], v[76:79], v[92:95], v[188:191]
    v_mfma_f32_16x16x32_bf16 v[184:187], v[76:79], v[88:91], v[184:187]
    v_mfma_f32_16x16x32_bf16 v[180:183], v[76:79], v[84:87], v[180:183]
    v_mfma_f32_16x16x32_bf16 v[176:179], v[76:79], v[80:83], v[176:179]
    s_waitcnt lgkmcnt(0)
    s_barrier
    v_mfma_f32_16x16x32_bf16 v[128:131], v[96:99], v[112:115], v[128:131]
    ds_read_b128 v[64:67], v18 offset:33792
    v_mfma_f32_16x16x32_bf16 v[132:135], v[96:99], v[116:119], v[132:135]
    ds_read_b64_tr_b16 v[80:81], v21 offset:33792
    v_mfma_f32_16x16x32_bf16 v[136:139], v[96:99], v[120:123], v[136:139]
    ds_read_b64_tr_b16 v[82:83], v21 offset:33856
    v_mfma_f32_16x16x32_bf16 v[140:143], v[96:99], v[124:127], v[140:143]
    ds_read_b64_tr_b16 v[84:85], v21 offset:35968
    v_mfma_f32_16x16x32_bf16 v[156:159], v[100:103], v[124:127], v[156:159]
    ds_read_b64_tr_b16 v[86:87], v21 offset:36032
    v_mfma_f32_16x16x32_bf16 v[152:155], v[100:103], v[120:123], v[152:155]
    ds_read_b64_tr_b16 v[88:89], v21 offset:38144
    v_mfma_f32_16x16x32_bf16 v[148:151], v[100:103], v[116:119], v[148:151]
    ds_read_b64_tr_b16 v[90:91], v21 offset:38208
    v_mfma_f32_16x16x32_bf16 v[144:147], v[100:103], v[112:115], v[144:147]
    ds_read_b64_tr_b16 v[92:93], v21 offset:40320
    v_mfma_f32_16x16x32_bf16 v[160:163], v[104:107], v[112:115], v[160:163]
    ds_read_b64_tr_b16 v[94:95], v21 offset:40384
    v_mfma_f32_16x16x32_bf16 v[164:167], v[104:107], v[116:119], v[164:167]
    ds_read_b128 v[68:71], v18 offset:35840
    v_mfma_f32_16x16x32_bf16 v[168:171], v[104:107], v[120:123], v[168:171]
    ds_read_b128 v[72:75], v18 offset:37888
    v_mfma_f32_16x16x32_bf16 v[172:175], v[104:107], v[124:127], v[172:175]
    ds_read_b128 v[76:79], v18 offset:39936
    v_mfma_f32_16x16x32_bf16 v[188:191], v[108:111], v[124:127], v[188:191]
    v_mfma_f32_16x16x32_bf16 v[184:187], v[108:111], v[120:123], v[184:187]
    v_mfma_f32_16x16x32_bf16 v[180:183], v[108:111], v[116:119], v[180:183]
    v_mfma_f32_16x16x32_bf16 v[176:179], v[108:111], v[112:115], v[176:179]
    s_waitcnt lgkmcnt(9)
    v_mfma_f32_16x16x32_bf16 v[128:131], v[64:67], v[80:83], v[128:131]
    ds_read_b128 v[96:99], v19 offset:33792
    s_waitcnt lgkmcnt(8)
    v_mfma_f32_16x16x32_bf16 v[132:135], v[64:67], v[84:87], v[132:135]
    ds_read_b64_tr_b16 v[112:113], v21 offset:34304
    s_waitcnt lgkmcnt(7)
    v_mfma_f32_16x16x32_bf16 v[136:139], v[64:67], v[88:91], v[136:139]
    ds_read_b64_tr_b16 v[114:115], v21 offset:34368
    s_waitcnt lgkmcnt(6)
    v_mfma_f32_16x16x32_bf16 v[140:143], v[64:67], v[92:95], v[140:143]
    ds_read_b64_tr_b16 v[116:117], v21 offset:36480
    s_waitcnt lgkmcnt(6)
    v_mfma_f32_16x16x32_bf16 v[156:159], v[68:71], v[92:95], v[156:159]
    ds_read_b64_tr_b16 v[118:119], v21 offset:36544
    v_mfma_f32_16x16x32_bf16 v[152:155], v[68:71], v[88:91], v[152:155]
    ds_read_b64_tr_b16 v[120:121], v21 offset:38656
    v_mfma_f32_16x16x32_bf16 v[148:151], v[68:71], v[84:87], v[148:151]
    ds_read_b64_tr_b16 v[122:123], v21 offset:38720
    v_mfma_f32_16x16x32_bf16 v[144:147], v[68:71], v[80:83], v[144:147]
    ds_read_b64_tr_b16 v[124:125], v21 offset:40832
    s_waitcnt lgkmcnt(9)
    v_mfma_f32_16x16x32_bf16 v[160:163], v[72:75], v[80:83], v[160:163]
    ds_read_b64_tr_b16 v[126:127], v21 offset:40896
    v_mfma_f32_16x16x32_bf16 v[164:167], v[72:75], v[84:87], v[164:167]
    ds_read_b128 v[100:103], v19 offset:35840
    v_mfma_f32_16x16x32_bf16 v[168:171], v[72:75], v[88:91], v[168:171]
    ds_read_b128 v[104:107], v19 offset:37888
    v_mfma_f32_16x16x32_bf16 v[172:175], v[72:75], v[92:95], v[172:175]
    ds_read_b128 v[108:111], v19 offset:39936
    s_waitcnt lgkmcnt(12)
    v_mfma_f32_16x16x32_bf16 v[188:191], v[76:79], v[92:95], v[188:191]
    v_mfma_f32_16x16x32_bf16 v[184:187], v[76:79], v[88:91], v[184:187]
    v_mfma_f32_16x16x32_bf16 v[180:183], v[76:79], v[84:87], v[180:183]
    v_mfma_f32_16x16x32_bf16 v[176:179], v[76:79], v[80:83], v[176:179]
    s_waitcnt lgkmcnt(0)
    s_barrier
    v_mfma_f32_16x16x32_bf16 v[128:131], v[96:99], v[112:115], v[128:131]
    ds_read_b128 v[64:67], v16 offset:0
    v_mfma_f32_16x16x32_bf16 v[132:135], v[96:99], v[116:119], v[132:135]
    ds_read_b64_tr_b16 v[80:81], v20 offset:0
    v_mfma_f32_16x16x32_bf16 v[136:139], v[96:99], v[120:123], v[136:139]
    ds_read_b64_tr_b16 v[82:83], v20 offset:64
    v_mfma_f32_16x16x32_bf16 v[140:143], v[96:99], v[124:127], v[140:143]
    ds_read_b64_tr_b16 v[84:85], v20 offset:2176
    v_mfma_f32_16x16x32_bf16 v[156:159], v[100:103], v[124:127], v[156:159]
    ds_read_b64_tr_b16 v[86:87], v20 offset:2240
    v_mfma_f32_16x16x32_bf16 v[152:155], v[100:103], v[120:123], v[152:155]
    ds_read_b64_tr_b16 v[88:89], v20 offset:4352
    v_mfma_f32_16x16x32_bf16 v[148:151], v[100:103], v[116:119], v[148:151]
    ds_read_b64_tr_b16 v[90:91], v20 offset:4416
    v_mfma_f32_16x16x32_bf16 v[144:147], v[100:103], v[112:115], v[144:147]
    ds_read_b64_tr_b16 v[92:93], v20 offset:6528
    v_mfma_f32_16x16x32_bf16 v[160:163], v[104:107], v[112:115], v[160:163]
    ds_read_b64_tr_b16 v[94:95], v20 offset:6592
    v_mfma_f32_16x16x32_bf16 v[164:167], v[104:107], v[116:119], v[164:167]
    ds_read_b128 v[68:71], v16 offset:2048
    v_mfma_f32_16x16x32_bf16 v[168:171], v[104:107], v[120:123], v[168:171]
    ds_read_b128 v[72:75], v16 offset:4096
    v_mfma_f32_16x16x32_bf16 v[172:175], v[104:107], v[124:127], v[172:175]
    ds_read_b128 v[76:79], v16 offset:6144
    v_mfma_f32_16x16x32_bf16 v[188:191], v[108:111], v[124:127], v[188:191]
    v_mfma_f32_16x16x32_bf16 v[184:187], v[108:111], v[120:123], v[184:187]
    v_mfma_f32_16x16x32_bf16 v[180:183], v[108:111], v[116:119], v[180:183]
    v_mfma_f32_16x16x32_bf16 v[176:179], v[108:111], v[112:115], v[176:179]
    s_waitcnt lgkmcnt(9)
    v_mfma_f32_16x16x32_bf16 v[128:131], v[64:67], v[80:83], v[128:131]
    ds_read_b128 v[96:99], v17 offset:0
    s_waitcnt lgkmcnt(8)
    v_mfma_f32_16x16x32_bf16 v[132:135], v[64:67], v[84:87], v[132:135]
    ds_read_b64_tr_b16 v[112:113], v20 offset:512
    s_waitcnt lgkmcnt(7)
    v_mfma_f32_16x16x32_bf16 v[136:139], v[64:67], v[88:91], v[136:139]
    ds_read_b64_tr_b16 v[114:115], v20 offset:576
    s_waitcnt lgkmcnt(6)
    v_mfma_f32_16x16x32_bf16 v[140:143], v[64:67], v[92:95], v[140:143]
    ds_read_b64_tr_b16 v[116:117], v20 offset:2688
    s_waitcnt lgkmcnt(6)
    v_mfma_f32_16x16x32_bf16 v[156:159], v[68:71], v[92:95], v[156:159]
    ds_read_b64_tr_b16 v[118:119], v20 offset:2752
    v_mfma_f32_16x16x32_bf16 v[152:155], v[68:71], v[88:91], v[152:155]
    ds_read_b64_tr_b16 v[120:121], v20 offset:4864
    v_mfma_f32_16x16x32_bf16 v[148:151], v[68:71], v[84:87], v[148:151]
    ds_read_b64_tr_b16 v[122:123], v20 offset:4928
    v_mfma_f32_16x16x32_bf16 v[144:147], v[68:71], v[80:83], v[144:147]
    ds_read_b64_tr_b16 v[124:125], v20 offset:7040
    s_waitcnt lgkmcnt(9)
    v_mfma_f32_16x16x32_bf16 v[160:163], v[72:75], v[80:83], v[160:163]
    ds_read_b64_tr_b16 v[126:127], v20 offset:7104
    v_mfma_f32_16x16x32_bf16 v[164:167], v[72:75], v[84:87], v[164:167]
    ds_read_b128 v[100:103], v17 offset:2048
    v_mfma_f32_16x16x32_bf16 v[168:171], v[72:75], v[88:91], v[168:171]
    ds_read_b128 v[104:107], v17 offset:4096
    v_mfma_f32_16x16x32_bf16 v[172:175], v[72:75], v[92:95], v[172:175]
    ds_read_b128 v[108:111], v17 offset:6144
    s_waitcnt lgkmcnt(12)
    v_mfma_f32_16x16x32_bf16 v[188:191], v[76:79], v[92:95], v[188:191]
    v_mfma_f32_16x16x32_bf16 v[184:187], v[76:79], v[88:91], v[184:187]
    v_mfma_f32_16x16x32_bf16 v[180:183], v[76:79], v[84:87], v[180:183]
    v_mfma_f32_16x16x32_bf16 v[176:179], v[76:79], v[80:83], v[176:179]
    s_waitcnt lgkmcnt(0)
    s_barrier
    v_mfma_f32_16x16x32_bf16 v[128:131], v[96:99], v[112:115], v[128:131]
    ds_read_b128 v[64:67], v16 offset:33792
    v_mfma_f32_16x16x32_bf16 v[132:135], v[96:99], v[116:119], v[132:135]
    ds_read_b64_tr_b16 v[80:81], v20 offset:33792
    v_mfma_f32_16x16x32_bf16 v[136:139], v[96:99], v[120:123], v[136:139]
    ds_read_b64_tr_b16 v[82:83], v20 offset:33856
    v_mfma_f32_16x16x32_bf16 v[140:143], v[96:99], v[124:127], v[140:143]
    ds_read_b64_tr_b16 v[84:85], v20 offset:35968
    v_mfma_f32_16x16x32_bf16 v[156:159], v[100:103], v[124:127], v[156:159]
    ds_read_b64_tr_b16 v[86:87], v20 offset:36032
    v_mfma_f32_16x16x32_bf16 v[152:155], v[100:103], v[120:123], v[152:155]
    ds_read_b64_tr_b16 v[88:89], v20 offset:38144
    v_mfma_f32_16x16x32_bf16 v[148:151], v[100:103], v[116:119], v[148:151]
    ds_read_b64_tr_b16 v[90:91], v20 offset:38208
    v_mfma_f32_16x16x32_bf16 v[144:147], v[100:103], v[112:115], v[144:147]
    ds_read_b64_tr_b16 v[92:93], v20 offset:40320
    v_mfma_f32_16x16x32_bf16 v[160:163], v[104:107], v[112:115], v[160:163]
    ds_read_b64_tr_b16 v[94:95], v20 offset:40384
    v_mfma_f32_16x16x32_bf16 v[164:167], v[104:107], v[116:119], v[164:167]
    ds_read_b128 v[68:71], v16 offset:35840
    v_mfma_f32_16x16x32_bf16 v[168:171], v[104:107], v[120:123], v[168:171]
    ds_read_b128 v[72:75], v16 offset:37888
    v_mfma_f32_16x16x32_bf16 v[172:175], v[104:107], v[124:127], v[172:175]
    ds_read_b128 v[76:79], v16 offset:39936
    v_mfma_f32_16x16x32_bf16 v[188:191], v[108:111], v[124:127], v[188:191]
    v_mfma_f32_16x16x32_bf16 v[184:187], v[108:111], v[120:123], v[184:187]
    v_mfma_f32_16x16x32_bf16 v[180:183], v[108:111], v[116:119], v[180:183]
    v_mfma_f32_16x16x32_bf16 v[176:179], v[108:111], v[112:115], v[176:179]
    s_waitcnt lgkmcnt(9)
    v_mfma_f32_16x16x32_bf16 v[128:131], v[64:67], v[80:83], v[128:131]
    ds_read_b128 v[96:99], v17 offset:33792
    s_waitcnt lgkmcnt(8)
    v_mfma_f32_16x16x32_bf16 v[132:135], v[64:67], v[84:87], v[132:135]
    ds_read_b64_tr_b16 v[112:113], v20 offset:34304
    s_waitcnt lgkmcnt(7)
    v_mfma_f32_16x16x32_bf16 v[136:139], v[64:67], v[88:91], v[136:139]
    ds_read_b64_tr_b16 v[114:115], v20 offset:34368
    s_waitcnt lgkmcnt(6)
    v_mfma_f32_16x16x32_bf16 v[140:143], v[64:67], v[92:95], v[140:143]
    ds_read_b64_tr_b16 v[116:117], v20 offset:36480
    s_waitcnt lgkmcnt(6)
    v_mfma_f32_16x16x32_bf16 v[156:159], v[68:71], v[92:95], v[156:159]
    ds_read_b64_tr_b16 v[118:119], v20 offset:36544
    v_mfma_f32_16x16x32_bf16 v[152:155], v[68:71], v[88:91], v[152:155]
    ds_read_b64_tr_b16 v[120:121], v20 offset:38656
    v_mfma_f32_16x16x32_bf16 v[148:151], v[68:71], v[84:87], v[148:151]
    ds_read_b64_tr_b16 v[122:123], v20 offset:38720
    v_mfma_f32_16x16x32_bf16 v[144:147], v[68:71], v[80:83], v[144:147]
    ds_read_b64_tr_b16 v[124:125], v20 offset:40832
    s_waitcnt lgkmcnt(9)
    v_mfma_f32_16x16x32_bf16 v[160:163], v[72:75], v[80:83], v[160:163]
    ds_read_b64_tr_b16 v[126:127], v20 offset:40896
    v_mfma_f32_16x16x32_bf16 v[164:167], v[72:75], v[84:87], v[164:167]
    ds_read_b128 v[100:103], v17 offset:35840
    v_mfma_f32_16x16x32_bf16 v[168:171], v[72:75], v[88:91], v[168:171]
    ds_read_b128 v[104:107], v17 offset:37888
    v_mfma_f32_16x16x32_bf16 v[172:175], v[72:75], v[92:95], v[172:175]
    ds_read_b128 v[108:111], v17 offset:39936
    s_waitcnt lgkmcnt(12)
    v_mfma_f32_16x16x32_bf16 v[188:191], v[76:79], v[92:95], v[188:191]
    v_mfma_f32_16x16x32_bf16 v[184:187], v[76:79], v[88:91], v[184:187]
    v_mfma_f32_16x16x32_bf16 v[180:183], v[76:79], v[84:87], v[180:183]
    v_mfma_f32_16x16x32_bf16 v[176:179], v[76:79], v[80:83], v[176:179]
    s_waitcnt lgkmcnt(0)
    s_barrier
    v_mfma_f32_16x16x32_bf16 v[128:131], v[96:99], v[112:115], v[128:131]
    ds_read_b128 v[64:67], v18 offset:0
    v_mfma_f32_16x16x32_bf16 v[132:135], v[96:99], v[116:119], v[132:135]
    ds_read_b64_tr_b16 v[80:81], v21 offset:0
    v_mfma_f32_16x16x32_bf16 v[136:139], v[96:99], v[120:123], v[136:139]
    ds_read_b64_tr_b16 v[82:83], v21 offset:64
    v_mfma_f32_16x16x32_bf16 v[140:143], v[96:99], v[124:127], v[140:143]
    ds_read_b64_tr_b16 v[84:85], v21 offset:2176
    v_mfma_f32_16x16x32_bf16 v[156:159], v[100:103], v[124:127], v[156:159]
    ds_read_b64_tr_b16 v[86:87], v21 offset:2240
    v_mfma_f32_16x16x32_bf16 v[152:155], v[100:103], v[120:123], v[152:155]
    ds_read_b64_tr_b16 v[88:89], v21 offset:4352
    v_mfma_f32_16x16x32_bf16 v[148:151], v[100:103], v[116:119], v[148:151]
    ds_read_b64_tr_b16 v[90:91], v21 offset:4416
    v_mfma_f32_16x16x32_bf16 v[144:147], v[100:103], v[112:115], v[144:147]
    ds_read_b64_tr_b16 v[92:93], v21 offset:6528
    v_mfma_f32_16x16x32_bf16 v[160:163], v[104:107], v[112:115], v[160:163]
    ds_read_b64_tr_b16 v[94:95], v21 offset:6592
    v_mfma_f32_16x16x32_bf16 v[164:167], v[104:107], v[116:119], v[164:167]
    ds_read_b128 v[68:71], v18 offset:2048
    v_mfma_f32_16x16x32_bf16 v[168:171], v[104:107], v[120:123], v[168:171]
    ds_read_b128 v[72:75], v18 offset:4096
    v_mfma_f32_16x16x32_bf16 v[172:175], v[104:107], v[124:127], v[172:175]
    ds_read_b128 v[76:79], v18 offset:6144
    v_mfma_f32_16x16x32_bf16 v[188:191], v[108:111], v[124:127], v[188:191]
    v_mfma_f32_16x16x32_bf16 v[184:187], v[108:111], v[120:123], v[184:187]
    v_mfma_f32_16x16x32_bf16 v[180:183], v[108:111], v[116:119], v[180:183]
    v_mfma_f32_16x16x32_bf16 v[176:179], v[108:111], v[112:115], v[176:179]
    s_waitcnt lgkmcnt(9)
    v_mfma_f32_16x16x32_bf16 v[128:131], v[64:67], v[80:83], v[128:131]
    ds_read_b128 v[96:99], v19 offset:0
    s_waitcnt lgkmcnt(8)
    v_mfma_f32_16x16x32_bf16 v[132:135], v[64:67], v[84:87], v[132:135]
    ds_read_b64_tr_b16 v[112:113], v21 offset:512
    s_waitcnt lgkmcnt(7)
    v_mfma_f32_16x16x32_bf16 v[136:139], v[64:67], v[88:91], v[136:139]
    ds_read_b64_tr_b16 v[114:115], v21 offset:576
    s_waitcnt lgkmcnt(6)
    v_mfma_f32_16x16x32_bf16 v[140:143], v[64:67], v[92:95], v[140:143]
    ds_read_b64_tr_b16 v[116:117], v21 offset:2688
    s_waitcnt lgkmcnt(6)
    v_mfma_f32_16x16x32_bf16 v[156:159], v[68:71], v[92:95], v[156:159]
    ds_read_b64_tr_b16 v[118:119], v21 offset:2752
    v_mfma_f32_16x16x32_bf16 v[152:155], v[68:71], v[88:91], v[152:155]
    ds_read_b64_tr_b16 v[120:121], v21 offset:4864
    v_mfma_f32_16x16x32_bf16 v[148:151], v[68:71], v[84:87], v[148:151]
    ds_read_b64_tr_b16 v[122:123], v21 offset:4928
    v_mfma_f32_16x16x32_bf16 v[144:147], v[68:71], v[80:83], v[144:147]
    ds_read_b64_tr_b16 v[124:125], v21 offset:7040
    s_waitcnt lgkmcnt(9)
    v_mfma_f32_16x16x32_bf16 v[160:163], v[72:75], v[80:83], v[160:163]
    ds_read_b64_tr_b16 v[126:127], v21 offset:7104
    v_mfma_f32_16x16x32_bf16 v[164:167], v[72:75], v[84:87], v[164:167]
    ds_read_b128 v[100:103], v19 offset:2048
    v_mfma_f32_16x16x32_bf16 v[168:171], v[72:75], v[88:91], v[168:171]
    ds_read_b128 v[104:107], v19 offset:4096
    v_mfma_f32_16x16x32_bf16 v[172:175], v[72:75], v[92:95], v[172:175]
    ds_read_b128 v[108:111], v19 offset:6144
    s_waitcnt lgkmcnt(12)
    v_mfma_f32_16x16x32_bf16 v[188:191], v[76:79], v[92:95], v[188:191]
    v_mfma_f32_16x16x32_bf16 v[184:187], v[76:79], v[88:91], v[184:187]
    v_mfma_f32_16x16x32_bf16 v[180:183], v[76:79], v[84:87], v[180:183]
    v_mfma_f32_16x16x32_bf16 v[176:179], v[76:79], v[80:83], v[176:179]
    s_waitcnt lgkmcnt(0)
    s_barrier
    v_mfma_f32_16x16x32_bf16 v[128:131], v[96:99], v[112:115], v[128:131]
    ds_read_b128 v[64:67], v18 offset:33792
    v_mfma_f32_16x16x32_bf16 v[132:135], v[96:99], v[116:119], v[132:135]
    ds_read_b64_tr_b16 v[80:81], v21 offset:33792
    v_mfma_f32_16x16x32_bf16 v[136:139], v[96:99], v[120:123], v[136:139]
    ds_read_b64_tr_b16 v[82:83], v21 offset:33856
    v_mfma_f32_16x16x32_bf16 v[140:143], v[96:99], v[124:127], v[140:143]
    ds_read_b64_tr_b16 v[84:85], v21 offset:35968
    v_mfma_f32_16x16x32_bf16 v[156:159], v[100:103], v[124:127], v[156:159]
    ds_read_b64_tr_b16 v[86:87], v21 offset:36032
    v_mfma_f32_16x16x32_bf16 v[152:155], v[100:103], v[120:123], v[152:155]
    ds_read_b64_tr_b16 v[88:89], v21 offset:38144
    v_mfma_f32_16x16x32_bf16 v[148:151], v[100:103], v[116:119], v[148:151]
    ds_read_b64_tr_b16 v[90:91], v21 offset:38208
    v_mfma_f32_16x16x32_bf16 v[144:147], v[100:103], v[112:115], v[144:147]
    ds_read_b64_tr_b16 v[92:93], v21 offset:40320
    v_mfma_f32_16x16x32_bf16 v[160:163], v[104:107], v[112:115], v[160:163]
    ds_read_b64_tr_b16 v[94:95], v21 offset:40384
    v_mfma_f32_16x16x32_bf16 v[164:167], v[104:107], v[116:119], v[164:167]
    ds_read_b128 v[68:71], v18 offset:35840
    v_mfma_f32_16x16x32_bf16 v[168:171], v[104:107], v[120:123], v[168:171]
    ds_read_b128 v[72:75], v18 offset:37888
    v_mfma_f32_16x16x32_bf16 v[172:175], v[104:107], v[124:127], v[172:175]
    ds_read_b128 v[76:79], v18 offset:39936
    v_mfma_f32_16x16x32_bf16 v[188:191], v[108:111], v[124:127], v[188:191]
    v_mfma_f32_16x16x32_bf16 v[184:187], v[108:111], v[120:123], v[184:187]
    v_mfma_f32_16x16x32_bf16 v[180:183], v[108:111], v[116:119], v[180:183]
    v_mfma_f32_16x16x32_bf16 v[176:179], v[108:111], v[112:115], v[176:179]
    s_waitcnt lgkmcnt(9)
    v_mfma_f32_16x16x32_bf16 v[128:131], v[64:67], v[80:83], v[128:131]
    ds_read_b128 v[96:99], v19 offset:33792
    s_waitcnt lgkmcnt(8)
    v_mfma_f32_16x16x32_bf16 v[132:135], v[64:67], v[84:87], v[132:135]
    ds_read_b64_tr_b16 v[112:113], v21 offset:34304
    s_waitcnt lgkmcnt(7)
    v_mfma_f32_16x16x32_bf16 v[136:139], v[64:67], v[88:91], v[136:139]
    ds_read_b64_tr_b16 v[114:115], v21 offset:34368
    s_waitcnt lgkmcnt(6)
    v_mfma_f32_16x16x32_bf16 v[140:143], v[64:67], v[92:95], v[140:143]
    ds_read_b64_tr_b16 v[116:117], v21 offset:36480
    s_waitcnt lgkmcnt(6)
    v_mfma_f32_16x16x32_bf16 v[156:159], v[68:71], v[92:95], v[156:159]
    ds_read_b64_tr_b16 v[118:119], v21 offset:36544
    v_mfma_f32_16x16x32_bf16 v[152:155], v[68:71], v[88:91], v[152:155]
    ds_read_b64_tr_b16 v[120:121], v21 offset:38656
    v_mfma_f32_16x16x32_bf16 v[148:151], v[68:71], v[84:87], v[148:151]
    ds_read_b64_tr_b16 v[122:123], v21 offset:38720
    v_mfma_f32_16x16x32_bf16 v[144:147], v[68:71], v[80:83], v[144:147]
    ds_read_b64_tr_b16 v[124:125], v21 offset:40832
    s_waitcnt lgkmcnt(9)
    v_mfma_f32_16x16x32_bf16 v[160:163], v[72:75], v[80:83], v[160:163]
    ds_read_b64_tr_b16 v[126:127], v21 offset:40896
    v_mfma_f32_16x16x32_bf16 v[164:167], v[72:75], v[84:87], v[164:167]
    ds_read_b128 v[100:103], v19 offset:35840
    v_mfma_f32_16x16x32_bf16 v[168:171], v[72:75], v[88:91], v[168:171]
    ds_read_b128 v[104:107], v19 offset:37888
    v_mfma_f32_16x16x32_bf16 v[172:175], v[72:75], v[92:95], v[172:175]
    ds_read_b128 v[108:111], v19 offset:39936
    s_waitcnt lgkmcnt(12)
    v_mfma_f32_16x16x32_bf16 v[188:191], v[76:79], v[92:95], v[188:191]
    v_mfma_f32_16x16x32_bf16 v[184:187], v[76:79], v[88:91], v[184:187]
    v_mfma_f32_16x16x32_bf16 v[180:183], v[76:79], v[84:87], v[180:183]
    v_mfma_f32_16x16x32_bf16 v[176:179], v[76:79], v[80:83], v[176:179]
    s_waitcnt lgkmcnt(0)
    s_barrier
    v_mfma_f32_16x16x32_bf16 v[128:131], v[96:99], v[112:115], v[128:131]
    ds_read_b128 v[64:67], v16 offset:0
    v_mfma_f32_16x16x32_bf16 v[132:135], v[96:99], v[116:119], v[132:135]
    ds_read_b64_tr_b16 v[80:81], v20 offset:0
    v_mfma_f32_16x16x32_bf16 v[136:139], v[96:99], v[120:123], v[136:139]
    ds_read_b64_tr_b16 v[82:83], v20 offset:64
    v_mfma_f32_16x16x32_bf16 v[140:143], v[96:99], v[124:127], v[140:143]
    ds_read_b64_tr_b16 v[84:85], v20 offset:2176
    v_mfma_f32_16x16x32_bf16 v[156:159], v[100:103], v[124:127], v[156:159]
    ds_read_b64_tr_b16 v[86:87], v20 offset:2240
    v_mfma_f32_16x16x32_bf16 v[152:155], v[100:103], v[120:123], v[152:155]
    ds_read_b64_tr_b16 v[88:89], v20 offset:4352
    v_mfma_f32_16x16x32_bf16 v[148:151], v[100:103], v[116:119], v[148:151]
    ds_read_b64_tr_b16 v[90:91], v20 offset:4416
    v_mfma_f32_16x16x32_bf16 v[144:147], v[100:103], v[112:115], v[144:147]
    ds_read_b64_tr_b16 v[92:93], v20 offset:6528
    v_mfma_f32_16x16x32_bf16 v[160:163], v[104:107], v[112:115], v[160:163]
    ds_read_b64_tr_b16 v[94:95], v20 offset:6592
    v_mfma_f32_16x16x32_bf16 v[164:167], v[104:107], v[116:119], v[164:167]
    ds_read_b128 v[68:71], v16 offset:2048
    v_mfma_f32_16x16x32_bf16 v[168:171], v[104:107], v[120:123], v[168:171]
    ds_read_b128 v[72:75], v16 offset:4096
    v_mfma_f32_16x16x32_bf16 v[172:175], v[104:107], v[124:127], v[172:175]
    ds_read_b128 v[76:79], v16 offset:6144
    v_mfma_f32_16x16x32_bf16 v[188:191], v[108:111], v[124:127], v[188:191]
    v_mfma_f32_16x16x32_bf16 v[184:187], v[108:111], v[120:123], v[184:187]
    v_mfma_f32_16x16x32_bf16 v[180:183], v[108:111], v[116:119], v[180:183]
    v_mfma_f32_16x16x32_bf16 v[176:179], v[108:111], v[112:115], v[176:179]
    s_waitcnt lgkmcnt(9)
    v_mfma_f32_16x16x32_bf16 v[128:131], v[64:67], v[80:83], v[128:131]
    ds_read_b128 v[96:99], v17 offset:0
    s_waitcnt lgkmcnt(8)
    v_mfma_f32_16x16x32_bf16 v[132:135], v[64:67], v[84:87], v[132:135]
    ds_read_b64_tr_b16 v[112:113], v20 offset:512
    s_waitcnt lgkmcnt(7)
    v_mfma_f32_16x16x32_bf16 v[136:139], v[64:67], v[88:91], v[136:139]
    ds_read_b64_tr_b16 v[114:115], v20 offset:576
    s_waitcnt lgkmcnt(6)
    v_mfma_f32_16x16x32_bf16 v[140:143], v[64:67], v[92:95], v[140:143]
    ds_read_b64_tr_b16 v[116:117], v20 offset:2688
    s_waitcnt lgkmcnt(6)
    v_mfma_f32_16x16x32_bf16 v[156:159], v[68:71], v[92:95], v[156:159]
    ds_read_b64_tr_b16 v[118:119], v20 offset:2752
    v_mfma_f32_16x16x32_bf16 v[152:155], v[68:71], v[88:91], v[152:155]
    ds_read_b64_tr_b16 v[120:121], v20 offset:4864
    v_mfma_f32_16x16x32_bf16 v[148:151], v[68:71], v[84:87], v[148:151]
    ds_read_b64_tr_b16 v[122:123], v20 offset:4928
    v_mfma_f32_16x16x32_bf16 v[144:147], v[68:71], v[80:83], v[144:147]
    ds_read_b64_tr_b16 v[124:125], v20 offset:7040
    s_waitcnt lgkmcnt(9)
    v_mfma_f32_16x16x32_bf16 v[160:163], v[72:75], v[80:83], v[160:163]
    ds_read_b64_tr_b16 v[126:127], v20 offset:7104
    v_mfma_f32_16x16x32_bf16 v[164:167], v[72:75], v[84:87], v[164:167]
    ds_read_b128 v[100:103], v17 offset:2048
    v_mfma_f32_16x16x32_bf16 v[168:171], v[72:75], v[88:91], v[168:171]
    ds_read_b128 v[104:107], v17 offset:4096
    v_mfma_f32_16x16x32_bf16 v[172:175], v[72:75], v[92:95], v[172:175]
    ds_read_b128 v[108:111], v17 offset:6144
    s_waitcnt lgkmcnt(12)
    v_mfma_f32_16x16x32_bf16 v[188:191], v[76:79], v[92:95], v[188:191]
    v_mfma_f32_16x16x32_bf16 v[184:187], v[76:79], v[88:91], v[184:187]
    v_mfma_f32_16x16x32_bf16 v[180:183], v[76:79], v[84:87], v[180:183]
    v_mfma_f32_16x16x32_bf16 v[176:179], v[76:79], v[80:83], v[176:179]
    s_waitcnt lgkmcnt(0)
    s_barrier
    v_mfma_f32_16x16x32_bf16 v[128:131], v[96:99], v[112:115], v[128:131]
    ds_read_b128 v[64:67], v16 offset:33792
    v_mfma_f32_16x16x32_bf16 v[132:135], v[96:99], v[116:119], v[132:135]
    ds_read_b64_tr_b16 v[80:81], v20 offset:33792
    v_mfma_f32_16x16x32_bf16 v[136:139], v[96:99], v[120:123], v[136:139]
    ds_read_b64_tr_b16 v[82:83], v20 offset:33856
    v_mfma_f32_16x16x32_bf16 v[140:143], v[96:99], v[124:127], v[140:143]
    ds_read_b64_tr_b16 v[84:85], v20 offset:35968
    v_mfma_f32_16x16x32_bf16 v[156:159], v[100:103], v[124:127], v[156:159]
    ds_read_b64_tr_b16 v[86:87], v20 offset:36032
    v_mfma_f32_16x16x32_bf16 v[152:155], v[100:103], v[120:123], v[152:155]
    ds_read_b64_tr_b16 v[88:89], v20 offset:38144
    v_mfma_f32_16x16x32_bf16 v[148:151], v[100:103], v[116:119], v[148:151]
    ds_read_b64_tr_b16 v[90:91], v20 offset:38208
    v_mfma_f32_16x16x32_bf16 v[144:147], v[100:103], v[112:115], v[144:147]
    ds_read_b64_tr_b16 v[92:93], v20 offset:40320
    v_mfma_f32_16x16x32_bf16 v[160:163], v[104:107], v[112:115], v[160:163]
    ds_read_b64_tr_b16 v[94:95], v20 offset:40384
    v_mfma_f32_16x16x32_bf16 v[164:167], v[104:107], v[116:119], v[164:167]
    ds_read_b128 v[68:71], v16 offset:35840
    v_mfma_f32_16x16x32_bf16 v[168:171], v[104:107], v[120:123], v[168:171]
    ds_read_b128 v[72:75], v16 offset:37888
    v_mfma_f32_16x16x32_bf16 v[172:175], v[104:107], v[124:127], v[172:175]
    ds_read_b128 v[76:79], v16 offset:39936
    v_mfma_f32_16x16x32_bf16 v[188:191], v[108:111], v[124:127], v[188:191]
    v_mfma_f32_16x16x32_bf16 v[184:187], v[108:111], v[120:123], v[184:187]
    v_mfma_f32_16x16x32_bf16 v[180:183], v[108:111], v[116:119], v[180:183]
    v_mfma_f32_16x16x32_bf16 v[176:179], v[108:111], v[112:115], v[176:179]
    s_waitcnt lgkmcnt(9)
    v_mfma_f32_16x16x32_bf16 v[128:131], v[64:67], v[80:83], v[128:131]
    ds_read_b128 v[96:99], v17 offset:33792
    s_waitcnt lgkmcnt(8)
    v_mfma_f32_16x16x32_bf16 v[132:135], v[64:67], v[84:87], v[132:135]
    ds_read_b64_tr_b16 v[112:113], v20 offset:34304
    s_waitcnt lgkmcnt(7)
    v_mfma_f32_16x16x32_bf16 v[136:139], v[64:67], v[88:91], v[136:139]
    ds_read_b64_tr_b16 v[114:115], v20 offset:34368
    s_waitcnt lgkmcnt(6)
    v_mfma_f32_16x16x32_bf16 v[140:143], v[64:67], v[92:95], v[140:143]
    ds_read_b64_tr_b16 v[116:117], v20 offset:36480
    s_waitcnt lgkmcnt(6)
    v_mfma_f32_16x16x32_bf16 v[156:159], v[68:71], v[92:95], v[156:159]
    ds_read_b64_tr_b16 v[118:119], v20 offset:36544
    v_mfma_f32_16x16x32_bf16 v[152:155], v[68:71], v[88:91], v[152:155]
    ds_read_b64_tr_b16 v[120:121], v20 offset:38656
    v_mfma_f32_16x16x32_bf16 v[148:151], v[68:71], v[84:87], v[148:151]
    ds_read_b64_tr_b16 v[122:123], v20 offset:38720
    v_mfma_f32_16x16x32_bf16 v[144:147], v[68:71], v[80:83], v[144:147]
    ds_read_b64_tr_b16 v[124:125], v20 offset:40832
    s_waitcnt lgkmcnt(9)
    v_mfma_f32_16x16x32_bf16 v[160:163], v[72:75], v[80:83], v[160:163]
    ds_read_b64_tr_b16 v[126:127], v20 offset:40896
    v_mfma_f32_16x16x32_bf16 v[164:167], v[72:75], v[84:87], v[164:167]
    ds_read_b128 v[100:103], v17 offset:35840
    v_mfma_f32_16x16x32_bf16 v[168:171], v[72:75], v[88:91], v[168:171]
    ds_read_b128 v[104:107], v17 offset:37888
    v_mfma_f32_16x16x32_bf16 v[172:175], v[72:75], v[92:95], v[172:175]
    ds_read_b128 v[108:111], v17 offset:39936
    s_waitcnt lgkmcnt(12)
    v_mfma_f32_16x16x32_bf16 v[188:191], v[76:79], v[92:95], v[188:191]
    v_mfma_f32_16x16x32_bf16 v[184:187], v[76:79], v[88:91], v[184:187]
    v_mfma_f32_16x16x32_bf16 v[180:183], v[76:79], v[84:87], v[180:183]
    v_mfma_f32_16x16x32_bf16 v[176:179], v[76:79], v[80:83], v[176:179]
    s_waitcnt lgkmcnt(0)
    s_barrier
    v_mfma_f32_16x16x32_bf16 v[128:131], v[96:99], v[112:115], v[128:131]
    ds_read_b128 v[64:67], v18 offset:0
    v_mfma_f32_16x16x32_bf16 v[132:135], v[96:99], v[116:119], v[132:135]
    ds_read_b64_tr_b16 v[80:81], v21 offset:0
    v_mfma_f32_16x16x32_bf16 v[136:139], v[96:99], v[120:123], v[136:139]
    ds_read_b64_tr_b16 v[82:83], v21 offset:64
    v_mfma_f32_16x16x32_bf16 v[140:143], v[96:99], v[124:127], v[140:143]
    ds_read_b64_tr_b16 v[84:85], v21 offset:2176
    v_mfma_f32_16x16x32_bf16 v[156:159], v[100:103], v[124:127], v[156:159]
    ds_read_b64_tr_b16 v[86:87], v21 offset:2240
    v_mfma_f32_16x16x32_bf16 v[152:155], v[100:103], v[120:123], v[152:155]
    ds_read_b64_tr_b16 v[88:89], v21 offset:4352
    v_mfma_f32_16x16x32_bf16 v[148:151], v[100:103], v[116:119], v[148:151]
    ds_read_b64_tr_b16 v[90:91], v21 offset:4416
    v_mfma_f32_16x16x32_bf16 v[144:147], v[100:103], v[112:115], v[144:147]
    ds_read_b64_tr_b16 v[92:93], v21 offset:6528
    v_mfma_f32_16x16x32_bf16 v[160:163], v[104:107], v[112:115], v[160:163]
    ds_read_b64_tr_b16 v[94:95], v21 offset:6592
    v_mfma_f32_16x16x32_bf16 v[164:167], v[104:107], v[116:119], v[164:167]
    ds_read_b128 v[68:71], v18 offset:2048
    v_mfma_f32_16x16x32_bf16 v[168:171], v[104:107], v[120:123], v[168:171]
    ds_read_b128 v[72:75], v18 offset:4096
    v_mfma_f32_16x16x32_bf16 v[172:175], v[104:107], v[124:127], v[172:175]
    ds_read_b128 v[76:79], v18 offset:6144
    v_mfma_f32_16x16x32_bf16 v[188:191], v[108:111], v[124:127], v[188:191]
    v_mfma_f32_16x16x32_bf16 v[184:187], v[108:111], v[120:123], v[184:187]
    v_mfma_f32_16x16x32_bf16 v[180:183], v[108:111], v[116:119], v[180:183]
    v_mfma_f32_16x16x32_bf16 v[176:179], v[108:111], v[112:115], v[176:179]
    s_waitcnt lgkmcnt(9)
    v_mfma_f32_16x16x32_bf16 v[128:131], v[64:67], v[80:83], v[128:131]
    ds_read_b128 v[96:99], v19 offset:0
    s_waitcnt lgkmcnt(8)
    v_mfma_f32_16x16x32_bf16 v[132:135], v[64:67], v[84:87], v[132:135]
    ds_read_b64_tr_b16 v[112:113], v21 offset:512
    s_waitcnt lgkmcnt(7)
    v_mfma_f32_16x16x32_bf16 v[136:139], v[64:67], v[88:91], v[136:139]
    ds_read_b64_tr_b16 v[114:115], v21 offset:576
    s_waitcnt lgkmcnt(6)
    v_mfma_f32_16x16x32_bf16 v[140:143], v[64:67], v[92:95], v[140:143]
    ds_read_b64_tr_b16 v[116:117], v21 offset:2688
    s_waitcnt lgkmcnt(6)
    v_mfma_f32_16x16x32_bf16 v[156:159], v[68:71], v[92:95], v[156:159]
    ds_read_b64_tr_b16 v[118:119], v21 offset:2752
    v_mfma_f32_16x16x32_bf16 v[152:155], v[68:71], v[88:91], v[152:155]
    ds_read_b64_tr_b16 v[120:121], v21 offset:4864
    v_mfma_f32_16x16x32_bf16 v[148:151], v[68:71], v[84:87], v[148:151]
    ds_read_b64_tr_b16 v[122:123], v21 offset:4928
    v_mfma_f32_16x16x32_bf16 v[144:147], v[68:71], v[80:83], v[144:147]
    ds_read_b64_tr_b16 v[124:125], v21 offset:7040
    s_waitcnt lgkmcnt(9)
    v_mfma_f32_16x16x32_bf16 v[160:163], v[72:75], v[80:83], v[160:163]
    ds_read_b64_tr_b16 v[126:127], v21 offset:7104
    v_mfma_f32_16x16x32_bf16 v[164:167], v[72:75], v[84:87], v[164:167]
    ds_read_b128 v[100:103], v19 offset:2048
    v_mfma_f32_16x16x32_bf16 v[168:171], v[72:75], v[88:91], v[168:171]
    ds_read_b128 v[104:107], v19 offset:4096
    v_mfma_f32_16x16x32_bf16 v[172:175], v[72:75], v[92:95], v[172:175]
    ds_read_b128 v[108:111], v19 offset:6144
    s_waitcnt lgkmcnt(12)
    v_mfma_f32_16x16x32_bf16 v[188:191], v[76:79], v[92:95], v[188:191]
    v_mfma_f32_16x16x32_bf16 v[184:187], v[76:79], v[88:91], v[184:187]
    v_mfma_f32_16x16x32_bf16 v[180:183], v[76:79], v[84:87], v[180:183]
    v_mfma_f32_16x16x32_bf16 v[176:179], v[76:79], v[80:83], v[176:179]
    s_waitcnt lgkmcnt(0)
    s_barrier
    v_mfma_f32_16x16x32_bf16 v[128:131], v[96:99], v[112:115], v[128:131]
    ds_read_b128 v[64:67], v18 offset:33792
    v_mfma_f32_16x16x32_bf16 v[132:135], v[96:99], v[116:119], v[132:135]
    ds_read_b64_tr_b16 v[80:81], v21 offset:33792
    v_mfma_f32_16x16x32_bf16 v[136:139], v[96:99], v[120:123], v[136:139]
    ds_read_b64_tr_b16 v[82:83], v21 offset:33856
    v_mfma_f32_16x16x32_bf16 v[140:143], v[96:99], v[124:127], v[140:143]
    ds_read_b64_tr_b16 v[84:85], v21 offset:35968
    v_mfma_f32_16x16x32_bf16 v[156:159], v[100:103], v[124:127], v[156:159]
    ds_read_b64_tr_b16 v[86:87], v21 offset:36032
    v_mfma_f32_16x16x32_bf16 v[152:155], v[100:103], v[120:123], v[152:155]
    ds_read_b64_tr_b16 v[88:89], v21 offset:38144
    v_mfma_f32_16x16x32_bf16 v[148:151], v[100:103], v[116:119], v[148:151]
    ds_read_b64_tr_b16 v[90:91], v21 offset:38208
    v_mfma_f32_16x16x32_bf16 v[144:147], v[100:103], v[112:115], v[144:147]
    ds_read_b64_tr_b16 v[92:93], v21 offset:40320
    v_mfma_f32_16x16x32_bf16 v[160:163], v[104:107], v[112:115], v[160:163]
    ds_read_b64_tr_b16 v[94:95], v21 offset:40384
    v_mfma_f32_16x16x32_bf16 v[164:167], v[104:107], v[116:119], v[164:167]
    ds_read_b128 v[68:71], v18 offset:35840
    v_mfma_f32_16x16x32_bf16 v[168:171], v[104:107], v[120:123], v[168:171]
    ds_read_b128 v[72:75], v18 offset:37888
    v_mfma_f32_16x16x32_bf16 v[172:175], v[104:107], v[124:127], v[172:175]
    ds_read_b128 v[76:79], v18 offset:39936
    v_mfma_f32_16x16x32_bf16 v[188:191], v[108:111], v[124:127], v[188:191]
    v_mfma_f32_16x16x32_bf16 v[184:187], v[108:111], v[120:123], v[184:187]
    v_mfma_f32_16x16x32_bf16 v[180:183], v[108:111], v[116:119], v[180:183]
    v_mfma_f32_16x16x32_bf16 v[176:179], v[108:111], v[112:115], v[176:179]
    s_waitcnt lgkmcnt(9)
    v_mfma_f32_16x16x32_bf16 v[128:131], v[64:67], v[80:83], v[128:131]
    ds_read_b128 v[96:99], v19 offset:33792
    s_waitcnt lgkmcnt(8)
    v_mfma_f32_16x16x32_bf16 v[132:135], v[64:67], v[84:87], v[132:135]
    ds_read_b64_tr_b16 v[112:113], v21 offset:34304
    s_waitcnt lgkmcnt(7)
    v_mfma_f32_16x16x32_bf16 v[136:139], v[64:67], v[88:91], v[136:139]
    ds_read_b64_tr_b16 v[114:115], v21 offset:34368
    s_waitcnt lgkmcnt(6)
    v_mfma_f32_16x16x32_bf16 v[140:143], v[64:67], v[92:95], v[140:143]
    ds_read_b64_tr_b16 v[116:117], v21 offset:36480
    s_waitcnt lgkmcnt(6)
    v_mfma_f32_16x16x32_bf16 v[156:159], v[68:71], v[92:95], v[156:159]
    ds_read_b64_tr_b16 v[118:119], v21 offset:36544
    v_mfma_f32_16x16x32_bf16 v[152:155], v[68:71], v[88:91], v[152:155]
    ds_read_b64_tr_b16 v[120:121], v21 offset:38656
    v_mfma_f32_16x16x32_bf16 v[148:151], v[68:71], v[84:87], v[148:151]
    ds_read_b64_tr_b16 v[122:123], v21 offset:38720
    v_mfma_f32_16x16x32_bf16 v[144:147], v[68:71], v[80:83], v[144:147]
    ds_read_b64_tr_b16 v[124:125], v21 offset:40832
    s_waitcnt lgkmcnt(9)
    v_mfma_f32_16x16x32_bf16 v[160:163], v[72:75], v[80:83], v[160:163]
    ds_read_b64_tr_b16 v[126:127], v21 offset:40896
    v_mfma_f32_16x16x32_bf16 v[164:167], v[72:75], v[84:87], v[164:167]
    ds_read_b128 v[100:103], v19 offset:35840
    v_mfma_f32_16x16x32_bf16 v[168:171], v[72:75], v[88:91], v[168:171]
    ds_read_b128 v[104:107], v19 offset:37888
    v_mfma_f32_16x16x32_bf16 v[172:175], v[72:75], v[92:95], v[172:175]
    ds_read_b128 v[108:111], v19 offset:39936
    s_waitcnt lgkmcnt(12)
    v_mfma_f32_16x16x32_bf16 v[188:191], v[76:79], v[92:95], v[188:191]
    v_mfma_f32_16x16x32_bf16 v[184:187], v[76:79], v[88:91], v[184:187]
    v_mfma_f32_16x16x32_bf16 v[180:183], v[76:79], v[84:87], v[180:183]
    v_mfma_f32_16x16x32_bf16 v[176:179], v[76:79], v[80:83], v[176:179]
    s_waitcnt lgkmcnt(0)
    s_barrier
    v_mfma_f32_16x16x32_bf16 v[128:131], v[96:99], v[112:115], v[128:131]
    ds_read_b128 v[64:67], v16 offset:0
    v_mfma_f32_16x16x32_bf16 v[132:135], v[96:99], v[116:119], v[132:135]
    ds_read_b64_tr_b16 v[80:81], v20 offset:0
    v_mfma_f32_16x16x32_bf16 v[136:139], v[96:99], v[120:123], v[136:139]
    ds_read_b64_tr_b16 v[82:83], v20 offset:64
    v_mfma_f32_16x16x32_bf16 v[140:143], v[96:99], v[124:127], v[140:143]
    ds_read_b64_tr_b16 v[84:85], v20 offset:2176
    v_mfma_f32_16x16x32_bf16 v[156:159], v[100:103], v[124:127], v[156:159]
    ds_read_b64_tr_b16 v[86:87], v20 offset:2240
    v_mfma_f32_16x16x32_bf16 v[152:155], v[100:103], v[120:123], v[152:155]
    ds_read_b64_tr_b16 v[88:89], v20 offset:4352
    v_mfma_f32_16x16x32_bf16 v[148:151], v[100:103], v[116:119], v[148:151]
    ds_read_b64_tr_b16 v[90:91], v20 offset:4416
    v_mfma_f32_16x16x32_bf16 v[144:147], v[100:103], v[112:115], v[144:147]
    ds_read_b64_tr_b16 v[92:93], v20 offset:6528
    v_mfma_f32_16x16x32_bf16 v[160:163], v[104:107], v[112:115], v[160:163]
    ds_read_b64_tr_b16 v[94:95], v20 offset:6592
    v_mfma_f32_16x16x32_bf16 v[164:167], v[104:107], v[116:119], v[164:167]
    ds_read_b128 v[68:71], v16 offset:2048
    v_mfma_f32_16x16x32_bf16 v[168:171], v[104:107], v[120:123], v[168:171]
    ds_read_b128 v[72:75], v16 offset:4096
    v_mfma_f32_16x16x32_bf16 v[172:175], v[104:107], v[124:127], v[172:175]
    ds_read_b128 v[76:79], v16 offset:6144
    v_mfma_f32_16x16x32_bf16 v[188:191], v[108:111], v[124:127], v[188:191]
    v_mfma_f32_16x16x32_bf16 v[184:187], v[108:111], v[120:123], v[184:187]
    v_mfma_f32_16x16x32_bf16 v[180:183], v[108:111], v[116:119], v[180:183]
    v_mfma_f32_16x16x32_bf16 v[176:179], v[108:111], v[112:115], v[176:179]
    s_waitcnt lgkmcnt(9)
    v_mfma_f32_16x16x32_bf16 v[128:131], v[64:67], v[80:83], v[128:131]
    ds_read_b128 v[96:99], v17 offset:0
    s_waitcnt lgkmcnt(8)
    v_mfma_f32_16x16x32_bf16 v[132:135], v[64:67], v[84:87], v[132:135]
    ds_read_b64_tr_b16 v[112:113], v20 offset:512
    s_waitcnt lgkmcnt(7)
    v_mfma_f32_16x16x32_bf16 v[136:139], v[64:67], v[88:91], v[136:139]
    ds_read_b64_tr_b16 v[114:115], v20 offset:576
    s_waitcnt lgkmcnt(6)
    v_mfma_f32_16x16x32_bf16 v[140:143], v[64:67], v[92:95], v[140:143]
    ds_read_b64_tr_b16 v[116:117], v20 offset:2688
    s_waitcnt lgkmcnt(6)
    v_mfma_f32_16x16x32_bf16 v[156:159], v[68:71], v[92:95], v[156:159]
    ds_read_b64_tr_b16 v[118:119], v20 offset:2752
    v_mfma_f32_16x16x32_bf16 v[152:155], v[68:71], v[88:91], v[152:155]
    ds_read_b64_tr_b16 v[120:121], v20 offset:4864
    v_mfma_f32_16x16x32_bf16 v[148:151], v[68:71], v[84:87], v[148:151]
    ds_read_b64_tr_b16 v[122:123], v20 offset:4928
    v_mfma_f32_16x16x32_bf16 v[144:147], v[68:71], v[80:83], v[144:147]
    ds_read_b64_tr_b16 v[124:125], v20 offset:7040
    s_waitcnt lgkmcnt(9)
    v_mfma_f32_16x16x32_bf16 v[160:163], v[72:75], v[80:83], v[160:163]
    ds_read_b64_tr_b16 v[126:127], v20 offset:7104
    v_mfma_f32_16x16x32_bf16 v[164:167], v[72:75], v[84:87], v[164:167]
    ds_read_b128 v[100:103], v17 offset:2048
    v_mfma_f32_16x16x32_bf16 v[168:171], v[72:75], v[88:91], v[168:171]
    ds_read_b128 v[104:107], v17 offset:4096
    v_mfma_f32_16x16x32_bf16 v[172:175], v[72:75], v[92:95], v[172:175]
    ds_read_b128 v[108:111], v17 offset:6144
    s_waitcnt lgkmcnt(12)
    v_mfma_f32_16x16x32_bf16 v[188:191], v[76:79], v[92:95], v[188:191]
    v_mfma_f32_16x16x32_bf16 v[184:187], v[76:79], v[88:91], v[184:187]
    v_mfma_f32_16x16x32_bf16 v[180:183], v[76:79], v[84:87], v[180:183]
    v_mfma_f32_16x16x32_bf16 v[176:179], v[76:79], v[80:83], v[176:179]
    s_waitcnt lgkmcnt(0)
    s_barrier
    v_mfma_f32_16x16x32_bf16 v[128:131], v[96:99], v[112:115], v[128:131]
    ds_read_b128 v[64:67], v16 offset:33792
    v_mfma_f32_16x16x32_bf16 v[132:135], v[96:99], v[116:119], v[132:135]
    ds_read_b64_tr_b16 v[80:81], v20 offset:33792
    v_mfma_f32_16x16x32_bf16 v[136:139], v[96:99], v[120:123], v[136:139]
    ds_read_b64_tr_b16 v[82:83], v20 offset:33856
    v_mfma_f32_16x16x32_bf16 v[140:143], v[96:99], v[124:127], v[140:143]
    ds_read_b64_tr_b16 v[84:85], v20 offset:35968
    v_mfma_f32_16x16x32_bf16 v[156:159], v[100:103], v[124:127], v[156:159]
    ds_read_b64_tr_b16 v[86:87], v20 offset:36032
    v_mfma_f32_16x16x32_bf16 v[152:155], v[100:103], v[120:123], v[152:155]
    ds_read_b64_tr_b16 v[88:89], v20 offset:38144
    v_mfma_f32_16x16x32_bf16 v[148:151], v[100:103], v[116:119], v[148:151]
    ds_read_b64_tr_b16 v[90:91], v20 offset:38208
    v_mfma_f32_16x16x32_bf16 v[144:147], v[100:103], v[112:115], v[144:147]
    ds_read_b64_tr_b16 v[92:93], v20 offset:40320
    v_mfma_f32_16x16x32_bf16 v[160:163], v[104:107], v[112:115], v[160:163]
    ds_read_b64_tr_b16 v[94:95], v20 offset:40384
    v_mfma_f32_16x16x32_bf16 v[164:167], v[104:107], v[116:119], v[164:167]
    ds_read_b128 v[68:71], v16 offset:35840
    v_mfma_f32_16x16x32_bf16 v[168:171], v[104:107], v[120:123], v[168:171]
    ds_read_b128 v[72:75], v16 offset:37888
    v_mfma_f32_16x16x32_bf16 v[172:175], v[104:107], v[124:127], v[172:175]
    ds_read_b128 v[76:79], v16 offset:39936
    v_mfma_f32_16x16x32_bf16 v[188:191], v[108:111], v[124:127], v[188:191]
    v_mfma_f32_16x16x32_bf16 v[184:187], v[108:111], v[120:123], v[184:187]
    v_mfma_f32_16x16x32_bf16 v[180:183], v[108:111], v[116:119], v[180:183]
    v_mfma_f32_16x16x32_bf16 v[176:179], v[108:111], v[112:115], v[176:179]
    s_waitcnt lgkmcnt(9)
    v_mfma_f32_16x16x32_bf16 v[128:131], v[64:67], v[80:83], v[128:131]
    ds_read_b128 v[96:99], v17 offset:33792
    s_waitcnt lgkmcnt(8)
    v_mfma_f32_16x16x32_bf16 v[132:135], v[64:67], v[84:87], v[132:135]
    ds_read_b64_tr_b16 v[112:113], v20 offset:34304
    s_waitcnt lgkmcnt(7)
    v_mfma_f32_16x16x32_bf16 v[136:139], v[64:67], v[88:91], v[136:139]
    ds_read_b64_tr_b16 v[114:115], v20 offset:34368
    s_waitcnt lgkmcnt(6)
    v_mfma_f32_16x16x32_bf16 v[140:143], v[64:67], v[92:95], v[140:143]
    ds_read_b64_tr_b16 v[116:117], v20 offset:36480
    s_waitcnt lgkmcnt(6)
    v_mfma_f32_16x16x32_bf16 v[156:159], v[68:71], v[92:95], v[156:159]
    ds_read_b64_tr_b16 v[118:119], v20 offset:36544
    v_mfma_f32_16x16x32_bf16 v[152:155], v[68:71], v[88:91], v[152:155]
    ds_read_b64_tr_b16 v[120:121], v20 offset:38656
    v_mfma_f32_16x16x32_bf16 v[148:151], v[68:71], v[84:87], v[148:151]
    ds_read_b64_tr_b16 v[122:123], v20 offset:38720
    v_mfma_f32_16x16x32_bf16 v[144:147], v[68:71], v[80:83], v[144:147]
    ds_read_b64_tr_b16 v[124:125], v20 offset:40832
    s_waitcnt lgkmcnt(9)
    v_mfma_f32_16x16x32_bf16 v[160:163], v[72:75], v[80:83], v[160:163]
    ds_read_b64_tr_b16 v[126:127], v20 offset:40896
    v_mfma_f32_16x16x32_bf16 v[164:167], v[72:75], v[84:87], v[164:167]
    ds_read_b128 v[100:103], v17 offset:35840
    v_mfma_f32_16x16x32_bf16 v[168:171], v[72:75], v[88:91], v[168:171]
    ds_read_b128 v[104:107], v17 offset:37888
    v_mfma_f32_16x16x32_bf16 v[172:175], v[72:75], v[92:95], v[172:175]
    ds_read_b128 v[108:111], v17 offset:39936
    s_waitcnt lgkmcnt(12)
    v_mfma_f32_16x16x32_bf16 v[188:191], v[76:79], v[92:95], v[188:191]
    v_mfma_f32_16x16x32_bf16 v[184:187], v[76:79], v[88:91], v[184:187]
    v_mfma_f32_16x16x32_bf16 v[180:183], v[76:79], v[84:87], v[180:183]
    v_mfma_f32_16x16x32_bf16 v[176:179], v[76:79], v[80:83], v[176:179]
    s_waitcnt lgkmcnt(0)
    s_barrier
    v_mfma_f32_16x16x32_bf16 v[128:131], v[96:99], v[112:115], v[128:131]
    ds_read_b128 v[64:67], v18 offset:0
    v_mfma_f32_16x16x32_bf16 v[132:135], v[96:99], v[116:119], v[132:135]
    ds_read_b64_tr_b16 v[80:81], v21 offset:0
    v_mfma_f32_16x16x32_bf16 v[136:139], v[96:99], v[120:123], v[136:139]
    ds_read_b64_tr_b16 v[82:83], v21 offset:64
    v_mfma_f32_16x16x32_bf16 v[140:143], v[96:99], v[124:127], v[140:143]
    ds_read_b64_tr_b16 v[84:85], v21 offset:2176
    v_mfma_f32_16x16x32_bf16 v[156:159], v[100:103], v[124:127], v[156:159]
    ds_read_b64_tr_b16 v[86:87], v21 offset:2240
    v_mfma_f32_16x16x32_bf16 v[152:155], v[100:103], v[120:123], v[152:155]
    ds_read_b64_tr_b16 v[88:89], v21 offset:4352
    v_mfma_f32_16x16x32_bf16 v[148:151], v[100:103], v[116:119], v[148:151]
    ds_read_b64_tr_b16 v[90:91], v21 offset:4416
    v_mfma_f32_16x16x32_bf16 v[144:147], v[100:103], v[112:115], v[144:147]
    ds_read_b64_tr_b16 v[92:93], v21 offset:6528
    v_mfma_f32_16x16x32_bf16 v[160:163], v[104:107], v[112:115], v[160:163]
    ds_read_b64_tr_b16 v[94:95], v21 offset:6592
    v_mfma_f32_16x16x32_bf16 v[164:167], v[104:107], v[116:119], v[164:167]
    ds_read_b128 v[68:71], v18 offset:2048
    v_mfma_f32_16x16x32_bf16 v[168:171], v[104:107], v[120:123], v[168:171]
    ds_read_b128 v[72:75], v18 offset:4096
    v_mfma_f32_16x16x32_bf16 v[172:175], v[104:107], v[124:127], v[172:175]
    ds_read_b128 v[76:79], v18 offset:6144
    v_mfma_f32_16x16x32_bf16 v[188:191], v[108:111], v[124:127], v[188:191]
    v_mfma_f32_16x16x32_bf16 v[184:187], v[108:111], v[120:123], v[184:187]
    v_mfma_f32_16x16x32_bf16 v[180:183], v[108:111], v[116:119], v[180:183]
    v_mfma_f32_16x16x32_bf16 v[176:179], v[108:111], v[112:115], v[176:179]
    s_waitcnt lgkmcnt(9)
    v_mfma_f32_16x16x32_bf16 v[128:131], v[64:67], v[80:83], v[128:131]
    ds_read_b128 v[96:99], v19 offset:0
    s_waitcnt lgkmcnt(8)
    v_mfma_f32_16x16x32_bf16 v[132:135], v[64:67], v[84:87], v[132:135]
    ds_read_b64_tr_b16 v[112:113], v21 offset:512
    s_waitcnt lgkmcnt(7)
    v_mfma_f32_16x16x32_bf16 v[136:139], v[64:67], v[88:91], v[136:139]
    ds_read_b64_tr_b16 v[114:115], v21 offset:576
    s_waitcnt lgkmcnt(6)
    v_mfma_f32_16x16x32_bf16 v[140:143], v[64:67], v[92:95], v[140:143]
    ds_read_b64_tr_b16 v[116:117], v21 offset:2688
    s_waitcnt lgkmcnt(6)
    v_mfma_f32_16x16x32_bf16 v[156:159], v[68:71], v[92:95], v[156:159]
    ds_read_b64_tr_b16 v[118:119], v21 offset:2752
    v_mfma_f32_16x16x32_bf16 v[152:155], v[68:71], v[88:91], v[152:155]
    ds_read_b64_tr_b16 v[120:121], v21 offset:4864
    v_mfma_f32_16x16x32_bf16 v[148:151], v[68:71], v[84:87], v[148:151]
    ds_read_b64_tr_b16 v[122:123], v21 offset:4928
    v_mfma_f32_16x16x32_bf16 v[144:147], v[68:71], v[80:83], v[144:147]
    ds_read_b64_tr_b16 v[124:125], v21 offset:7040
    s_waitcnt lgkmcnt(9)
    v_mfma_f32_16x16x32_bf16 v[160:163], v[72:75], v[80:83], v[160:163]
    ds_read_b64_tr_b16 v[126:127], v21 offset:7104
    v_mfma_f32_16x16x32_bf16 v[164:167], v[72:75], v[84:87], v[164:167]
    ds_read_b128 v[100:103], v19 offset:2048
    v_mfma_f32_16x16x32_bf16 v[168:171], v[72:75], v[88:91], v[168:171]
    ds_read_b128 v[104:107], v19 offset:4096
    v_mfma_f32_16x16x32_bf16 v[172:175], v[72:75], v[92:95], v[172:175]
    ds_read_b128 v[108:111], v19 offset:6144
    s_waitcnt lgkmcnt(12)
    v_mfma_f32_16x16x32_bf16 v[188:191], v[76:79], v[92:95], v[188:191]
    v_mfma_f32_16x16x32_bf16 v[184:187], v[76:79], v[88:91], v[184:187]
    v_mfma_f32_16x16x32_bf16 v[180:183], v[76:79], v[84:87], v[180:183]
    v_mfma_f32_16x16x32_bf16 v[176:179], v[76:79], v[80:83], v[176:179]
    s_waitcnt lgkmcnt(0)
    s_barrier
    v_mfma_f32_16x16x32_bf16 v[128:131], v[96:99], v[112:115], v[128:131]
    ds_read_b128 v[64:67], v18 offset:33792
    v_mfma_f32_16x16x32_bf16 v[132:135], v[96:99], v[116:119], v[132:135]
    ds_read_b64_tr_b16 v[80:81], v21 offset:33792
    v_mfma_f32_16x16x32_bf16 v[136:139], v[96:99], v[120:123], v[136:139]
    ds_read_b64_tr_b16 v[82:83], v21 offset:33856
    v_mfma_f32_16x16x32_bf16 v[140:143], v[96:99], v[124:127], v[140:143]
    ds_read_b64_tr_b16 v[84:85], v21 offset:35968
    v_mfma_f32_16x16x32_bf16 v[156:159], v[100:103], v[124:127], v[156:159]
    ds_read_b64_tr_b16 v[86:87], v21 offset:36032
    v_mfma_f32_16x16x32_bf16 v[152:155], v[100:103], v[120:123], v[152:155]
    ds_read_b64_tr_b16 v[88:89], v21 offset:38144
    v_mfma_f32_16x16x32_bf16 v[148:151], v[100:103], v[116:119], v[148:151]
    ds_read_b64_tr_b16 v[90:91], v21 offset:38208
    v_mfma_f32_16x16x32_bf16 v[144:147], v[100:103], v[112:115], v[144:147]
    ds_read_b64_tr_b16 v[92:93], v21 offset:40320
    v_mfma_f32_16x16x32_bf16 v[160:163], v[104:107], v[112:115], v[160:163]
    ds_read_b64_tr_b16 v[94:95], v21 offset:40384
    v_mfma_f32_16x16x32_bf16 v[164:167], v[104:107], v[116:119], v[164:167]
    ds_read_b128 v[68:71], v18 offset:35840
    v_mfma_f32_16x16x32_bf16 v[168:171], v[104:107], v[120:123], v[168:171]
    ds_read_b128 v[72:75], v18 offset:37888
    v_mfma_f32_16x16x32_bf16 v[172:175], v[104:107], v[124:127], v[172:175]
    ds_read_b128 v[76:79], v18 offset:39936
    v_mfma_f32_16x16x32_bf16 v[188:191], v[108:111], v[124:127], v[188:191]
    v_mfma_f32_16x16x32_bf16 v[184:187], v[108:111], v[120:123], v[184:187]
    v_mfma_f32_16x16x32_bf16 v[180:183], v[108:111], v[116:119], v[180:183]
    v_mfma_f32_16x16x32_bf16 v[176:179], v[108:111], v[112:115], v[176:179]
    s_waitcnt lgkmcnt(9)
    v_mfma_f32_16x16x32_bf16 v[128:131], v[64:67], v[80:83], v[128:131]
    ds_read_b128 v[96:99], v19 offset:33792
    s_waitcnt lgkmcnt(8)
    v_mfma_f32_16x16x32_bf16 v[132:135], v[64:67], v[84:87], v[132:135]
    ds_read_b64_tr_b16 v[112:113], v21 offset:34304
    s_waitcnt lgkmcnt(7)
    v_mfma_f32_16x16x32_bf16 v[136:139], v[64:67], v[88:91], v[136:139]
    ds_read_b64_tr_b16 v[114:115], v21 offset:34368
    s_waitcnt lgkmcnt(6)
    v_mfma_f32_16x16x32_bf16 v[140:143], v[64:67], v[92:95], v[140:143]
    ds_read_b64_tr_b16 v[116:117], v21 offset:36480
    s_waitcnt lgkmcnt(6)
    v_mfma_f32_16x16x32_bf16 v[156:159], v[68:71], v[92:95], v[156:159]
    ds_read_b64_tr_b16 v[118:119], v21 offset:36544
    v_mfma_f32_16x16x32_bf16 v[152:155], v[68:71], v[88:91], v[152:155]
    ds_read_b64_tr_b16 v[120:121], v21 offset:38656
    v_mfma_f32_16x16x32_bf16 v[148:151], v[68:71], v[84:87], v[148:151]
    ds_read_b64_tr_b16 v[122:123], v21 offset:38720
    v_mfma_f32_16x16x32_bf16 v[144:147], v[68:71], v[80:83], v[144:147]
    ds_read_b64_tr_b16 v[124:125], v21 offset:40832
    s_waitcnt lgkmcnt(9)
    v_mfma_f32_16x16x32_bf16 v[160:163], v[72:75], v[80:83], v[160:163]
    ds_read_b64_tr_b16 v[126:127], v21 offset:40896
    v_mfma_f32_16x16x32_bf16 v[164:167], v[72:75], v[84:87], v[164:167]
    ds_read_b128 v[100:103], v19 offset:35840
    v_mfma_f32_16x16x32_bf16 v[168:171], v[72:75], v[88:91], v[168:171]
    ds_read_b128 v[104:107], v19 offset:37888
    v_mfma_f32_16x16x32_bf16 v[172:175], v[72:75], v[92:95], v[172:175]
    ds_read_b128 v[108:111], v19 offset:39936
    s_waitcnt lgkmcnt(12)
    v_mfma_f32_16x16x32_bf16 v[188:191], v[76:79], v[92:95], v[188:191]
    v_mfma_f32_16x16x32_bf16 v[184:187], v[76:79], v[88:91], v[184:187]
    v_mfma_f32_16x16x32_bf16 v[180:183], v[76:79], v[84:87], v[180:183]
    v_mfma_f32_16x16x32_bf16 v[176:179], v[76:79], v[80:83], v[176:179]
    s_waitcnt lgkmcnt(0)
    s_barrier
    v_mfma_f32_16x16x32_bf16 v[128:131], v[96:99], v[112:115], v[128:131]
    ds_read_b128 v[64:67], v16 offset:0
    v_mfma_f32_16x16x32_bf16 v[132:135], v[96:99], v[116:119], v[132:135]
    ds_read_b64_tr_b16 v[80:81], v20 offset:0
    v_mfma_f32_16x16x32_bf16 v[136:139], v[96:99], v[120:123], v[136:139]
    ds_read_b64_tr_b16 v[82:83], v20 offset:64
    v_mfma_f32_16x16x32_bf16 v[140:143], v[96:99], v[124:127], v[140:143]
    ds_read_b64_tr_b16 v[84:85], v20 offset:2176
    v_mfma_f32_16x16x32_bf16 v[156:159], v[100:103], v[124:127], v[156:159]
    ds_read_b64_tr_b16 v[86:87], v20 offset:2240
    v_mfma_f32_16x16x32_bf16 v[152:155], v[100:103], v[120:123], v[152:155]
    ds_read_b64_tr_b16 v[88:89], v20 offset:4352
    v_mfma_f32_16x16x32_bf16 v[148:151], v[100:103], v[116:119], v[148:151]
    ds_read_b64_tr_b16 v[90:91], v20 offset:4416
    v_mfma_f32_16x16x32_bf16 v[144:147], v[100:103], v[112:115], v[144:147]
    ds_read_b64_tr_b16 v[92:93], v20 offset:6528
    v_mfma_f32_16x16x32_bf16 v[160:163], v[104:107], v[112:115], v[160:163]
    ds_read_b64_tr_b16 v[94:95], v20 offset:6592
    v_mfma_f32_16x16x32_bf16 v[164:167], v[104:107], v[116:119], v[164:167]
    ds_read_b128 v[68:71], v16 offset:2048
    v_mfma_f32_16x16x32_bf16 v[168:171], v[104:107], v[120:123], v[168:171]
    ds_read_b128 v[72:75], v16 offset:4096
    v_mfma_f32_16x16x32_bf16 v[172:175], v[104:107], v[124:127], v[172:175]
    ds_read_b128 v[76:79], v16 offset:6144
    v_mfma_f32_16x16x32_bf16 v[188:191], v[108:111], v[124:127], v[188:191]
    v_mfma_f32_16x16x32_bf16 v[184:187], v[108:111], v[120:123], v[184:187]
    v_mfma_f32_16x16x32_bf16 v[180:183], v[108:111], v[116:119], v[180:183]
    v_mfma_f32_16x16x32_bf16 v[176:179], v[108:111], v[112:115], v[176:179]
    s_waitcnt lgkmcnt(9)
    v_mfma_f32_16x16x32_bf16 v[128:131], v[64:67], v[80:83], v[128:131]
    ds_read_b128 v[96:99], v17 offset:0
    s_waitcnt lgkmcnt(8)
    v_mfma_f32_16x16x32_bf16 v[132:135], v[64:67], v[84:87], v[132:135]
    ds_read_b64_tr_b16 v[112:113], v20 offset:512
    s_waitcnt lgkmcnt(7)
    v_mfma_f32_16x16x32_bf16 v[136:139], v[64:67], v[88:91], v[136:139]
    ds_read_b64_tr_b16 v[114:115], v20 offset:576
    s_waitcnt lgkmcnt(6)
    v_mfma_f32_16x16x32_bf16 v[140:143], v[64:67], v[92:95], v[140:143]
    ds_read_b64_tr_b16 v[116:117], v20 offset:2688
    s_waitcnt lgkmcnt(6)
    v_mfma_f32_16x16x32_bf16 v[156:159], v[68:71], v[92:95], v[156:159]
    ds_read_b64_tr_b16 v[118:119], v20 offset:2752
    v_mfma_f32_16x16x32_bf16 v[152:155], v[68:71], v[88:91], v[152:155]
    ds_read_b64_tr_b16 v[120:121], v20 offset:4864
    v_mfma_f32_16x16x32_bf16 v[148:151], v[68:71], v[84:87], v[148:151]
    ds_read_b64_tr_b16 v[122:123], v20 offset:4928
    v_mfma_f32_16x16x32_bf16 v[144:147], v[68:71], v[80:83], v[144:147]
    ds_read_b64_tr_b16 v[124:125], v20 offset:7040
    s_waitcnt lgkmcnt(9)
    v_mfma_f32_16x16x32_bf16 v[160:163], v[72:75], v[80:83], v[160:163]
    ds_read_b64_tr_b16 v[126:127], v20 offset:7104
    v_mfma_f32_16x16x32_bf16 v[164:167], v[72:75], v[84:87], v[164:167]
    ds_read_b128 v[100:103], v17 offset:2048
    v_mfma_f32_16x16x32_bf16 v[168:171], v[72:75], v[88:91], v[168:171]
    ds_read_b128 v[104:107], v17 offset:4096
    v_mfma_f32_16x16x32_bf16 v[172:175], v[72:75], v[92:95], v[172:175]
    ds_read_b128 v[108:111], v17 offset:6144
    s_waitcnt lgkmcnt(12)
    v_mfma_f32_16x16x32_bf16 v[188:191], v[76:79], v[92:95], v[188:191]
    v_mfma_f32_16x16x32_bf16 v[184:187], v[76:79], v[88:91], v[184:187]
    v_mfma_f32_16x16x32_bf16 v[180:183], v[76:79], v[84:87], v[180:183]
    v_mfma_f32_16x16x32_bf16 v[176:179], v[76:79], v[80:83], v[176:179]
    s_waitcnt lgkmcnt(0)
    s_barrier
    v_mfma_f32_16x16x32_bf16 v[128:131], v[96:99], v[112:115], v[128:131]
    ds_read_b128 v[64:67], v16 offset:33792
    v_mfma_f32_16x16x32_bf16 v[132:135], v[96:99], v[116:119], v[132:135]
    ds_read_b64_tr_b16 v[80:81], v20 offset:33792
    v_mfma_f32_16x16x32_bf16 v[136:139], v[96:99], v[120:123], v[136:139]
    ds_read_b64_tr_b16 v[82:83], v20 offset:33856
    v_mfma_f32_16x16x32_bf16 v[140:143], v[96:99], v[124:127], v[140:143]
    ds_read_b64_tr_b16 v[84:85], v20 offset:35968
    v_mfma_f32_16x16x32_bf16 v[156:159], v[100:103], v[124:127], v[156:159]
    ds_read_b64_tr_b16 v[86:87], v20 offset:36032
    v_mfma_f32_16x16x32_bf16 v[152:155], v[100:103], v[120:123], v[152:155]
    ds_read_b64_tr_b16 v[88:89], v20 offset:38144
    v_mfma_f32_16x16x32_bf16 v[148:151], v[100:103], v[116:119], v[148:151]
    ds_read_b64_tr_b16 v[90:91], v20 offset:38208
    v_mfma_f32_16x16x32_bf16 v[144:147], v[100:103], v[112:115], v[144:147]
    ds_read_b64_tr_b16 v[92:93], v20 offset:40320
    v_mfma_f32_16x16x32_bf16 v[160:163], v[104:107], v[112:115], v[160:163]
    ds_read_b64_tr_b16 v[94:95], v20 offset:40384
    v_mfma_f32_16x16x32_bf16 v[164:167], v[104:107], v[116:119], v[164:167]
    ds_read_b128 v[68:71], v16 offset:35840
    v_mfma_f32_16x16x32_bf16 v[168:171], v[104:107], v[120:123], v[168:171]
    ds_read_b128 v[72:75], v16 offset:37888
    v_mfma_f32_16x16x32_bf16 v[172:175], v[104:107], v[124:127], v[172:175]
    ds_read_b128 v[76:79], v16 offset:39936
    v_mfma_f32_16x16x32_bf16 v[188:191], v[108:111], v[124:127], v[188:191]
    v_mfma_f32_16x16x32_bf16 v[184:187], v[108:111], v[120:123], v[184:187]
    v_mfma_f32_16x16x32_bf16 v[180:183], v[108:111], v[116:119], v[180:183]
    v_mfma_f32_16x16x32_bf16 v[176:179], v[108:111], v[112:115], v[176:179]
    s_waitcnt lgkmcnt(9)
    v_mfma_f32_16x16x32_bf16 v[128:131], v[64:67], v[80:83], v[128:131]
    ds_read_b128 v[96:99], v17 offset:33792
    s_waitcnt lgkmcnt(8)
    v_mfma_f32_16x16x32_bf16 v[132:135], v[64:67], v[84:87], v[132:135]
    ds_read_b64_tr_b16 v[112:113], v20 offset:34304
    s_waitcnt lgkmcnt(7)
    v_mfma_f32_16x16x32_bf16 v[136:139], v[64:67], v[88:91], v[136:139]
    ds_read_b64_tr_b16 v[114:115], v20 offset:34368
    s_waitcnt lgkmcnt(6)
    v_mfma_f32_16x16x32_bf16 v[140:143], v[64:67], v[92:95], v[140:143]
    ds_read_b64_tr_b16 v[116:117], v20 offset:36480
    s_waitcnt lgkmcnt(6)
    v_mfma_f32_16x16x32_bf16 v[156:159], v[68:71], v[92:95], v[156:159]
    ds_read_b64_tr_b16 v[118:119], v20 offset:36544
    v_mfma_f32_16x16x32_bf16 v[152:155], v[68:71], v[88:91], v[152:155]
    ds_read_b64_tr_b16 v[120:121], v20 offset:38656
    v_mfma_f32_16x16x32_bf16 v[148:151], v[68:71], v[84:87], v[148:151]
    ds_read_b64_tr_b16 v[122:123], v20 offset:38720
    v_mfma_f32_16x16x32_bf16 v[144:147], v[68:71], v[80:83], v[144:147]
    ds_read_b64_tr_b16 v[124:125], v20 offset:40832
    s_waitcnt lgkmcnt(9)
    v_mfma_f32_16x16x32_bf16 v[160:163], v[72:75], v[80:83], v[160:163]
    ds_read_b64_tr_b16 v[126:127], v20 offset:40896
    v_mfma_f32_16x16x32_bf16 v[164:167], v[72:75], v[84:87], v[164:167]
    ds_read_b128 v[100:103], v17 offset:35840
    v_mfma_f32_16x16x32_bf16 v[168:171], v[72:75], v[88:91], v[168:171]
    ds_read_b128 v[104:107], v17 offset:37888
    v_mfma_f32_16x16x32_bf16 v[172:175], v[72:75], v[92:95], v[172:175]
    ds_read_b128 v[108:111], v17 offset:39936
    s_waitcnt lgkmcnt(12)
    v_mfma_f32_16x16x32_bf16 v[188:191], v[76:79], v[92:95], v[188:191]
    v_mfma_f32_16x16x32_bf16 v[184:187], v[76:79], v[88:91], v[184:187]
    v_mfma_f32_16x16x32_bf16 v[180:183], v[76:79], v[84:87], v[180:183]
    v_mfma_f32_16x16x32_bf16 v[176:179], v[76:79], v[80:83], v[176:179]
    s_waitcnt lgkmcnt(0)
    s_barrier
    v_mfma_f32_16x16x32_bf16 v[128:131], v[96:99], v[112:115], v[128:131]
    ds_read_b128 v[64:67], v18 offset:0
    v_mfma_f32_16x16x32_bf16 v[132:135], v[96:99], v[116:119], v[132:135]
    ds_read_b64_tr_b16 v[80:81], v21 offset:0
    v_mfma_f32_16x16x32_bf16 v[136:139], v[96:99], v[120:123], v[136:139]
    ds_read_b64_tr_b16 v[82:83], v21 offset:64
    v_mfma_f32_16x16x32_bf16 v[140:143], v[96:99], v[124:127], v[140:143]
    ds_read_b64_tr_b16 v[84:85], v21 offset:2176
    v_mfma_f32_16x16x32_bf16 v[156:159], v[100:103], v[124:127], v[156:159]
    ds_read_b64_tr_b16 v[86:87], v21 offset:2240
    v_mfma_f32_16x16x32_bf16 v[152:155], v[100:103], v[120:123], v[152:155]
    ds_read_b64_tr_b16 v[88:89], v21 offset:4352
    v_mfma_f32_16x16x32_bf16 v[148:151], v[100:103], v[116:119], v[148:151]
    ds_read_b64_tr_b16 v[90:91], v21 offset:4416
    v_mfma_f32_16x16x32_bf16 v[144:147], v[100:103], v[112:115], v[144:147]
    ds_read_b64_tr_b16 v[92:93], v21 offset:6528
    v_mfma_f32_16x16x32_bf16 v[160:163], v[104:107], v[112:115], v[160:163]
    ds_read_b64_tr_b16 v[94:95], v21 offset:6592
    v_mfma_f32_16x16x32_bf16 v[164:167], v[104:107], v[116:119], v[164:167]
    ds_read_b128 v[68:71], v18 offset:2048
    v_mfma_f32_16x16x32_bf16 v[168:171], v[104:107], v[120:123], v[168:171]
    ds_read_b128 v[72:75], v18 offset:4096
    v_mfma_f32_16x16x32_bf16 v[172:175], v[104:107], v[124:127], v[172:175]
    ds_read_b128 v[76:79], v18 offset:6144
    v_mfma_f32_16x16x32_bf16 v[188:191], v[108:111], v[124:127], v[188:191]
    v_mfma_f32_16x16x32_bf16 v[184:187], v[108:111], v[120:123], v[184:187]
    v_mfma_f32_16x16x32_bf16 v[180:183], v[108:111], v[116:119], v[180:183]
    v_mfma_f32_16x16x32_bf16 v[176:179], v[108:111], v[112:115], v[176:179]
    s_waitcnt lgkmcnt(9)
    v_mfma_f32_16x16x32_bf16 v[128:131], v[64:67], v[80:83], v[128:131]
    ds_read_b128 v[96:99], v19 offset:0
    s_waitcnt lgkmcnt(8)
    v_mfma_f32_16x16x32_bf16 v[132:135], v[64:67], v[84:87], v[132:135]
    ds_read_b64_tr_b16 v[112:113], v21 offset:512
    s_waitcnt lgkmcnt(7)
    v_mfma_f32_16x16x32_bf16 v[136:139], v[64:67], v[88:91], v[136:139]
    ds_read_b64_tr_b16 v[114:115], v21 offset:576
    s_waitcnt lgkmcnt(6)
    v_mfma_f32_16x16x32_bf16 v[140:143], v[64:67], v[92:95], v[140:143]
    ds_read_b64_tr_b16 v[116:117], v21 offset:2688
    s_waitcnt lgkmcnt(6)
    v_mfma_f32_16x16x32_bf16 v[156:159], v[68:71], v[92:95], v[156:159]
    ds_read_b64_tr_b16 v[118:119], v21 offset:2752
    v_mfma_f32_16x16x32_bf16 v[152:155], v[68:71], v[88:91], v[152:155]
    ds_read_b64_tr_b16 v[120:121], v21 offset:4864
    v_mfma_f32_16x16x32_bf16 v[148:151], v[68:71], v[84:87], v[148:151]
    ds_read_b64_tr_b16 v[122:123], v21 offset:4928
    v_mfma_f32_16x16x32_bf16 v[144:147], v[68:71], v[80:83], v[144:147]
    ds_read_b64_tr_b16 v[124:125], v21 offset:7040
    s_waitcnt lgkmcnt(9)
    v_mfma_f32_16x16x32_bf16 v[160:163], v[72:75], v[80:83], v[160:163]
    ds_read_b64_tr_b16 v[126:127], v21 offset:7104
    v_mfma_f32_16x16x32_bf16 v[164:167], v[72:75], v[84:87], v[164:167]
    ds_read_b128 v[100:103], v19 offset:2048
    v_mfma_f32_16x16x32_bf16 v[168:171], v[72:75], v[88:91], v[168:171]
    ds_read_b128 v[104:107], v19 offset:4096
    v_mfma_f32_16x16x32_bf16 v[172:175], v[72:75], v[92:95], v[172:175]
    ds_read_b128 v[108:111], v19 offset:6144
    s_waitcnt lgkmcnt(12)
    v_mfma_f32_16x16x32_bf16 v[188:191], v[76:79], v[92:95], v[188:191]
    v_mfma_f32_16x16x32_bf16 v[184:187], v[76:79], v[88:91], v[184:187]
    v_mfma_f32_16x16x32_bf16 v[180:183], v[76:79], v[84:87], v[180:183]
    v_mfma_f32_16x16x32_bf16 v[176:179], v[76:79], v[80:83], v[176:179]
    s_waitcnt lgkmcnt(0)
    s_barrier
    v_mfma_f32_16x16x32_bf16 v[128:131], v[96:99], v[112:115], v[128:131]
    ds_read_b128 v[64:67], v18 offset:33792
    v_mfma_f32_16x16x32_bf16 v[132:135], v[96:99], v[116:119], v[132:135]
    ds_read_b64_tr_b16 v[80:81], v21 offset:33792
    v_mfma_f32_16x16x32_bf16 v[136:139], v[96:99], v[120:123], v[136:139]
    ds_read_b64_tr_b16 v[82:83], v21 offset:33856
    v_mfma_f32_16x16x32_bf16 v[140:143], v[96:99], v[124:127], v[140:143]
    ds_read_b64_tr_b16 v[84:85], v21 offset:35968
    v_mfma_f32_16x16x32_bf16 v[156:159], v[100:103], v[124:127], v[156:159]
    ds_read_b64_tr_b16 v[86:87], v21 offset:36032
    v_mfma_f32_16x16x32_bf16 v[152:155], v[100:103], v[120:123], v[152:155]
    ds_read_b64_tr_b16 v[88:89], v21 offset:38144
    v_mfma_f32_16x16x32_bf16 v[148:151], v[100:103], v[116:119], v[148:151]
    ds_read_b64_tr_b16 v[90:91], v21 offset:38208
    v_mfma_f32_16x16x32_bf16 v[144:147], v[100:103], v[112:115], v[144:147]
    ds_read_b64_tr_b16 v[92:93], v21 offset:40320
    v_mfma_f32_16x16x32_bf16 v[160:163], v[104:107], v[112:115], v[160:163]
    ds_read_b64_tr_b16 v[94:95], v21 offset:40384
    v_mfma_f32_16x16x32_bf16 v[164:167], v[104:107], v[116:119], v[164:167]
    ds_read_b128 v[68:71], v18 offset:35840
    v_mfma_f32_16x16x32_bf16 v[168:171], v[104:107], v[120:123], v[168:171]
    ds_read_b128 v[72:75], v18 offset:37888
    v_mfma_f32_16x16x32_bf16 v[172:175], v[104:107], v[124:127], v[172:175]
    ds_read_b128 v[76:79], v18 offset:39936
    v_mfma_f32_16x16x32_bf16 v[188:191], v[108:111], v[124:127], v[188:191]
    v_mfma_f32_16x16x32_bf16 v[184:187], v[108:111], v[120:123], v[184:187]
    v_mfma_f32_16x16x32_bf16 v[180:183], v[108:111], v[116:119], v[180:183]
    v_mfma_f32_16x16x32_bf16 v[176:179], v[108:111], v[112:115], v[176:179]
    s_waitcnt lgkmcnt(9)
    v_mfma_f32_16x16x32_bf16 v[128:131], v[64:67], v[80:83], v[128:131]
    ds_read_b128 v[96:99], v19 offset:33792
    s_waitcnt lgkmcnt(8)
    v_mfma_f32_16x16x32_bf16 v[132:135], v[64:67], v[84:87], v[132:135]
    ds_read_b64_tr_b16 v[112:113], v21 offset:34304
    s_waitcnt lgkmcnt(7)
    v_mfma_f32_16x16x32_bf16 v[136:139], v[64:67], v[88:91], v[136:139]
    ds_read_b64_tr_b16 v[114:115], v21 offset:34368
    s_waitcnt lgkmcnt(6)
    v_mfma_f32_16x16x32_bf16 v[140:143], v[64:67], v[92:95], v[140:143]
    ds_read_b64_tr_b16 v[116:117], v21 offset:36480
    s_waitcnt lgkmcnt(6)
    v_mfma_f32_16x16x32_bf16 v[156:159], v[68:71], v[92:95], v[156:159]
    ds_read_b64_tr_b16 v[118:119], v21 offset:36544
    v_mfma_f32_16x16x32_bf16 v[152:155], v[68:71], v[88:91], v[152:155]
    ds_read_b64_tr_b16 v[120:121], v21 offset:38656
    v_mfma_f32_16x16x32_bf16 v[148:151], v[68:71], v[84:87], v[148:151]
    ds_read_b64_tr_b16 v[122:123], v21 offset:38720
    v_mfma_f32_16x16x32_bf16 v[144:147], v[68:71], v[80:83], v[144:147]
    ds_read_b64_tr_b16 v[124:125], v21 offset:40832
    s_waitcnt lgkmcnt(9)
    v_mfma_f32_16x16x32_bf16 v[160:163], v[72:75], v[80:83], v[160:163]
    ds_read_b64_tr_b16 v[126:127], v21 offset:40896
    v_mfma_f32_16x16x32_bf16 v[164:167], v[72:75], v[84:87], v[164:167]
    ds_read_b128 v[100:103], v19 offset:35840
    v_mfma_f32_16x16x32_bf16 v[168:171], v[72:75], v[88:91], v[168:171]
    ds_read_b128 v[104:107], v19 offset:37888
    v_mfma_f32_16x16x32_bf16 v[172:175], v[72:75], v[92:95], v[172:175]
    ds_read_b128 v[108:111], v19 offset:39936
    s_waitcnt lgkmcnt(12)
    v_mfma_f32_16x16x32_bf16 v[188:191], v[76:79], v[92:95], v[188:191]
    v_mfma_f32_16x16x32_bf16 v[184:187], v[76:79], v[88:91], v[184:187]
    v_mfma_f32_16x16x32_bf16 v[180:183], v[76:79], v[84:87], v[180:183]
    v_mfma_f32_16x16x32_bf16 v[176:179], v[76:79], v[80:83], v[176:179]
    s_waitcnt lgkmcnt(0)
    s_barrier
    v_mfma_f32_16x16x32_bf16 v[128:131], v[96:99], v[112:115], v[128:131]
    ds_read_b128 v[64:67], v16 offset:0
    v_mfma_f32_16x16x32_bf16 v[132:135], v[96:99], v[116:119], v[132:135]
    ds_read_b64_tr_b16 v[80:81], v20 offset:0
    v_mfma_f32_16x16x32_bf16 v[136:139], v[96:99], v[120:123], v[136:139]
    ds_read_b64_tr_b16 v[82:83], v20 offset:64
    v_mfma_f32_16x16x32_bf16 v[140:143], v[96:99], v[124:127], v[140:143]
    ds_read_b64_tr_b16 v[84:85], v20 offset:2176
    v_mfma_f32_16x16x32_bf16 v[156:159], v[100:103], v[124:127], v[156:159]
    ds_read_b64_tr_b16 v[86:87], v20 offset:2240
    v_mfma_f32_16x16x32_bf16 v[152:155], v[100:103], v[120:123], v[152:155]
    ds_read_b64_tr_b16 v[88:89], v20 offset:4352
    v_mfma_f32_16x16x32_bf16 v[148:151], v[100:103], v[116:119], v[148:151]
    ds_read_b64_tr_b16 v[90:91], v20 offset:4416
    v_mfma_f32_16x16x32_bf16 v[144:147], v[100:103], v[112:115], v[144:147]
    ds_read_b64_tr_b16 v[92:93], v20 offset:6528
    v_mfma_f32_16x16x32_bf16 v[160:163], v[104:107], v[112:115], v[160:163]
    ds_read_b64_tr_b16 v[94:95], v20 offset:6592
    v_mfma_f32_16x16x32_bf16 v[164:167], v[104:107], v[116:119], v[164:167]
    ds_read_b128 v[68:71], v16 offset:2048
    v_mfma_f32_16x16x32_bf16 v[168:171], v[104:107], v[120:123], v[168:171]
    ds_read_b128 v[72:75], v16 offset:4096
    v_mfma_f32_16x16x32_bf16 v[172:175], v[104:107], v[124:127], v[172:175]
    ds_read_b128 v[76:79], v16 offset:6144
    v_mfma_f32_16x16x32_bf16 v[188:191], v[108:111], v[124:127], v[188:191]
    v_mfma_f32_16x16x32_bf16 v[184:187], v[108:111], v[120:123], v[184:187]
    v_mfma_f32_16x16x32_bf16 v[180:183], v[108:111], v[116:119], v[180:183]
    v_mfma_f32_16x16x32_bf16 v[176:179], v[108:111], v[112:115], v[176:179]
    s_waitcnt lgkmcnt(9)
    v_mfma_f32_16x16x32_bf16 v[128:131], v[64:67], v[80:83], v[128:131]
    ds_read_b128 v[96:99], v17 offset:0
    s_waitcnt lgkmcnt(8)
    v_mfma_f32_16x16x32_bf16 v[132:135], v[64:67], v[84:87], v[132:135]
    ds_read_b64_tr_b16 v[112:113], v20 offset:512
    s_waitcnt lgkmcnt(7)
    v_mfma_f32_16x16x32_bf16 v[136:139], v[64:67], v[88:91], v[136:139]
    ds_read_b64_tr_b16 v[114:115], v20 offset:576
    s_waitcnt lgkmcnt(6)
    v_mfma_f32_16x16x32_bf16 v[140:143], v[64:67], v[92:95], v[140:143]
    ds_read_b64_tr_b16 v[116:117], v20 offset:2688
    s_waitcnt lgkmcnt(6)
    v_mfma_f32_16x16x32_bf16 v[156:159], v[68:71], v[92:95], v[156:159]
    ds_read_b64_tr_b16 v[118:119], v20 offset:2752
    v_mfma_f32_16x16x32_bf16 v[152:155], v[68:71], v[88:91], v[152:155]
    ds_read_b64_tr_b16 v[120:121], v20 offset:4864
    v_mfma_f32_16x16x32_bf16 v[148:151], v[68:71], v[84:87], v[148:151]
    ds_read_b64_tr_b16 v[122:123], v20 offset:4928
    v_mfma_f32_16x16x32_bf16 v[144:147], v[68:71], v[80:83], v[144:147]
    ds_read_b64_tr_b16 v[124:125], v20 offset:7040
    s_waitcnt lgkmcnt(9)
    v_mfma_f32_16x16x32_bf16 v[160:163], v[72:75], v[80:83], v[160:163]
    ds_read_b64_tr_b16 v[126:127], v20 offset:7104
    v_mfma_f32_16x16x32_bf16 v[164:167], v[72:75], v[84:87], v[164:167]
    ds_read_b128 v[100:103], v17 offset:2048
    v_mfma_f32_16x16x32_bf16 v[168:171], v[72:75], v[88:91], v[168:171]
    ds_read_b128 v[104:107], v17 offset:4096
    v_mfma_f32_16x16x32_bf16 v[172:175], v[72:75], v[92:95], v[172:175]
    ds_read_b128 v[108:111], v17 offset:6144
    s_waitcnt lgkmcnt(12)
    v_mfma_f32_16x16x32_bf16 v[188:191], v[76:79], v[92:95], v[188:191]
    v_mfma_f32_16x16x32_bf16 v[184:187], v[76:79], v[88:91], v[184:187]
    v_mfma_f32_16x16x32_bf16 v[180:183], v[76:79], v[84:87], v[180:183]
    v_mfma_f32_16x16x32_bf16 v[176:179], v[76:79], v[80:83], v[176:179]
    s_waitcnt lgkmcnt(0)
    s_barrier
    v_mfma_f32_16x16x32_bf16 v[128:131], v[96:99], v[112:115], v[128:131]
    ds_read_b128 v[64:67], v16 offset:33792
    v_mfma_f32_16x16x32_bf16 v[132:135], v[96:99], v[116:119], v[132:135]
    ds_read_b64_tr_b16 v[80:81], v20 offset:33792
    v_mfma_f32_16x16x32_bf16 v[136:139], v[96:99], v[120:123], v[136:139]
    ds_read_b64_tr_b16 v[82:83], v20 offset:33856
    v_mfma_f32_16x16x32_bf16 v[140:143], v[96:99], v[124:127], v[140:143]
    ds_read_b64_tr_b16 v[84:85], v20 offset:35968
    v_mfma_f32_16x16x32_bf16 v[156:159], v[100:103], v[124:127], v[156:159]
    ds_read_b64_tr_b16 v[86:87], v20 offset:36032
    v_mfma_f32_16x16x32_bf16 v[152:155], v[100:103], v[120:123], v[152:155]
    ds_read_b64_tr_b16 v[88:89], v20 offset:38144
    v_mfma_f32_16x16x32_bf16 v[148:151], v[100:103], v[116:119], v[148:151]
    ds_read_b64_tr_b16 v[90:91], v20 offset:38208
    v_mfma_f32_16x16x32_bf16 v[144:147], v[100:103], v[112:115], v[144:147]
    ds_read_b64_tr_b16 v[92:93], v20 offset:40320
    v_mfma_f32_16x16x32_bf16 v[160:163], v[104:107], v[112:115], v[160:163]
    ds_read_b64_tr_b16 v[94:95], v20 offset:40384
    v_mfma_f32_16x16x32_bf16 v[164:167], v[104:107], v[116:119], v[164:167]
    ds_read_b128 v[68:71], v16 offset:35840
    v_mfma_f32_16x16x32_bf16 v[168:171], v[104:107], v[120:123], v[168:171]
    ds_read_b128 v[72:75], v16 offset:37888
    v_mfma_f32_16x16x32_bf16 v[172:175], v[104:107], v[124:127], v[172:175]
    ds_read_b128 v[76:79], v16 offset:39936
    v_mfma_f32_16x16x32_bf16 v[188:191], v[108:111], v[124:127], v[188:191]
    v_mfma_f32_16x16x32_bf16 v[184:187], v[108:111], v[120:123], v[184:187]
    v_mfma_f32_16x16x32_bf16 v[180:183], v[108:111], v[116:119], v[180:183]
    v_mfma_f32_16x16x32_bf16 v[176:179], v[108:111], v[112:115], v[176:179]
    s_waitcnt lgkmcnt(9)
    v_mfma_f32_16x16x32_bf16 v[128:131], v[64:67], v[80:83], v[128:131]
    ds_read_b128 v[96:99], v17 offset:33792
    s_waitcnt lgkmcnt(8)
    v_mfma_f32_16x16x32_bf16 v[132:135], v[64:67], v[84:87], v[132:135]
    ds_read_b64_tr_b16 v[112:113], v20 offset:34304
    s_waitcnt lgkmcnt(7)
    v_mfma_f32_16x16x32_bf16 v[136:139], v[64:67], v[88:91], v[136:139]
    ds_read_b64_tr_b16 v[114:115], v20 offset:34368
    s_waitcnt lgkmcnt(6)
    v_mfma_f32_16x16x32_bf16 v[140:143], v[64:67], v[92:95], v[140:143]
    ds_read_b64_tr_b16 v[116:117], v20 offset:36480
    s_waitcnt lgkmcnt(6)
    v_mfma_f32_16x16x32_bf16 v[156:159], v[68:71], v[92:95], v[156:159]
    ds_read_b64_tr_b16 v[118:119], v20 offset:36544
    v_mfma_f32_16x16x32_bf16 v[152:155], v[68:71], v[88:91], v[152:155]
    ds_read_b64_tr_b16 v[120:121], v20 offset:38656
    v_mfma_f32_16x16x32_bf16 v[148:151], v[68:71], v[84:87], v[148:151]
    ds_read_b64_tr_b16 v[122:123], v20 offset:38720
    v_mfma_f32_16x16x32_bf16 v[144:147], v[68:71], v[80:83], v[144:147]
    ds_read_b64_tr_b16 v[124:125], v20 offset:40832
    s_waitcnt lgkmcnt(9)
    v_mfma_f32_16x16x32_bf16 v[160:163], v[72:75], v[80:83], v[160:163]
    ds_read_b64_tr_b16 v[126:127], v20 offset:40896
    v_mfma_f32_16x16x32_bf16 v[164:167], v[72:75], v[84:87], v[164:167]
    ds_read_b128 v[100:103], v17 offset:35840
    v_mfma_f32_16x16x32_bf16 v[168:171], v[72:75], v[88:91], v[168:171]
    ds_read_b128 v[104:107], v17 offset:37888
    v_mfma_f32_16x16x32_bf16 v[172:175], v[72:75], v[92:95], v[172:175]
    ds_read_b128 v[108:111], v17 offset:39936
    s_waitcnt lgkmcnt(12)
    v_mfma_f32_16x16x32_bf16 v[188:191], v[76:79], v[92:95], v[188:191]
    v_mfma_f32_16x16x32_bf16 v[184:187], v[76:79], v[88:91], v[184:187]
    v_mfma_f32_16x16x32_bf16 v[180:183], v[76:79], v[84:87], v[180:183]
    v_mfma_f32_16x16x32_bf16 v[176:179], v[76:79], v[80:83], v[176:179]
    s_waitcnt lgkmcnt(0)
    s_barrier
    v_mfma_f32_16x16x32_bf16 v[128:131], v[96:99], v[112:115], v[128:131]
    ds_read_b128 v[64:67], v18 offset:0
    v_mfma_f32_16x16x32_bf16 v[132:135], v[96:99], v[116:119], v[132:135]
    ds_read_b64_tr_b16 v[80:81], v21 offset:0
    v_mfma_f32_16x16x32_bf16 v[136:139], v[96:99], v[120:123], v[136:139]
    ds_read_b64_tr_b16 v[82:83], v21 offset:64
    v_mfma_f32_16x16x32_bf16 v[140:143], v[96:99], v[124:127], v[140:143]
    ds_read_b64_tr_b16 v[84:85], v21 offset:2176
    v_mfma_f32_16x16x32_bf16 v[156:159], v[100:103], v[124:127], v[156:159]
    ds_read_b64_tr_b16 v[86:87], v21 offset:2240
    v_mfma_f32_16x16x32_bf16 v[152:155], v[100:103], v[120:123], v[152:155]
    ds_read_b64_tr_b16 v[88:89], v21 offset:4352
    v_mfma_f32_16x16x32_bf16 v[148:151], v[100:103], v[116:119], v[148:151]
    ds_read_b64_tr_b16 v[90:91], v21 offset:4416
    v_mfma_f32_16x16x32_bf16 v[144:147], v[100:103], v[112:115], v[144:147]
    ds_read_b64_tr_b16 v[92:93], v21 offset:6528
    v_mfma_f32_16x16x32_bf16 v[160:163], v[104:107], v[112:115], v[160:163]
    ds_read_b64_tr_b16 v[94:95], v21 offset:6592
    v_mfma_f32_16x16x32_bf16 v[164:167], v[104:107], v[116:119], v[164:167]
    ds_read_b128 v[68:71], v18 offset:2048
    v_mfma_f32_16x16x32_bf16 v[168:171], v[104:107], v[120:123], v[168:171]
    ds_read_b128 v[72:75], v18 offset:4096
    v_mfma_f32_16x16x32_bf16 v[172:175], v[104:107], v[124:127], v[172:175]
    ds_read_b128 v[76:79], v18 offset:6144
    v_mfma_f32_16x16x32_bf16 v[188:191], v[108:111], v[124:127], v[188:191]
    v_mfma_f32_16x16x32_bf16 v[184:187], v[108:111], v[120:123], v[184:187]
    v_mfma_f32_16x16x32_bf16 v[180:183], v[108:111], v[116:119], v[180:183]
    v_mfma_f32_16x16x32_bf16 v[176:179], v[108:111], v[112:115], v[176:179]
    s_waitcnt lgkmcnt(9)
    v_mfma_f32_16x16x32_bf16 v[128:131], v[64:67], v[80:83], v[128:131]
    ds_read_b128 v[96:99], v19 offset:0
    s_waitcnt lgkmcnt(8)
    v_mfma_f32_16x16x32_bf16 v[132:135], v[64:67], v[84:87], v[132:135]
    ds_read_b64_tr_b16 v[112:113], v21 offset:512
    s_waitcnt lgkmcnt(7)
    v_mfma_f32_16x16x32_bf16 v[136:139], v[64:67], v[88:91], v[136:139]
    ds_read_b64_tr_b16 v[114:115], v21 offset:576
    s_waitcnt lgkmcnt(6)
    v_mfma_f32_16x16x32_bf16 v[140:143], v[64:67], v[92:95], v[140:143]
    ds_read_b64_tr_b16 v[116:117], v21 offset:2688
    s_waitcnt lgkmcnt(6)
    v_mfma_f32_16x16x32_bf16 v[156:159], v[68:71], v[92:95], v[156:159]
    ds_read_b64_tr_b16 v[118:119], v21 offset:2752
    v_mfma_f32_16x16x32_bf16 v[152:155], v[68:71], v[88:91], v[152:155]
    ds_read_b64_tr_b16 v[120:121], v21 offset:4864
    v_mfma_f32_16x16x32_bf16 v[148:151], v[68:71], v[84:87], v[148:151]
    ds_read_b64_tr_b16 v[122:123], v21 offset:4928
    v_mfma_f32_16x16x32_bf16 v[144:147], v[68:71], v[80:83], v[144:147]
    ds_read_b64_tr_b16 v[124:125], v21 offset:7040
    s_waitcnt lgkmcnt(9)
    v_mfma_f32_16x16x32_bf16 v[160:163], v[72:75], v[80:83], v[160:163]
    ds_read_b64_tr_b16 v[126:127], v21 offset:7104
    v_mfma_f32_16x16x32_bf16 v[164:167], v[72:75], v[84:87], v[164:167]
    ds_read_b128 v[100:103], v19 offset:2048
    v_mfma_f32_16x16x32_bf16 v[168:171], v[72:75], v[88:91], v[168:171]
    ds_read_b128 v[104:107], v19 offset:4096
    v_mfma_f32_16x16x32_bf16 v[172:175], v[72:75], v[92:95], v[172:175]
    ds_read_b128 v[108:111], v19 offset:6144
    s_waitcnt lgkmcnt(12)
    v_mfma_f32_16x16x32_bf16 v[188:191], v[76:79], v[92:95], v[188:191]
    v_mfma_f32_16x16x32_bf16 v[184:187], v[76:79], v[88:91], v[184:187]
    v_mfma_f32_16x16x32_bf16 v[180:183], v[76:79], v[84:87], v[180:183]
    v_mfma_f32_16x16x32_bf16 v[176:179], v[76:79], v[80:83], v[176:179]
    s_waitcnt lgkmcnt(0)
    s_barrier
    v_mfma_f32_16x16x32_bf16 v[128:131], v[96:99], v[112:115], v[128:131]
    ds_read_b128 v[64:67], v18 offset:33792
    v_mfma_f32_16x16x32_bf16 v[132:135], v[96:99], v[116:119], v[132:135]
    ds_read_b64_tr_b16 v[80:81], v21 offset:33792
    v_mfma_f32_16x16x32_bf16 v[136:139], v[96:99], v[120:123], v[136:139]
    ds_read_b64_tr_b16 v[82:83], v21 offset:33856
    v_mfma_f32_16x16x32_bf16 v[140:143], v[96:99], v[124:127], v[140:143]
    ds_read_b64_tr_b16 v[84:85], v21 offset:35968
    v_mfma_f32_16x16x32_bf16 v[156:159], v[100:103], v[124:127], v[156:159]
    ds_read_b64_tr_b16 v[86:87], v21 offset:36032
    v_mfma_f32_16x16x32_bf16 v[152:155], v[100:103], v[120:123], v[152:155]
    ds_read_b64_tr_b16 v[88:89], v21 offset:38144
    v_mfma_f32_16x16x32_bf16 v[148:151], v[100:103], v[116:119], v[148:151]
    ds_read_b64_tr_b16 v[90:91], v21 offset:38208
    v_mfma_f32_16x16x32_bf16 v[144:147], v[100:103], v[112:115], v[144:147]
    ds_read_b64_tr_b16 v[92:93], v21 offset:40320
    v_mfma_f32_16x16x32_bf16 v[160:163], v[104:107], v[112:115], v[160:163]
    ds_read_b64_tr_b16 v[94:95], v21 offset:40384
    v_mfma_f32_16x16x32_bf16 v[164:167], v[104:107], v[116:119], v[164:167]
    ds_read_b128 v[68:71], v18 offset:35840
    v_mfma_f32_16x16x32_bf16 v[168:171], v[104:107], v[120:123], v[168:171]
    ds_read_b128 v[72:75], v18 offset:37888
    v_mfma_f32_16x16x32_bf16 v[172:175], v[104:107], v[124:127], v[172:175]
    ds_read_b128 v[76:79], v18 offset:39936
    v_mfma_f32_16x16x32_bf16 v[188:191], v[108:111], v[124:127], v[188:191]
    v_mfma_f32_16x16x32_bf16 v[184:187], v[108:111], v[120:123], v[184:187]
    v_mfma_f32_16x16x32_bf16 v[180:183], v[108:111], v[116:119], v[180:183]
    v_mfma_f32_16x16x32_bf16 v[176:179], v[108:111], v[112:115], v[176:179]
    s_waitcnt lgkmcnt(9)
    v_mfma_f32_16x16x32_bf16 v[128:131], v[64:67], v[80:83], v[128:131]
    ds_read_b128 v[96:99], v19 offset:33792
    s_waitcnt lgkmcnt(8)
    v_mfma_f32_16x16x32_bf16 v[132:135], v[64:67], v[84:87], v[132:135]
    ds_read_b64_tr_b16 v[112:113], v21 offset:34304
    s_waitcnt lgkmcnt(7)
    v_mfma_f32_16x16x32_bf16 v[136:139], v[64:67], v[88:91], v[136:139]
    ds_read_b64_tr_b16 v[114:115], v21 offset:34368
    s_waitcnt lgkmcnt(6)
    v_mfma_f32_16x16x32_bf16 v[140:143], v[64:67], v[92:95], v[140:143]
    ds_read_b64_tr_b16 v[116:117], v21 offset:36480
    s_waitcnt lgkmcnt(6)
    v_mfma_f32_16x16x32_bf16 v[156:159], v[68:71], v[92:95], v[156:159]
    ds_read_b64_tr_b16 v[118:119], v21 offset:36544
    v_mfma_f32_16x16x32_bf16 v[152:155], v[68:71], v[88:91], v[152:155]
    ds_read_b64_tr_b16 v[120:121], v21 offset:38656
    v_mfma_f32_16x16x32_bf16 v[148:151], v[68:71], v[84:87], v[148:151]
    ds_read_b64_tr_b16 v[122:123], v21 offset:38720
    v_mfma_f32_16x16x32_bf16 v[144:147], v[68:71], v[80:83], v[144:147]
    ds_read_b64_tr_b16 v[124:125], v21 offset:40832
    s_waitcnt lgkmcnt(9)
    v_mfma_f32_16x16x32_bf16 v[160:163], v[72:75], v[80:83], v[160:163]
    ds_read_b64_tr_b16 v[126:127], v21 offset:40896
    v_mfma_f32_16x16x32_bf16 v[164:167], v[72:75], v[84:87], v[164:167]
    ds_read_b128 v[100:103], v19 offset:35840
    v_mfma_f32_16x16x32_bf16 v[168:171], v[72:75], v[88:91], v[168:171]
    ds_read_b128 v[104:107], v19 offset:37888
    v_mfma_f32_16x16x32_bf16 v[172:175], v[72:75], v[92:95], v[172:175]
    ds_read_b128 v[108:111], v19 offset:39936
    s_waitcnt lgkmcnt(12)
    v_mfma_f32_16x16x32_bf16 v[188:191], v[76:79], v[92:95], v[188:191]
    v_mfma_f32_16x16x32_bf16 v[184:187], v[76:79], v[88:91], v[184:187]
    v_mfma_f32_16x16x32_bf16 v[180:183], v[76:79], v[84:87], v[180:183]
    v_mfma_f32_16x16x32_bf16 v[176:179], v[76:79], v[80:83], v[176:179]
    s_waitcnt lgkmcnt(0)
    s_barrier
    v_mfma_f32_16x16x32_bf16 v[128:131], v[96:99], v[112:115], v[128:131]
    ds_read_b128 v[64:67], v16 offset:0
    v_mfma_f32_16x16x32_bf16 v[132:135], v[96:99], v[116:119], v[132:135]
    ds_read_b64_tr_b16 v[80:81], v20 offset:0
    v_mfma_f32_16x16x32_bf16 v[136:139], v[96:99], v[120:123], v[136:139]
    ds_read_b64_tr_b16 v[82:83], v20 offset:64
    v_mfma_f32_16x16x32_bf16 v[140:143], v[96:99], v[124:127], v[140:143]
    ds_read_b64_tr_b16 v[84:85], v20 offset:2176
    v_mfma_f32_16x16x32_bf16 v[156:159], v[100:103], v[124:127], v[156:159]
    ds_read_b64_tr_b16 v[86:87], v20 offset:2240
    v_mfma_f32_16x16x32_bf16 v[152:155], v[100:103], v[120:123], v[152:155]
    ds_read_b64_tr_b16 v[88:89], v20 offset:4352
    v_mfma_f32_16x16x32_bf16 v[148:151], v[100:103], v[116:119], v[148:151]
    ds_read_b64_tr_b16 v[90:91], v20 offset:4416
    v_mfma_f32_16x16x32_bf16 v[144:147], v[100:103], v[112:115], v[144:147]
    ds_read_b64_tr_b16 v[92:93], v20 offset:6528
    v_mfma_f32_16x16x32_bf16 v[160:163], v[104:107], v[112:115], v[160:163]
    ds_read_b64_tr_b16 v[94:95], v20 offset:6592
    v_mfma_f32_16x16x32_bf16 v[164:167], v[104:107], v[116:119], v[164:167]
    ds_read_b128 v[68:71], v16 offset:2048
    v_mfma_f32_16x16x32_bf16 v[168:171], v[104:107], v[120:123], v[168:171]
    ds_read_b128 v[72:75], v16 offset:4096
    v_mfma_f32_16x16x32_bf16 v[172:175], v[104:107], v[124:127], v[172:175]
    ds_read_b128 v[76:79], v16 offset:6144
    v_mfma_f32_16x16x32_bf16 v[188:191], v[108:111], v[124:127], v[188:191]
    v_mfma_f32_16x16x32_bf16 v[184:187], v[108:111], v[120:123], v[184:187]
    v_mfma_f32_16x16x32_bf16 v[180:183], v[108:111], v[116:119], v[180:183]
    v_mfma_f32_16x16x32_bf16 v[176:179], v[108:111], v[112:115], v[176:179]
    s_waitcnt lgkmcnt(9)
    v_mfma_f32_16x16x32_bf16 v[128:131], v[64:67], v[80:83], v[128:131]
    ds_read_b128 v[96:99], v17 offset:0
    s_waitcnt lgkmcnt(8)
    v_mfma_f32_16x16x32_bf16 v[132:135], v[64:67], v[84:87], v[132:135]
    ds_read_b64_tr_b16 v[112:113], v20 offset:512
    s_waitcnt lgkmcnt(7)
    v_mfma_f32_16x16x32_bf16 v[136:139], v[64:67], v[88:91], v[136:139]
    ds_read_b64_tr_b16 v[114:115], v20 offset:576
    s_waitcnt lgkmcnt(6)
    v_mfma_f32_16x16x32_bf16 v[140:143], v[64:67], v[92:95], v[140:143]
    ds_read_b64_tr_b16 v[116:117], v20 offset:2688
    s_waitcnt lgkmcnt(6)
    v_mfma_f32_16x16x32_bf16 v[156:159], v[68:71], v[92:95], v[156:159]
    ds_read_b64_tr_b16 v[118:119], v20 offset:2752
    v_mfma_f32_16x16x32_bf16 v[152:155], v[68:71], v[88:91], v[152:155]
    ds_read_b64_tr_b16 v[120:121], v20 offset:4864
    v_mfma_f32_16x16x32_bf16 v[148:151], v[68:71], v[84:87], v[148:151]
    ds_read_b64_tr_b16 v[122:123], v20 offset:4928
    v_mfma_f32_16x16x32_bf16 v[144:147], v[68:71], v[80:83], v[144:147]
    ds_read_b64_tr_b16 v[124:125], v20 offset:7040
    s_waitcnt lgkmcnt(9)
    v_mfma_f32_16x16x32_bf16 v[160:163], v[72:75], v[80:83], v[160:163]
    ds_read_b64_tr_b16 v[126:127], v20 offset:7104
    v_mfma_f32_16x16x32_bf16 v[164:167], v[72:75], v[84:87], v[164:167]
    ds_read_b128 v[100:103], v17 offset:2048
    v_mfma_f32_16x16x32_bf16 v[168:171], v[72:75], v[88:91], v[168:171]
    ds_read_b128 v[104:107], v17 offset:4096
    v_mfma_f32_16x16x32_bf16 v[172:175], v[72:75], v[92:95], v[172:175]
    ds_read_b128 v[108:111], v17 offset:6144
    s_waitcnt lgkmcnt(12)
    v_mfma_f32_16x16x32_bf16 v[188:191], v[76:79], v[92:95], v[188:191]
    v_mfma_f32_16x16x32_bf16 v[184:187], v[76:79], v[88:91], v[184:187]
    v_mfma_f32_16x16x32_bf16 v[180:183], v[76:79], v[84:87], v[180:183]
    v_mfma_f32_16x16x32_bf16 v[176:179], v[76:79], v[80:83], v[176:179]
    s_waitcnt lgkmcnt(0)
    s_barrier
    v_mfma_f32_16x16x32_bf16 v[128:131], v[96:99], v[112:115], v[128:131]
    ds_read_b128 v[64:67], v16 offset:33792
    v_mfma_f32_16x16x32_bf16 v[132:135], v[96:99], v[116:119], v[132:135]
    ds_read_b64_tr_b16 v[80:81], v20 offset:33792
    v_mfma_f32_16x16x32_bf16 v[136:139], v[96:99], v[120:123], v[136:139]
    ds_read_b64_tr_b16 v[82:83], v20 offset:33856
    v_mfma_f32_16x16x32_bf16 v[140:143], v[96:99], v[124:127], v[140:143]
    ds_read_b64_tr_b16 v[84:85], v20 offset:35968
    v_mfma_f32_16x16x32_bf16 v[156:159], v[100:103], v[124:127], v[156:159]
    ds_read_b64_tr_b16 v[86:87], v20 offset:36032
    v_mfma_f32_16x16x32_bf16 v[152:155], v[100:103], v[120:123], v[152:155]
    ds_read_b64_tr_b16 v[88:89], v20 offset:38144
    v_mfma_f32_16x16x32_bf16 v[148:151], v[100:103], v[116:119], v[148:151]
    ds_read_b64_tr_b16 v[90:91], v20 offset:38208
    v_mfma_f32_16x16x32_bf16 v[144:147], v[100:103], v[112:115], v[144:147]
    ds_read_b64_tr_b16 v[92:93], v20 offset:40320
    v_mfma_f32_16x16x32_bf16 v[160:163], v[104:107], v[112:115], v[160:163]
    ds_read_b64_tr_b16 v[94:95], v20 offset:40384
    v_mfma_f32_16x16x32_bf16 v[164:167], v[104:107], v[116:119], v[164:167]
    ds_read_b128 v[68:71], v16 offset:35840
    v_mfma_f32_16x16x32_bf16 v[168:171], v[104:107], v[120:123], v[168:171]
    ds_read_b128 v[72:75], v16 offset:37888
    v_mfma_f32_16x16x32_bf16 v[172:175], v[104:107], v[124:127], v[172:175]
    ds_read_b128 v[76:79], v16 offset:39936
    v_mfma_f32_16x16x32_bf16 v[188:191], v[108:111], v[124:127], v[188:191]
    v_mfma_f32_16x16x32_bf16 v[184:187], v[108:111], v[120:123], v[184:187]
    v_mfma_f32_16x16x32_bf16 v[180:183], v[108:111], v[116:119], v[180:183]
    v_mfma_f32_16x16x32_bf16 v[176:179], v[108:111], v[112:115], v[176:179]
    s_waitcnt lgkmcnt(9)
    v_mfma_f32_16x16x32_bf16 v[128:131], v[64:67], v[80:83], v[128:131]
    ds_read_b128 v[96:99], v17 offset:33792
    s_waitcnt lgkmcnt(8)
    v_mfma_f32_16x16x32_bf16 v[132:135], v[64:67], v[84:87], v[132:135]
    ds_read_b64_tr_b16 v[112:113], v20 offset:34304
    s_waitcnt lgkmcnt(7)
    v_mfma_f32_16x16x32_bf16 v[136:139], v[64:67], v[88:91], v[136:139]
    ds_read_b64_tr_b16 v[114:115], v20 offset:34368
    s_waitcnt lgkmcnt(6)
    v_mfma_f32_16x16x32_bf16 v[140:143], v[64:67], v[92:95], v[140:143]
    ds_read_b64_tr_b16 v[116:117], v20 offset:36480
    s_waitcnt lgkmcnt(6)
    v_mfma_f32_16x16x32_bf16 v[156:159], v[68:71], v[92:95], v[156:159]
    ds_read_b64_tr_b16 v[118:119], v20 offset:36544
    v_mfma_f32_16x16x32_bf16 v[152:155], v[68:71], v[88:91], v[152:155]
    ds_read_b64_tr_b16 v[120:121], v20 offset:38656
    v_mfma_f32_16x16x32_bf16 v[148:151], v[68:71], v[84:87], v[148:151]
    ds_read_b64_tr_b16 v[122:123], v20 offset:38720
    v_mfma_f32_16x16x32_bf16 v[144:147], v[68:71], v[80:83], v[144:147]
    ds_read_b64_tr_b16 v[124:125], v20 offset:40832
    s_waitcnt lgkmcnt(9)
    v_mfma_f32_16x16x32_bf16 v[160:163], v[72:75], v[80:83], v[160:163]
    ds_read_b64_tr_b16 v[126:127], v20 offset:40896
    v_mfma_f32_16x16x32_bf16 v[164:167], v[72:75], v[84:87], v[164:167]
    ds_read_b128 v[100:103], v17 offset:35840
    v_mfma_f32_16x16x32_bf16 v[168:171], v[72:75], v[88:91], v[168:171]
    ds_read_b128 v[104:107], v17 offset:37888
    v_mfma_f32_16x16x32_bf16 v[172:175], v[72:75], v[92:95], v[172:175]
    ds_read_b128 v[108:111], v17 offset:39936
    s_waitcnt lgkmcnt(12)
    v_mfma_f32_16x16x32_bf16 v[188:191], v[76:79], v[92:95], v[188:191]
    v_mfma_f32_16x16x32_bf16 v[184:187], v[76:79], v[88:91], v[184:187]
    v_mfma_f32_16x16x32_bf16 v[180:183], v[76:79], v[84:87], v[180:183]
    v_mfma_f32_16x16x32_bf16 v[176:179], v[76:79], v[80:83], v[176:179]
    s_waitcnt lgkmcnt(0)
    s_barrier
    v_mfma_f32_16x16x32_bf16 v[128:131], v[96:99], v[112:115], v[128:131]
    ds_read_b128 v[64:67], v18 offset:0
    v_mfma_f32_16x16x32_bf16 v[132:135], v[96:99], v[116:119], v[132:135]
    ds_read_b64_tr_b16 v[80:81], v21 offset:0
    v_mfma_f32_16x16x32_bf16 v[136:139], v[96:99], v[120:123], v[136:139]
    ds_read_b64_tr_b16 v[82:83], v21 offset:64
    v_mfma_f32_16x16x32_bf16 v[140:143], v[96:99], v[124:127], v[140:143]
    ds_read_b64_tr_b16 v[84:85], v21 offset:2176
    v_mfma_f32_16x16x32_bf16 v[156:159], v[100:103], v[124:127], v[156:159]
    ds_read_b64_tr_b16 v[86:87], v21 offset:2240
    v_mfma_f32_16x16x32_bf16 v[152:155], v[100:103], v[120:123], v[152:155]
    ds_read_b64_tr_b16 v[88:89], v21 offset:4352
    v_mfma_f32_16x16x32_bf16 v[148:151], v[100:103], v[116:119], v[148:151]
    ds_read_b64_tr_b16 v[90:91], v21 offset:4416
    v_mfma_f32_16x16x32_bf16 v[144:147], v[100:103], v[112:115], v[144:147]
    ds_read_b64_tr_b16 v[92:93], v21 offset:6528
    v_mfma_f32_16x16x32_bf16 v[160:163], v[104:107], v[112:115], v[160:163]
    ds_read_b64_tr_b16 v[94:95], v21 offset:6592
    v_mfma_f32_16x16x32_bf16 v[164:167], v[104:107], v[116:119], v[164:167]
    ds_read_b128 v[68:71], v18 offset:2048
    v_mfma_f32_16x16x32_bf16 v[168:171], v[104:107], v[120:123], v[168:171]
    ds_read_b128 v[72:75], v18 offset:4096
    v_mfma_f32_16x16x32_bf16 v[172:175], v[104:107], v[124:127], v[172:175]
    ds_read_b128 v[76:79], v18 offset:6144
    v_mfma_f32_16x16x32_bf16 v[188:191], v[108:111], v[124:127], v[188:191]
    v_mfma_f32_16x16x32_bf16 v[184:187], v[108:111], v[120:123], v[184:187]
    v_mfma_f32_16x16x32_bf16 v[180:183], v[108:111], v[116:119], v[180:183]
    v_mfma_f32_16x16x32_bf16 v[176:179], v[108:111], v[112:115], v[176:179]
    s_waitcnt lgkmcnt(9)
    v_mfma_f32_16x16x32_bf16 v[128:131], v[64:67], v[80:83], v[128:131]
    ds_read_b128 v[96:99], v19 offset:0
    s_waitcnt lgkmcnt(8)
    v_mfma_f32_16x16x32_bf16 v[132:135], v[64:67], v[84:87], v[132:135]
    ds_read_b64_tr_b16 v[112:113], v21 offset:512
    s_waitcnt lgkmcnt(7)
    v_mfma_f32_16x16x32_bf16 v[136:139], v[64:67], v[88:91], v[136:139]
    ds_read_b64_tr_b16 v[114:115], v21 offset:576
    s_waitcnt lgkmcnt(6)
    v_mfma_f32_16x16x32_bf16 v[140:143], v[64:67], v[92:95], v[140:143]
    ds_read_b64_tr_b16 v[116:117], v21 offset:2688
    s_waitcnt lgkmcnt(6)
    v_mfma_f32_16x16x32_bf16 v[156:159], v[68:71], v[92:95], v[156:159]
    ds_read_b64_tr_b16 v[118:119], v21 offset:2752
    v_mfma_f32_16x16x32_bf16 v[152:155], v[68:71], v[88:91], v[152:155]
    ds_read_b64_tr_b16 v[120:121], v21 offset:4864
    v_mfma_f32_16x16x32_bf16 v[148:151], v[68:71], v[84:87], v[148:151]
    ds_read_b64_tr_b16 v[122:123], v21 offset:4928
    v_mfma_f32_16x16x32_bf16 v[144:147], v[68:71], v[80:83], v[144:147]
    ds_read_b64_tr_b16 v[124:125], v21 offset:7040
    s_waitcnt lgkmcnt(9)
    v_mfma_f32_16x16x32_bf16 v[160:163], v[72:75], v[80:83], v[160:163]
    ds_read_b64_tr_b16 v[126:127], v21 offset:7104
    v_mfma_f32_16x16x32_bf16 v[164:167], v[72:75], v[84:87], v[164:167]
    ds_read_b128 v[100:103], v19 offset:2048
    v_mfma_f32_16x16x32_bf16 v[168:171], v[72:75], v[88:91], v[168:171]
    ds_read_b128 v[104:107], v19 offset:4096
    v_mfma_f32_16x16x32_bf16 v[172:175], v[72:75], v[92:95], v[172:175]
    ds_read_b128 v[108:111], v19 offset:6144
    s_waitcnt lgkmcnt(12)
    v_mfma_f32_16x16x32_bf16 v[188:191], v[76:79], v[92:95], v[188:191]
    v_mfma_f32_16x16x32_bf16 v[184:187], v[76:79], v[88:91], v[184:187]
    v_mfma_f32_16x16x32_bf16 v[180:183], v[76:79], v[84:87], v[180:183]
    v_mfma_f32_16x16x32_bf16 v[176:179], v[76:79], v[80:83], v[176:179]
    s_waitcnt lgkmcnt(0)
    s_barrier
    v_mfma_f32_16x16x32_bf16 v[128:131], v[96:99], v[112:115], v[128:131]
    ds_read_b128 v[64:67], v18 offset:33792
    v_mfma_f32_16x16x32_bf16 v[132:135], v[96:99], v[116:119], v[132:135]
    ds_read_b64_tr_b16 v[80:81], v21 offset:33792
    v_mfma_f32_16x16x32_bf16 v[136:139], v[96:99], v[120:123], v[136:139]
    ds_read_b64_tr_b16 v[82:83], v21 offset:33856
    v_mfma_f32_16x16x32_bf16 v[140:143], v[96:99], v[124:127], v[140:143]
    ds_read_b64_tr_b16 v[84:85], v21 offset:35968
    v_mfma_f32_16x16x32_bf16 v[156:159], v[100:103], v[124:127], v[156:159]
    ds_read_b64_tr_b16 v[86:87], v21 offset:36032
    v_mfma_f32_16x16x32_bf16 v[152:155], v[100:103], v[120:123], v[152:155]
    ds_read_b64_tr_b16 v[88:89], v21 offset:38144
    v_mfma_f32_16x16x32_bf16 v[148:151], v[100:103], v[116:119], v[148:151]
    ds_read_b64_tr_b16 v[90:91], v21 offset:38208
    v_mfma_f32_16x16x32_bf16 v[144:147], v[100:103], v[112:115], v[144:147]
    ds_read_b64_tr_b16 v[92:93], v21 offset:40320
    v_mfma_f32_16x16x32_bf16 v[160:163], v[104:107], v[112:115], v[160:163]
    ds_read_b64_tr_b16 v[94:95], v21 offset:40384
    v_mfma_f32_16x16x32_bf16 v[164:167], v[104:107], v[116:119], v[164:167]
    ds_read_b128 v[68:71], v18 offset:35840
    v_mfma_f32_16x16x32_bf16 v[168:171], v[104:107], v[120:123], v[168:171]
    ds_read_b128 v[72:75], v18 offset:37888
    v_mfma_f32_16x16x32_bf16 v[172:175], v[104:107], v[124:127], v[172:175]
    ds_read_b128 v[76:79], v18 offset:39936
    v_mfma_f32_16x16x32_bf16 v[188:191], v[108:111], v[124:127], v[188:191]
    v_mfma_f32_16x16x32_bf16 v[184:187], v[108:111], v[120:123], v[184:187]
    v_mfma_f32_16x16x32_bf16 v[180:183], v[108:111], v[116:119], v[180:183]
    v_mfma_f32_16x16x32_bf16 v[176:179], v[108:111], v[112:115], v[176:179]
    s_waitcnt lgkmcnt(9)
    v_mfma_f32_16x16x32_bf16 v[128:131], v[64:67], v[80:83], v[128:131]
    ds_read_b128 v[96:99], v19 offset:33792
    s_waitcnt lgkmcnt(8)
    v_mfma_f32_16x16x32_bf16 v[132:135], v[64:67], v[84:87], v[132:135]
    ds_read_b64_tr_b16 v[112:113], v21 offset:34304
    s_waitcnt lgkmcnt(7)
    v_mfma_f32_16x16x32_bf16 v[136:139], v[64:67], v[88:91], v[136:139]
    ds_read_b64_tr_b16 v[114:115], v21 offset:34368
    s_waitcnt lgkmcnt(6)
    v_mfma_f32_16x16x32_bf16 v[140:143], v[64:67], v[92:95], v[140:143]
    ds_read_b64_tr_b16 v[116:117], v21 offset:36480
    s_waitcnt lgkmcnt(6)
    v_mfma_f32_16x16x32_bf16 v[156:159], v[68:71], v[92:95], v[156:159]
    ds_read_b64_tr_b16 v[118:119], v21 offset:36544
    v_mfma_f32_16x16x32_bf16 v[152:155], v[68:71], v[88:91], v[152:155]
    ds_read_b64_tr_b16 v[120:121], v21 offset:38656
    v_mfma_f32_16x16x32_bf16 v[148:151], v[68:71], v[84:87], v[148:151]
    ds_read_b64_tr_b16 v[122:123], v21 offset:38720
    v_mfma_f32_16x16x32_bf16 v[144:147], v[68:71], v[80:83], v[144:147]
    ds_read_b64_tr_b16 v[124:125], v21 offset:40832
    s_waitcnt lgkmcnt(9)
    v_mfma_f32_16x16x32_bf16 v[160:163], v[72:75], v[80:83], v[160:163]
    ds_read_b64_tr_b16 v[126:127], v21 offset:40896
    v_mfma_f32_16x16x32_bf16 v[164:167], v[72:75], v[84:87], v[164:167]
    ds_read_b128 v[100:103], v19 offset:35840
    v_mfma_f32_16x16x32_bf16 v[168:171], v[72:75], v[88:91], v[168:171]
    ds_read_b128 v[104:107], v19 offset:37888
    v_mfma_f32_16x16x32_bf16 v[172:175], v[72:75], v[92:95], v[172:175]
    ds_read_b128 v[108:111], v19 offset:39936
    s_waitcnt lgkmcnt(12)
    v_mfma_f32_16x16x32_bf16 v[188:191], v[76:79], v[92:95], v[188:191]
    v_mfma_f32_16x16x32_bf16 v[184:187], v[76:79], v[88:91], v[184:187]
    v_mfma_f32_16x16x32_bf16 v[180:183], v[76:79], v[84:87], v[180:183]
    v_mfma_f32_16x16x32_bf16 v[176:179], v[76:79], v[80:83], v[176:179]
    s_waitcnt lgkmcnt(9)
    v_mfma_f32_16x16x32_bf16 v[128:131], v[96:99], v[112:115], v[128:131]
    s_waitcnt lgkmcnt(7)
    v_mfma_f32_16x16x32_bf16 v[132:135], v[96:99], v[116:119], v[132:135]
    s_waitcnt lgkmcnt(5)
    v_mfma_f32_16x16x32_bf16 v[136:139], v[96:99], v[120:123], v[136:139]
    s_waitcnt lgkmcnt(3)
    v_mfma_f32_16x16x32_bf16 v[140:143], v[96:99], v[124:127], v[140:143]
    s_waitcnt lgkmcnt(2)
    v_mfma_f32_16x16x32_bf16 v[156:159], v[100:103], v[124:127], v[156:159]
    v_mfma_f32_16x16x32_bf16 v[152:155], v[100:103], v[120:123], v[152:155]
    v_mfma_f32_16x16x32_bf16 v[148:151], v[100:103], v[116:119], v[148:151]
    v_mfma_f32_16x16x32_bf16 v[144:147], v[100:103], v[112:115], v[144:147]
    s_waitcnt lgkmcnt(1)
    v_mfma_f32_16x16x32_bf16 v[160:163], v[104:107], v[112:115], v[160:163]
    v_mfma_f32_16x16x32_bf16 v[164:167], v[104:107], v[116:119], v[164:167]
    v_mfma_f32_16x16x32_bf16 v[168:171], v[104:107], v[120:123], v[168:171]
    v_mfma_f32_16x16x32_bf16 v[172:175], v[104:107], v[124:127], v[172:175]
    s_waitcnt lgkmcnt(0)
    v_mfma_f32_16x16x32_bf16 v[188:191], v[108:111], v[124:127], v[188:191]
    v_mfma_f32_16x16x32_bf16 v[184:187], v[108:111], v[120:123], v[184:187]
    v_mfma_f32_16x16x32_bf16 v[180:183], v[108:111], v[116:119], v[180:183]
    v_mfma_f32_16x16x32_bf16 v[176:179], v[108:111], v[112:115], v[176:179]
    s_lshl_b32 s22, s2, 2
    s_add_u32 s22, s22, s3
    s_lshl_b32 s25, s22, 7
    s_add_u32 s25, s25, 18153472
    s_lshl_b32 s22, s22, 13
    s_add_u32 s22, s22, 18874368
    s_xor_b32 s23, s2, 1
    s_lshl_b32 s23, s23, 2
    s_add_u32 s23, s23, s3
    s_lshl_b32 s24, s23, 7
    s_add_u32 s24, s24, 18153472
    s_lshl_b32 s23, s23, 13
    s_add_u32 s23, s23, 18874368
    v_lshlrev_b32 v12, 4, v2
    v_add_u32 v13, 4096, v12
    v_mov_b32 v30, 0
    v_add_u32 v11, 0x10000, v10
    s_cmp_eq_u32 s70, 0
    s_cbranch_scc0 LT_b1
    v_max3_f32 v22, |v136|, |v137|, |v138|
    v_max3_f32 v23, |v139|, |v140|, |v141|
    v_max3_f32 v22, |v142|, |v143|, v22
    v_max3_f32 v23, |v152|, |v153|, v23
    v_max3_f32 v22, |v154|, |v155|, v22
    v_max3_f32 v23, |v156|, |v157|, v23
    v_max3_f32 v22, |v158|, |v159|, v22
    v_max3_f32 v23, |v168|, |v169|, v23
    v_max3_f32 v22, |v170|, |v171|, v22
    v_max3_f32 v23, |v172|, |v173|, v23
    v_max3_f32 v22, |v174|, |v175|, v22
    v_max3_f32 v23, |v184|, |v185|, v23
    v_max3_f32 v22, |v186|, |v187|, v22
    v_max3_f32 v23, |v188|, |v189|, v23
    v_max3_f32 v22, |v190|, |v191|, v22
    v_max_f32 v22, v22, v23
    v_lshrrev_b32 v22, 23, v22
    v_min_u32 v22, 252, v22
    v_sub_u32 v24, 253, v22
    v_lshlrev_b32 v24, 23, v24
    v_add_u32 v80, 1, v22
    v_lshlrev_b32 v80, 23, v80
    v_pk_mul_f32 v[26:27], v[24:25], v[136:137] op_sel_hi:[0,1]
    v_pk_mul_f32 v[28:29], v[24:25], v[138:139] op_sel_hi:[0,1]
    v_cvt_pknorm_i16_f32 v64, v26, v27
    v_cvt_pknorm_i16_f32 v65, v28, v29
    v_pk_mul_f32 v[26:27], v[24:25], v[140:141] op_sel_hi:[0,1]
    v_pk_mul_f32 v[28:29], v[24:25], v[142:143] op_sel_hi:[0,1]
    v_cvt_pknorm_i16_f32 v66, v26, v27
    v_cvt_pknorm_i16_f32 v67, v28, v29
    buffer_store_dwordx4 v[64:67], v12, s[44:47], s22 offen offset:0 sc1
    v_pk_mul_f32 v[26:27], v[24:25], v[152:153] op_sel_hi:[0,1]
    v_pk_mul_f32 v[28:29], v[24:25], v[154:155] op_sel_hi:[0,1]
    v_cvt_pknorm_i16_f32 v68, v26, v27
    v_cvt_pknorm_i16_f32 v69, v28, v29
    v_pk_mul_f32 v[26:27], v[24:25], v[156:157] op_sel_hi:[0,1]
    v_pk_mul_f32 v[28:29], v[24:25], v[158:159] op_sel_hi:[0,1]
    v_cvt_pknorm_i16_f32 v70, v26, v27
    v_cvt_pknorm_i16_f32 v71, v28, v29
    buffer_store_dwordx4 v[68:71], v12, s[44:47], s22 offen offset:1024 sc1
    v_pk_mul_f32 v[26:27], v[24:25], v[168:169] op_sel_hi:[0,1]
    v_pk_mul_f32 v[28:29], v[24:25], v[170:171] op_sel_hi:[0,1]
    v_cvt_pknorm_i16_f32 v72, v26, v27
    v_cvt_pknorm_i16_f32 v73, v28, v29
    v_pk_mul_f32 v[26:27], v[24:25], v[172:173] op_sel_hi:[0,1]
    v_pk_mul_f32 v[28:29], v[24:25], v[174:175] op_sel_hi:[0,1]
    v_cvt_pknorm_i16_f32 v74, v26, v27
    v_cvt_pknorm_i16_f32 v75, v28, v29
    buffer_store_dwordx4 v[72:75], v12, s[44:47], s22 offen offset:2048 sc1
    v_pk_mul_f32 v[26:27], v[24:25], v[184:185] op_sel_hi:[0,1]
    v_pk_mul_f32 v[28:29], v[24:25], v[186:187] op_sel_hi:[0,1]
    v_cvt_pknorm_i16_f32 v76, v26, v27
    v_cvt_pknorm_i16_f32 v77, v28, v29
    v_pk_mul_f32 v[26:27], v[24:25], v[188:189] op_sel_hi:[0,1]
    v_pk_mul_f32 v[28:29], v[24:25], v[190:191] op_sel_hi:[0,1]
    v_cvt_pknorm_i16_f32 v78, v26, v27
    v_cvt_pknorm_i16_f32 v79, v28, v29
    buffer_store_dwordx4 v[76:79], v12, s[44:47], s22 offen offset:3072 sc1
    v_lshrrev_b32 v31, 2, v12
    v_add_u32 v31, 4096, v31
    buffer_store_dword v80, v31, s[44:47], s22 offen sc1
    s_barrier
    v_lshrrev_b32 v22, 1, v4
    s_lshl_b32 s22, s20, 3
    v_add_u32 v22, s22, v22
    v_and_b32 v23, 1, v4
    v_lshlrev_b32 v23, 3, v23
    v_lshl_add_u32 v23, v3, 8, v23
    s_lshl_b32 s22, s21, 13
    v_add_u32 v23, s22, v23
    v_add_u32 v24, 0, v22
    v_xor_b32 v24, v24, v3
    v_lshl_add_u32 v24, v24, 4, v23
    ds_read_b64 v[192:193], v24 offset:0
    ds_read_b64 v[200:201], v24 offset:4096
    v_add_u32 v24, 2, v22
    v_xor_b32 v24, v24, v3
    v_lshl_add_u32 v24, v24, 4, v23
    ds_read_b64 v[194:195], v24 offset:0
    ds_read_b64 v[202:203], v24 offset:4096
    v_add_u32 v24, 4, v22
    v_xor_b32 v24, v24, v3
    v_lshl_add_u32 v24, v24, 4, v23
    ds_read_b64 v[196:197], v24 offset:0
    ds_read_b64 v[204:205], v24 offset:4096
    v_add_u32 v24, 6, v22
    v_xor_b32 v24, v24, v3
    v_lshl_add_u32 v24, v24, 4, v23
    ds_read_b64 v[198:199], v24 offset:0
    ds_read_b64 v[206:207], v24 offset:4096
    s_lshl_b32 s22, s20, 7
    v_lshlrev_b32 v24, 3, v4
    v_add_u32 v24, s22, v24
    ds_read_b64 v[208:209], v24 offset:16384
    ds_read_b64 v[216:217], v24 offset:16640
    ds_read_b64 v[210:211], v24 offset:16416
    ds_read_b64 v[218:219], v24 offset:16672
    ds_read_b64 v[212:213], v24 offset:16448
    ds_read_b64 v[220:221], v24 offset:16704
    ds_read_b64 v[214:215], v24 offset:16480
    ds_read_b64 v[222:223], v24 offset:16736
    s_lshl_b32 s22, s21, 9
    v_lshlrev_b32 v25, 4, v3
    v_add_u32 v25, s22, v25
    ds_read_b128 v[224:227], v25 offset:16896
    ds_read_b128 v[228:231], v25 offset:17152
    s_waitcnt lgkmcnt(0)
    s_mov_b32 s98, 0
LT0_g:
    s_add_u32 s98, s98, 1
    s_cmp_gt_u32 s98, 262144
    s_cbranch_scc1 L_end
    v_cmp_ne_u32 vcc, v225, v15
    s_mov_b64 s[56:57], vcc
    v_cmp_ne_u32 vcc, v227, v15
    s_or_b64 s[56:57], s[56:57], vcc
    v_cmp_ne_u32 vcc, v229, v15
    s_or_b64 s[56:57], s[56:57], vcc
    v_cmp_ne_u32 vcc, v231, v15
    s_or_b64 s[56:57], s[56:57], vcc
    s_cmp_eq_u64 s[56:57], 0
    s_cbranch_scc1 LT0_gok
    s_sleep 1
    global_load_dwordx4 v[224:227], v9, s[34:35] sc1
    global_load_dwordx4 v[228:231], v9, s[34:35] offset:256 sc1
    s_waitcnt vmcnt(0)
    s_branch LT0_g
LT0_gok:
    v_lshlrev_b32 v232, 16, v208
    v_and_b32 v233, 0xffff0000, v208
    v_lshlrev_b32 v108, 16, v216
    v_and_b32 v109, 0xffff0000, v216
    v_lshlrev_b32 v234, 16, v209
    v_and_b32 v235, 0xffff0000, v209
    v_lshlrev_b32 v110, 16, v217
    v_and_b32 v111, 0xffff0000, v217
    v_lshlrev_b32 v236, 16, v210
    v_and_b32 v237, 0xffff0000, v210
    v_lshlrev_b32 v112, 16, v218
    v_and_b32 v113, 0xffff0000, v218
    v_lshlrev_b32 v238, 16, v211
    v_and_b32 v239, 0xffff0000, v211
    v_lshlrev_b32 v114, 16, v219
    v_and_b32 v115, 0xffff0000, v219
    v_lshlrev_b32 v240, 16, v212
    v_and_b32 v241, 0xffff0000, v212
    v_lshlrev_b32 v116, 16, v220
    v_and_b32 v117, 0xffff0000, v220
    v_lshlrev_b32 v242, 16, v213
    v_and_b32 v243, 0xffff0000, v213
    v_lshlrev_b32 v118, 16, v221
    v_and_b32 v119, 0xffff0000, v221
    v_lshlrev_b32 v244, 16, v214
    v_and_b32 v245, 0xffff0000, v214
    v_lshlrev_b32 v120, 16, v222
    v_and_b32 v121, 0xffff0000, v222
    v_lshlrev_b32 v246, 16, v215
    v_and_b32 v247, 0xffff0000, v215
    v_lshlrev_b32 v122, 16, v223
    v_and_b32 v123, 0xffff0000, v223
    v_lshlrev_b32 v22, 16, v192
    v_and_b32 v23, 0xffff0000, v192
    v_pk_mul_f32 v[24:25], v[22:23], v[232:233]
    v_pk_mul_f32 v[26:27], v[22:23], v[108:109]
    v_cvt_pk_bf16_f32 v24, v24, v25
    v_cvt_pk_bf16_f32 v26, v26, v27
    v_lshlrev_b32 v22, 16, v24
    v_and_b32 v23, 0xffff0000, v24
    v_lshlrev_b32 v28, 16, v26
    v_and_b32 v29, 0xffff0000, v26
    v_pk_mul_f32 v[32:33], v[224:225], v[22:23] op_sel:[0,0] op_sel_hi:[0,1]
    v_pk_fma_f32 v[32:33], v[226:227], v[28:29], v[32:33] op_sel:[0,0,0] op_sel_hi:[0,1,1]
    v_pk_fma_f32 v[32:33], v[224:225], v[128:129], v[32:33] op_sel:[0,0,0] op_sel_hi:[0,1,1]
    v_lshlrev_b32 v22, 16, v193
    v_and_b32 v23, 0xffff0000, v193
    v_pk_mul_f32 v[24:25], v[22:23], v[234:235]
    v_pk_mul_f32 v[26:27], v[22:23], v[110:111]
    v_cvt_pk_bf16_f32 v24, v24, v25
    v_cvt_pk_bf16_f32 v26, v26, v27
    v_lshlrev_b32 v22, 16, v24
    v_and_b32 v23, 0xffff0000, v24
    v_lshlrev_b32 v28, 16, v26
    v_and_b32 v29, 0xffff0000, v26
    v_pk_mul_f32 v[34:35], v[224:225], v[22:23] op_sel:[0,0] op_sel_hi:[0,1]
    v_pk_fma_f32 v[34:35], v[226:227], v[28:29], v[34:35] op_sel:[0,0,0] op_sel_hi:[0,1,1]
    v_pk_fma_f32 v[34:35], v[224:225], v[130:131], v[34:35] op_sel:[0,0,0] op_sel_hi:[0,1,1]
    v_lshlrev_b32 v22, 16, v200
    v_and_b32 v23, 0xffff0000, v200
    v_pk_mul_f32 v[24:25], v[22:23], v[232:233]
    v_pk_mul_f32 v[26:27], v[22:23], v[108:109]
    v_cvt_pk_bf16_f32 v24, v24, v25
    v_cvt_pk_bf16_f32 v26, v26, v27
    v_lshlrev_b32 v22, 16, v24
    v_and_b32 v23, 0xffff0000, v24
    v_lshlrev_b32 v28, 16, v26
    v_and_b32 v29, 0xffff0000, v26
    v_pk_mul_f32 v[36:37], v[228:229], v[22:23] op_sel:[0,0] op_sel_hi:[0,1]
    v_pk_fma_f32 v[36:37], v[230:231], v[28:29], v[36:37] op_sel:[0,0,0] op_sel_hi:[0,1,1]
    v_pk_fma_f32 v[36:37], v[228:229], v[132:133], v[36:37] op_sel:[0,0,0] op_sel_hi:[0,1,1]
    v_lshlrev_b32 v22, 16, v201
    v_and_b32 v23, 0xffff0000, v201
    v_pk_mul_f32 v[24:25], v[22:23], v[234:235]
    v_pk_mul_f32 v[26:27], v[22:23], v[110:111]
    v_cvt_pk_bf16_f32 v24, v24, v25
    v_cvt_pk_bf16_f32 v26, v26, v27
    v_lshlrev_b32 v22, 16, v24
    v_and_b32 v23, 0xffff0000, v24
    v_lshlrev_b32 v28, 16, v26
    v_and_b32 v29, 0xffff0000, v26
    v_pk_mul_f32 v[38:39], v[228:229], v[22:23] op_sel:[0,0] op_sel_hi:[0,1]
    v_pk_fma_f32 v[38:39], v[230:231], v[28:29], v[38:39] op_sel:[0,0,0] op_sel_hi:[0,1,1]
    v_pk_fma_f32 v[38:39], v[228:229], v[134:135], v[38:39] op_sel:[0,0,0] op_sel_hi:[0,1,1]
    v_lshlrev_b32 v22, 16, v194
    v_and_b32 v23, 0xffff0000, v194
    v_pk_mul_f32 v[24:25], v[22:23], v[236:237]
    v_pk_mul_f32 v[26:27], v[22:23], v[112:113]
    v_cvt_pk_bf16_f32 v24, v24, v25
    v_cvt_pk_bf16_f32 v26, v26, v27
    v_lshlrev_b32 v22, 16, v24
    v_and_b32 v23, 0xffff0000, v24
    v_lshlrev_b32 v28, 16, v26
    v_and_b32 v29, 0xffff0000, v26
    v_pk_mul_f32 v[40:41], v[224:225], v[22:23] op_sel:[0,0] op_sel_hi:[0,1]
    v_pk_fma_f32 v[40:41], v[226:227], v[28:29], v[40:41] op_sel:[0,0,0] op_sel_hi:[0,1,1]
    v_pk_fma_f32 v[40:41], v[224:225], v[144:145], v[40:41] op_sel:[0,0,0] op_sel_hi:[0,1,1]
    v_lshlrev_b32 v22, 16, v195
    v_and_b32 v23, 0xffff0000, v195
    v_pk_mul_f32 v[24:25], v[22:23], v[238:239]
    v_pk_mul_f32 v[26:27], v[22:23], v[114:115]
    v_cvt_pk_bf16_f32 v24, v24, v25
    v_cvt_pk_bf16_f32 v26, v26, v27
    v_lshlrev_b32 v22, 16, v24
    v_and_b32 v23, 0xffff0000, v24
    v_lshlrev_b32 v28, 16, v26
    v_and_b32 v29, 0xffff0000, v26
    v_pk_mul_f32 v[42:43], v[224:225], v[22:23] op_sel:[0,0] op_sel_hi:[0,1]
    v_pk_fma_f32 v[42:43], v[226:227], v[28:29], v[42:43] op_sel:[0,0,0] op_sel_hi:[0,1,1]
    v_pk_fma_f32 v[42:43], v[224:225], v[146:147], v[42:43] op_sel:[0,0,0] op_sel_hi:[0,1,1]
    s_waitcnt vmcnt(0)
    s_mov_b64 s[56:57], exec
    s_mov_b64 exec, 1
    buffer_store_dword v15, v30, s[44:47], s25 offen sc1
    s_mov_b64 exec, s[56:57]
    v_lshlrev_b32 v22, 16, v202
    v_and_b32 v23, 0xffff0000, v202
    v_pk_mul_f32 v[24:25], v[22:23], v[236:237]
    v_pk_mul_f32 v[26:27], v[22:23], v[112:113]
    v_cvt_pk_bf16_f32 v24, v24, v25
    v_cvt_pk_bf16_f32 v26, v26, v27
    v_lshlrev_b32 v22, 16, v24
    v_and_b32 v23, 0xffff0000, v24
    v_lshlrev_b32 v28, 16, v26
    v_and_b32 v29, 0xffff0000, v26
    v_pk_mul_f32 v[44:45], v[228:229], v[22:23] op_sel:[0,0] op_sel_hi:[0,1]
    v_pk_fma_f32 v[44:45], v[230:231], v[28:29], v[44:45] op_sel:[0,0,0] op_sel_hi:[0,1,1]
    v_pk_fma_f32 v[44:45], v[228:229], v[148:149], v[44:45] op_sel:[0,0,0] op_sel_hi:[0,1,1]
    v_lshlrev_b32 v22, 16, v203
    v_and_b32 v23, 0xffff0000, v203
    v_pk_mul_f32 v[24:25], v[22:23], v[238:239]
    v_pk_mul_f32 v[26:27], v[22:23], v[114:115]
    v_cvt_pk_bf16_f32 v24, v24, v25
    v_cvt_pk_bf16_f32 v26, v26, v27
    v_lshlrev_b32 v22, 16, v24
    v_and_b32 v23, 0xffff0000, v24
    v_lshlrev_b32 v28, 16, v26
    v_and_b32 v29, 0xffff0000, v26
    v_pk_mul_f32 v[46:47], v[228:229], v[22:23] op_sel:[0,0] op_sel_hi:[0,1]
    v_pk_fma_f32 v[46:47], v[230:231], v[28:29], v[46:47] op_sel:[0,0,0] op_sel_hi:[0,1,1]
    v_pk_fma_f32 v[46:47], v[228:229], v[150:151], v[46:47] op_sel:[0,0,0] op_sel_hi:[0,1,1]
    v_lshlrev_b32 v22, 16, v196
    v_and_b32 v23, 0xffff0000, v196
    v_pk_mul_f32 v[24:25], v[22:23], v[240:241]
    v_pk_mul_f32 v[26:27], v[22:23], v[116:117]
    v_cvt_pk_bf16_f32 v24, v24, v25
    v_cvt_pk_bf16_f32 v26, v26, v27
    v_lshlrev_b32 v22, 16, v24
    v_and_b32 v23, 0xffff0000, v24
    v_lshlrev_b32 v28, 16, v26
    v_and_b32 v29, 0xffff0000, v26
    v_pk_mul_f32 v[48:49], v[224:225], v[22:23] op_sel:[0,0] op_sel_hi:[0,1]
    v_pk_fma_f32 v[48:49], v[226:227], v[28:29], v[48:49] op_sel:[0,0,0] op_sel_hi:[0,1,1]
    v_pk_fma_f32 v[48:49], v[224:225], v[160:161], v[48:49] op_sel:[0,0,0] op_sel_hi:[0,1,1]
    v_lshlrev_b32 v22, 16, v197
    v_and_b32 v23, 0xffff0000, v197
    v_pk_mul_f32 v[24:25], v[22:23], v[242:243]
    v_pk_mul_f32 v[26:27], v[22:23], v[118:119]
    v_cvt_pk_bf16_f32 v24, v24, v25
    v_cvt_pk_bf16_f32 v26, v26, v27
    v_lshlrev_b32 v22, 16, v24
    v_and_b32 v23, 0xffff0000, v24
    v_lshlrev_b32 v28, 16, v26
    v_and_b32 v29, 0xffff0000, v26
    v_pk_mul_f32 v[50:51], v[224:225], v[22:23] op_sel:[0,0] op_sel_hi:[0,1]
    v_pk_fma_f32 v[50:51], v[226:227], v[28:29], v[50:51] op_sel:[0,0,0] op_sel_hi:[0,1,1]
    v_pk_fma_f32 v[50:51], v[224:225], v[162:163], v[50:51] op_sel:[0,0,0] op_sel_hi:[0,1,1]
    v_lshlrev_b32 v22, 16, v204
    v_and_b32 v23, 0xffff0000, v204
    v_pk_mul_f32 v[24:25], v[22:23], v[240:241]
    v_pk_mul_f32 v[26:27], v[22:23], v[116:117]
    v_cvt_pk_bf16_f32 v24, v24, v25
    v_cvt_pk_bf16_f32 v26, v26, v27
    v_lshlrev_b32 v22, 16, v24
    v_and_b32 v23, 0xffff0000, v24
    v_lshlrev_b32 v28, 16, v26
    v_and_b32 v29, 0xffff0000, v26
    v_pk_mul_f32 v[52:53], v[228:229], v[22:23] op_sel:[0,0] op_sel_hi:[0,1]
    v_pk_fma_f32 v[52:53], v[230:231], v[28:29], v[52:53] op_sel:[0,0,0] op_sel_hi:[0,1,1]
    v_pk_fma_f32 v[52:53], v[228:229], v[164:165], v[52:53] op_sel:[0,0,0] op_sel_hi:[0,1,1]
    v_lshlrev_b32 v22, 16, v205
    v_and_b32 v23, 0xffff0000, v205
    v_pk_mul_f32 v[24:25], v[22:23], v[242:243]
    v_pk_mul_f32 v[26:27], v[22:23], v[118:119]
    v_cvt_pk_bf16_f32 v24, v24, v25
    v_cvt_pk_bf16_f32 v26, v26, v27
    v_lshlrev_b32 v22, 16, v24
    v_and_b32 v23, 0xffff0000, v24
    v_lshlrev_b32 v28, 16, v26
    v_and_b32 v29, 0xffff0000, v26
    v_pk_mul_f32 v[54:55], v[228:229], v[22:23] op_sel:[0,0] op_sel_hi:[0,1]
    v_pk_fma_f32 v[54:55], v[230:231], v[28:29], v[54:55] op_sel:[0,0,0] op_sel_hi:[0,1,1]
    v_pk_fma_f32 v[54:55], v[228:229], v[166:167], v[54:55] op_sel:[0,0,0] op_sel_hi:[0,1,1]
    v_lshlrev_b32 v22, 16, v198
    v_and_b32 v23, 0xffff0000, v198
    v_pk_mul_f32 v[24:25], v[22:23], v[244:245]
    v_pk_mul_f32 v[26:27], v[22:23], v[120:121]
    v_cvt_pk_bf16_f32 v24, v24, v25
    v_cvt_pk_bf16_f32 v26, v26, v27
    v_lshlrev_b32 v22, 16, v24
    v_and_b32 v23, 0xffff0000, v24
    v_lshlrev_b32 v28, 16, v26
    v_and_b32 v29, 0xffff0000, v26
    v_pk_mul_f32 v[56:57], v[224:225], v[22:23] op_sel:[0,0] op_sel_hi:[0,1]
    v_pk_fma_f32 v[56:57], v[226:227], v[28:29], v[56:57] op_sel:[0,0,0] op_sel_hi:[0,1,1]
    v_pk_fma_f32 v[56:57], v[224:225], v[176:177], v[56:57] op_sel:[0,0,0] op_sel_hi:[0,1,1]
    v_lshlrev_b32 v22, 16, v199
    v_and_b32 v23, 0xffff0000, v199
    v_pk_mul_f32 v[24:25], v[22:23], v[246:247]
    v_pk_mul_f32 v[26:27], v[22:23], v[122:123]
    v_cvt_pk_bf16_f32 v24, v24, v25
    v_cvt_pk_bf16_f32 v26, v26, v27
    v_lshlrev_b32 v22, 16, v24
    v_and_b32 v23, 0xffff0000, v24
    v_lshlrev_b32 v28, 16, v26
    v_and_b32 v29, 0xffff0000, v26
    v_pk_mul_f32 v[58:59], v[224:225], v[22:23] op_sel:[0,0] op_sel_hi:[0,1]
    v_pk_fma_f32 v[58:59], v[226:227], v[28:29], v[58:59] op_sel:[0,0,0] op_sel_hi:[0,1,1]
    v_pk_fma_f32 v[58:59], v[224:225], v[178:179], v[58:59] op_sel:[0,0,0] op_sel_hi:[0,1,1]
    v_lshlrev_b32 v22, 16, v206
    v_and_b32 v23, 0xffff0000, v206
    v_pk_mul_f32 v[24:25], v[22:23], v[244:245]
    v_pk_mul_f32 v[26:27], v[22:23], v[120:121]
    v_cvt_pk_bf16_f32 v24, v24, v25
    v_cvt_pk_bf16_f32 v26, v26, v27
    v_lshlrev_b32 v22, 16, v24
    v_and_b32 v23, 0xffff0000, v24
    v_lshlrev_b32 v28, 16, v26
    v_and_b32 v29, 0xffff0000, v26
    v_pk_mul_f32 v[60:61], v[228:229], v[22:23] op_sel:[0,0] op_sel_hi:[0,1]
    v_pk_fma_f32 v[60:61], v[230:231], v[28:29], v[60:61] op_sel:[0,0,0] op_sel_hi:[0,1,1]
    v_pk_fma_f32 v[60:61], v[228:229], v[180:181], v[60:61] op_sel:[0,0,0] op_sel_hi:[0,1,1]
    v_lshlrev_b32 v22, 16, v207
    v_and_b32 v23, 0xffff0000, v207
    v_pk_mul_f32 v[24:25], v[22:23], v[246:247]
    v_pk_mul_f32 v[26:27], v[22:23], v[122:123]
    v_cvt_pk_bf16_f32 v24, v24, v25
    v_cvt_pk_bf16_f32 v26, v26, v27
    v_lshlrev_b32 v22, 16, v24
    v_and_b32 v23, 0xffff0000, v24
    v_lshlrev_b32 v28, 16, v26
    v_and_b32 v29, 0xffff0000, v26
    v_pk_mul_f32 v[62:63], v[228:229], v[22:23] op_sel:[0,0] op_sel_hi:[0,1]
    v_pk_fma_f32 v[62:63], v[230:231], v[28:29], v[62:63] op_sel:[0,0,0] op_sel_hi:[0,1,1]
    v_pk_fma_f32 v[62:63], v[228:229], v[182:183], v[62:63] op_sel:[0,0,0] op_sel_hi:[0,1,1]
    buffer_load_dword v18, v30, s[44:47], s24 offen sc1
    s_mov_b32 s98, 0
LT0_p:
    s_add_u32 s98, s98, 1
    s_cmp_gt_u32 s98, 262144
    s_cbranch_scc1 L_end
    s_waitcnt vmcnt(0)
    v_cmp_ne_u32 vcc, v18, v15
    s_nop 4
    s_cbranch_vccz LT0_got
    s_sleep 2
    buffer_load_dword v18, v30, s[44:47], s24 offen sc1
    s_branch LT0_p
LT0_got:
    buffer_load_dword v19, v31, s[44:47], s23 offen sc1
    buffer_load_dwordx4 v[64:67], v12, s[44:47], s23 offen offset:0 sc1
    buffer_load_dwordx4 v[68:71], v12, s[44:47], s23 offen offset:1024 sc1
    buffer_load_dwordx4 v[72:75], v12, s[44:47], s23 offen offset:2048 sc1
    buffer_load_dwordx4 v[76:79], v12, s[44:47], s23 offen offset:3072 sc1
    s_waitcnt vmcnt(4)
    v_mul_f32 v26, v226, v19
    v_mul_f32 v26, 0x38000100, v26
    v_mul_f32 v28, v230, v19
    v_mul_f32 v28, 0x38000100, v28
    s_waitcnt vmcnt(3)
    v_cvt_f32_i32_sdwa v22, sext(v64) dst_sel:DWORD dst_unused:UNUSED_PAD src0_sel:WORD_0
    v_cvt_f32_i32_sdwa v23, sext(v64) dst_sel:DWORD dst_unused:UNUSED_PAD src0_sel:WORD_1
    s_nop 0
    v_pk_fma_f32 v[32:33], v[26:27], v[22:23], v[32:33] op_sel:[0,0,0] op_sel_hi:[0,1,1]
    v_cvt_f32_i32_sdwa v22, sext(v65) dst_sel:DWORD dst_unused:UNUSED_PAD src0_sel:WORD_0
    v_cvt_f32_i32_sdwa v23, sext(v65) dst_sel:DWORD dst_unused:UNUSED_PAD src0_sel:WORD_1
    s_nop 0
    v_pk_fma_f32 v[34:35], v[26:27], v[22:23], v[34:35] op_sel:[0,0,0] op_sel_hi:[0,1,1]
    global_store_dwordx4 v10, v[32:35], s[40:41] offset:0
    v_cvt_f32_i32_sdwa v22, sext(v66) dst_sel:DWORD dst_unused:UNUSED_PAD src0_sel:WORD_0
    v_cvt_f32_i32_sdwa v23, sext(v66) dst_sel:DWORD dst_unused:UNUSED_PAD src0_sel:WORD_1
    s_nop 0
    v_pk_fma_f32 v[36:37], v[28:29], v[22:23], v[36:37] op_sel:[0,0,0] op_sel_hi:[0,1,1]
    v_cvt_f32_i32_sdwa v22, sext(v67) dst_sel:DWORD dst_unused:UNUSED_PAD src0_sel:WORD_0
    v_cvt_f32_i32_sdwa v23, sext(v67) dst_sel:DWORD dst_unused:UNUSED_PAD src0_sel:WORD_1
    s_nop 0
    v_pk_fma_f32 v[38:39], v[28:29], v[22:23], v[38:39] op_sel:[0,0,0] op_sel_hi:[0,1,1]
    global_store_dwordx4 v11, v[36:39], s[40:41] offset:0
    s_waitcnt vmcnt(4)
    v_cvt_f32_i32_sdwa v22, sext(v68) dst_sel:DWORD dst_unused:UNUSED_PAD src0_sel:WORD_0
    v_cvt_f32_i32_sdwa v23, sext(v68) dst_sel:DWORD dst_unused:UNUSED_PAD src0_sel:WORD_1
    s_nop 0
    v_pk_fma_f32 v[40:41], v[26:27], v[22:23], v[40:41] op_sel:[0,0,0] op_sel_hi:[0,1,1]
    v_cvt_f32_i32_sdwa v22, sext(v69) dst_sel:DWORD dst_unused:UNUSED_PAD src0_sel:WORD_0
    v_cvt_f32_i32_sdwa v23, sext(v69) dst_sel:DWORD dst_unused:UNUSED_PAD src0_sel:WORD_1
    s_nop 0
    v_pk_fma_f32 v[42:43], v[26:27], v[22:23], v[42:43] op_sel:[0,0,0] op_sel_hi:[0,1,1]
    global_store_dwordx4 v10, v[40:43], s[40:41] offset:64
    v_cvt_f32_i32_sdwa v22, sext(v70) dst_sel:DWORD dst_unused:UNUSED_PAD src0_sel:WORD_0
    v_cvt_f32_i32_sdwa v23, sext(v70) dst_sel:DWORD dst_unused:UNUSED_PAD src0_sel:WORD_1
    s_nop 0
    v_pk_fma_f32 v[44:45], v[28:29], v[22:23], v[44:45] op_sel:[0,0,0] op_sel_hi:[0,1,1]
    v_cvt_f32_i32_sdwa v22, sext(v71) dst_sel:DWORD dst_unused:UNUSED_PAD src0_sel:WORD_0
    v_cvt_f32_i32_sdwa v23, sext(v71) dst_sel:DWORD dst_unused:UNUSED_PAD src0_sel:WORD_1
    s_nop 0
    v_pk_fma_f32 v[46:47], v[28:29], v[22:23], v[46:47] op_sel:[0,0,0] op_sel_hi:[0,1,1]
    global_store_dwordx4 v11, v[44:47], s[40:41] offset:64
    s_waitcnt vmcnt(5)
    v_cvt_f32_i32_sdwa v22, sext(v72) dst_sel:DWORD dst_unused:UNUSED_PAD src0_sel:WORD_0
    v_cvt_f32_i32_sdwa v23, sext(v72) dst_sel:DWORD dst_unused:UNUSED_PAD src0_sel:WORD_1
    s_nop 0
    v_pk_fma_f32 v[48:49], v[26:27], v[22:23], v[48:49] op_sel:[0,0,0] op_sel_hi:[0,1,1]
    v_cvt_f32_i32_sdwa v22, sext(v73) dst_sel:DWORD dst_unused:UNUSED_PAD src0_sel:WORD_0
    v_cvt_f32_i32_sdwa v23, sext(v73) dst_sel:DWORD dst_unused:UNUSED_PAD src0_sel:WORD_1
    s_nop 0
    v_pk_fma_f32 v[50:51], v[26:27], v[22:23], v[50:51] op_sel:[0,0,0] op_sel_hi:[0,1,1]
    global_store_dwordx4 v10, v[48:51], s[40:41] offset:128
    v_cvt_f32_i32_sdwa v22, sext(v74) dst_sel:DWORD dst_unused:UNUSED_PAD src0_sel:WORD_0
    v_cvt_f32_i32_sdwa v23, sext(v74) dst_sel:DWORD dst_unused:UNUSED_PAD src0_sel:WORD_1
    s_nop 0
    v_pk_fma_f32 v[52:53], v[28:29], v[22:23], v[52:53] op_sel:[0,0,0] op_sel_hi:[0,1,1]
    v_cvt_f32_i32_sdwa v22, sext(v75) dst_sel:DWORD dst_unused:UNUSED_PAD src0_sel:WORD_0
    v_cvt_f32_i32_sdwa v23, sext(v75) dst_sel:DWORD dst_unused:UNUSED_PAD src0_sel:WORD_1
    s_nop 0
    v_pk_fma_f32 v[54:55], v[28:29], v[22:23], v[54:55] op_sel:[0,0,0] op_sel_hi:[0,1,1]
    global_store_dwordx4 v11, v[52:55], s[40:41] offset:128
    s_waitcnt vmcnt(6)
    v_cvt_f32_i32_sdwa v22, sext(v76) dst_sel:DWORD dst_unused:UNUSED_PAD src0_sel:WORD_0
    v_cvt_f32_i32_sdwa v23, sext(v76) dst_sel:DWORD dst_unused:UNUSED_PAD src0_sel:WORD_1
    s_nop 0
    v_pk_fma_f32 v[56:57], v[26:27], v[22:23], v[56:57] op_sel:[0,0,0] op_sel_hi:[0,1,1]
    v_cvt_f32_i32_sdwa v22, sext(v77) dst_sel:DWORD dst_unused:UNUSED_PAD src0_sel:WORD_0
    v_cvt_f32_i32_sdwa v23, sext(v77) dst_sel:DWORD dst_unused:UNUSED_PAD src0_sel:WORD_1
    s_nop 0
    v_pk_fma_f32 v[58:59], v[26:27], v[22:23], v[58:59] op_sel:[0,0,0] op_sel_hi:[0,1,1]
    global_store_dwordx4 v10, v[56:59], s[40:41] offset:192
    v_cvt_f32_i32_sdwa v22, sext(v78) dst_sel:DWORD dst_unused:UNUSED_PAD src0_sel:WORD_0
    v_cvt_f32_i32_sdwa v23, sext(v78) dst_sel:DWORD dst_unused:UNUSED_PAD src0_sel:WORD_1
    s_nop 0
    v_pk_fma_f32 v[60:61], v[28:29], v[22:23], v[60:61] op_sel:[0,0,0] op_sel_hi:[0,1,1]
    v_cvt_f32_i32_sdwa v22, sext(v79) dst_sel:DWORD dst_unused:UNUSED_PAD src0_sel:WORD_0
    v_cvt_f32_i32_sdwa v23, sext(v79) dst_sel:DWORD dst_unused:UNUSED_PAD src0_sel:WORD_1
    s_nop 0
    v_pk_fma_f32 v[62:63], v[28:29], v[22:23], v[62:63] op_sel:[0,0,0] op_sel_hi:[0,1,1]
    global_store_dwordx4 v11, v[60:63], s[40:41] offset:192
    s_branch LT_done
LT_b1:
    v_max3_f32 v22, |v128|, |v129|, |v130|
    v_max3_f32 v23, |v131|, |v132|, |v133|
    v_max3_f32 v22, |v134|, |v135|, v22
    v_max3_f32 v23, |v144|, |v145|, v23
    v_max3_f32 v22, |v146|, |v147|, v22
    v_max3_f32 v23, |v148|, |v149|, v23
    v_max3_f32 v22, |v150|, |v151|, v22
    v_max3_f32 v23, |v160|, |v161|, v23
    v_max3_f32 v22, |v162|, |v163|, v22
    v_max3_f32 v23, |v164|, |v165|, v23
    v_max3_f32 v22, |v166|, |v167|, v22
    v_max3_f32 v23, |v176|, |v177|, v23
    v_max3_f32 v22, |v178|, |v179|, v22
    v_max3_f32 v23, |v180|, |v181|, v23
    v_max3_f32 v22, |v182|, |v183|, v22
    v_max_f32 v22, v22, v23
    v_lshrrev_b32 v22, 23, v22
    v_min_u32 v22, 252, v22
    v_sub_u32 v24, 253, v22
    v_lshlrev_b32 v24, 23, v24
    v_add_u32 v80, 1, v22
    v_lshlrev_b32 v80, 23, v80
    v_pk_mul_f32 v[26:27], v[24:25], v[128:129] op_sel_hi:[0,1]
    v_pk_mul_f32 v[28:29], v[24:25], v[130:131] op_sel_hi:[0,1]
    v_cvt_pknorm_i16_f32 v64, v26, v27
    v_cvt_pknorm_i16_f32 v65, v28, v29
    v_pk_mul_f32 v[26:27], v[24:25], v[132:133] op_sel_hi:[0,1]
    v_pk_mul_f32 v[28:29], v[24:25], v[134:135] op_sel_hi:[0,1]
    v_cvt_pknorm_i16_f32 v66, v26, v27
    v_cvt_pknorm_i16_f32 v67, v28, v29
    buffer_store_dwordx4 v[64:67], v12, s[44:47], s22 offen offset:0 sc1
    v_pk_mul_f32 v[26:27], v[24:25], v[144:145] op_sel_hi:[0,1]
    v_pk_mul_f32 v[28:29], v[24:25], v[146:147] op_sel_hi:[0,1]
    v_cvt_pknorm_i16_f32 v68, v26, v27
    v_cvt_pknorm_i16_f32 v69, v28, v29
    v_pk_mul_f32 v[26:27], v[24:25], v[148:149] op_sel_hi:[0,1]
    v_pk_mul_f32 v[28:29], v[24:25], v[150:151] op_sel_hi:[0,1]
    v_cvt_pknorm_i16_f32 v70, v26, v27
    v_cvt_pknorm_i16_f32 v71, v28, v29
    buffer_store_dwordx4 v[68:71], v12, s[44:47], s22 offen offset:1024 sc1
    v_pk_mul_f32 v[26:27], v[24:25], v[160:161] op_sel_hi:[0,1]
    v_pk_mul_f32 v[28:29], v[24:25], v[162:163] op_sel_hi:[0,1]
    v_cvt_pknorm_i16_f32 v72, v26, v27
    v_cvt_pknorm_i16_f32 v73, v28, v29
    v_pk_mul_f32 v[26:27], v[24:25], v[164:165] op_sel_hi:[0,1]
    v_pk_mul_f32 v[28:29], v[24:25], v[166:167] op_sel_hi:[0,1]
    v_cvt_pknorm_i16_f32 v74, v26, v27
    v_cvt_pknorm_i16_f32 v75, v28, v29
    buffer_store_dwordx4 v[72:75], v12, s[44:47], s22 offen offset:2048 sc1
    v_pk_mul_f32 v[26:27], v[24:25], v[176:177] op_sel_hi:[0,1]
    v_pk_mul_f32 v[28:29], v[24:25], v[178:179] op_sel_hi:[0,1]
    v_cvt_pknorm_i16_f32 v76, v26, v27
    v_cvt_pknorm_i16_f32 v77, v28, v29
    v_pk_mul_f32 v[26:27], v[24:25], v[180:181] op_sel_hi:[0,1]
    v_pk_mul_f32 v[28:29], v[24:25], v[182:183] op_sel_hi:[0,1]
    v_cvt_pknorm_i16_f32 v78, v26, v27
    v_cvt_pknorm_i16_f32 v79, v28, v29
    buffer_store_dwordx4 v[76:79], v12, s[44:47], s22 offen offset:3072 sc1
    v_lshrrev_b32 v31, 2, v12
    v_add_u32 v31, 4096, v31
    buffer_store_dword v80, v31, s[44:47], s22 offen sc1
    s_barrier
    v_lshrrev_b32 v22, 1, v4
    s_lshl_b32 s22, s20, 3
    v_add_u32 v22, s22, v22
    v_and_b32 v23, 1, v4
    v_lshlrev_b32 v23, 3, v23
    v_lshl_add_u32 v23, v3, 8, v23
    s_lshl_b32 s22, s21, 13
    v_add_u32 v23, s22, v23
    v_add_u32 v24, 0, v22
    v_xor_b32 v24, v24, v3
    v_lshl_add_u32 v24, v24, 4, v23
    ds_read_b64 v[192:193], v24 offset:0
    ds_read_b64 v[200:201], v24 offset:4096
    v_add_u32 v24, 2, v22
    v_xor_b32 v24, v24, v3
    v_lshl_add_u32 v24, v24, 4, v23
    ds_read_b64 v[194:195], v24 offset:0
    ds_read_b64 v[202:203], v24 offset:4096
    v_add_u32 v24, 4, v22
    v_xor_b32 v24, v24, v3
    v_lshl_add_u32 v24, v24, 4, v23
    ds_read_b64 v[196:197], v24 offset:0
    ds_read_b64 v[204:205], v24 offset:4096
    v_add_u32 v24, 6, v22
    v_xor_b32 v24, v24, v3
    v_lshl_add_u32 v24, v24, 4, v23
    ds_read_b64 v[198:199], v24 offset:0
    ds_read_b64 v[206:207], v24 offset:4096
    s_lshl_b32 s22, s20, 7
    v_lshlrev_b32 v24, 3, v4
    v_add_u32 v24, s22, v24
    ds_read_b64 v[208:209], v24 offset:16384
    ds_read_b64 v[216:217], v24 offset:16640
    ds_read_b64 v[210:211], v24 offset:16416
    ds_read_b64 v[218:219], v24 offset:16672
    ds_read_b64 v[212:213], v24 offset:16448
    ds_read_b64 v[220:221], v24 offset:16704
    ds_read_b64 v[214:215], v24 offset:16480
    ds_read_b64 v[222:223], v24 offset:16736
    s_lshl_b32 s22, s21, 9
    v_lshlrev_b32 v25, 4, v3
    v_add_u32 v25, s22, v25
    ds_read_b128 v[224:227], v25 offset:16896
    ds_read_b128 v[228:231], v25 offset:17152
    s_waitcnt lgkmcnt(0)
    s_mov_b32 s98, 0
LT1_g:
    s_add_u32 s98, s98, 1
    s_cmp_gt_u32 s98, 262144
    s_cbranch_scc1 L_end
    v_cmp_ne_u32 vcc, v225, v15
    s_mov_b64 s[56:57], vcc
    v_cmp_ne_u32 vcc, v227, v15
    s_or_b64 s[56:57], s[56:57], vcc
    v_cmp_ne_u32 vcc, v229, v15
    s_or_b64 s[56:57], s[56:57], vcc
    v_cmp_ne_u32 vcc, v231, v15
    s_or_b64 s[56:57], s[56:57], vcc
    s_cmp_eq_u64 s[56:57], 0
    s_cbranch_scc1 LT1_gok
    s_sleep 1
    global_load_dwordx4 v[224:227], v9, s[34:35] sc1
    global_load_dwordx4 v[228:231], v9, s[34:35] offset:256 sc1
    s_waitcnt vmcnt(0)
    s_branch LT1_g
LT1_gok:
    v_lshlrev_b32 v232, 16, v208
    v_and_b32 v233, 0xffff0000, v208
    v_lshlrev_b32 v108, 16, v216
    v_and_b32 v109, 0xffff0000, v216
    v_lshlrev_b32 v234, 16, v209
    v_and_b32 v235, 0xffff0000, v209
    v_lshlrev_b32 v110, 16, v217
    v_and_b32 v111, 0xffff0000, v217
    v_lshlrev_b32 v236, 16, v210
    v_and_b32 v237, 0xffff0000, v210
    v_lshlrev_b32 v112, 16, v218
    v_and_b32 v113, 0xffff0000, v218
    v_lshlrev_b32 v238, 16, v211
    v_and_b32 v239, 0xffff0000, v211
    v_lshlrev_b32 v114, 16, v219
    v_and_b32 v115, 0xffff0000, v219
    v_lshlrev_b32 v240, 16, v212
    v_and_b32 v241, 0xffff0000, v212
    v_lshlrev_b32 v116, 16, v220
    v_and_b32 v117, 0xffff0000, v220
    v_lshlrev_b32 v242, 16, v213
    v_and_b32 v243, 0xffff0000, v213
    v_lshlrev_b32 v118, 16, v221
    v_and_b32 v119, 0xffff0000, v221
    v_lshlrev_b32 v244, 16, v214
    v_and_b32 v245, 0xffff0000, v214
    v_lshlrev_b32 v120, 16, v222
    v_and_b32 v121, 0xffff0000, v222
    v_lshlrev_b32 v246, 16, v215
    v_and_b32 v247, 0xffff0000, v215
    v_lshlrev_b32 v122, 16, v223
    v_and_b32 v123, 0xffff0000, v223
    v_lshlrev_b32 v22, 16, v192
    v_and_b32 v23, 0xffff0000, v192
    v_pk_mul_f32 v[24:25], v[22:23], v[232:233]
    v_pk_mul_f32 v[26:27], v[22:23], v[108:109]
    v_cvt_pk_bf16_f32 v24, v24, v25
    v_cvt_pk_bf16_f32 v26, v26, v27
    v_lshlrev_b32 v22, 16, v24
    v_and_b32 v23, 0xffff0000, v24
    v_lshlrev_b32 v28, 16, v26
    v_and_b32 v29, 0xffff0000, v26
    v_pk_mul_f32 v[32:33], v[224:225], v[22:23] op_sel:[0,0] op_sel_hi:[0,1]
    v_pk_fma_f32 v[32:33], v[226:227], v[28:29], v[32:33] op_sel:[0,0,0] op_sel_hi:[0,1,1]
    v_pk_fma_f32 v[32:33], v[226:227], v[136:137], v[32:33] op_sel:[0,0,0] op_sel_hi:[0,1,1]
    v_lshlrev_b32 v22, 16, v193
    v_and_b32 v23, 0xffff0000, v193
    v_pk_mul_f32 v[24:25], v[22:23], v[234:235]
    v_pk_mul_f32 v[26:27], v[22:23], v[110:111]
    v_cvt_pk_bf16_f32 v24, v24, v25
    v_cvt_pk_bf16_f32 v26, v26, v27
    v_lshlrev_b32 v22, 16, v24
    v_and_b32 v23, 0xffff0000, v24
    v_lshlrev_b32 v28, 16, v26
    v_and_b32 v29, 0xffff0000, v26
    v_pk_mul_f32 v[34:35], v[224:225], v[22:23] op_sel:[0,0] op_sel_hi:[0,1]
    v_pk_fma_f32 v[34:35], v[226:227], v[28:29], v[34:35] op_sel:[0,0,0] op_sel_hi:[0,1,1]
    v_pk_fma_f32 v[34:35], v[226:227], v[138:139], v[34:35] op_sel:[0,0,0] op_sel_hi:[0,1,1]
    v_lshlrev_b32 v22, 16, v200
    v_and_b32 v23, 0xffff0000, v200
    v_pk_mul_f32 v[24:25], v[22:23], v[232:233]
    v_pk_mul_f32 v[26:27], v[22:23], v[108:109]
    v_cvt_pk_bf16_f32 v24, v24, v25
    v_cvt_pk_bf16_f32 v26, v26, v27
    v_lshlrev_b32 v22, 16, v24
    v_and_b32 v23, 0xffff0000, v24
    v_lshlrev_b32 v28, 16, v26
    v_and_b32 v29, 0xffff0000, v26
    v_pk_mul_f32 v[36:37], v[228:229], v[22:23] op_sel:[0,0] op_sel_hi:[0,1]
    v_pk_fma_f32 v[36:37], v[230:231], v[28:29], v[36:37] op_sel:[0,0,0] op_sel_hi:[0,1,1]
    v_pk_fma_f32 v[36:37], v[230:231], v[140:141], v[36:37] op_sel:[0,0,0] op_sel_hi:[0,1,1]
    v_lshlrev_b32 v22, 16, v201
    v_and_b32 v23, 0xffff0000, v201
    v_pk_mul_f32 v[24:25], v[22:23], v[234:235]
    v_pk_mul_f32 v[26:27], v[22:23], v[110:111]
    v_cvt_pk_bf16_f32 v24, v24, v25
    v_cvt_pk_bf16_f32 v26, v26, v27
    v_lshlrev_b32 v22, 16, v24
    v_and_b32 v23, 0xffff0000, v24
    v_lshlrev_b32 v28, 16, v26
    v_and_b32 v29, 0xffff0000, v26
    v_pk_mul_f32 v[38:39], v[228:229], v[22:23] op_sel:[0,0] op_sel_hi:[0,1]
    v_pk_fma_f32 v[38:39], v[230:231], v[28:29], v[38:39] op_sel:[0,0,0] op_sel_hi:[0,1,1]
    v_pk_fma_f32 v[38:39], v[230:231], v[142:143], v[38:39] op_sel:[0,0,0] op_sel_hi:[0,1,1]
    v_lshlrev_b32 v22, 16, v194
    v_and_b32 v23, 0xffff0000, v194
    v_pk_mul_f32 v[24:25], v[22:23], v[236:237]
    v_pk_mul_f32 v[26:27], v[22:23], v[112:113]
    v_cvt_pk_bf16_f32 v24, v24, v25
    v_cvt_pk_bf16_f32 v26, v26, v27
    v_lshlrev_b32 v22, 16, v24
    v_and_b32 v23, 0xffff0000, v24
    v_lshlrev_b32 v28, 16, v26
    v_and_b32 v29, 0xffff0000, v26
    v_pk_mul_f32 v[40:41], v[224:225], v[22:23] op_sel:[0,0] op_sel_hi:[0,1]
    v_pk_fma_f32 v[40:41], v[226:227], v[28:29], v[40:41] op_sel:[0,0,0] op_sel_hi:[0,1,1]
    v_pk_fma_f32 v[40:41], v[226:227], v[152:153], v[40:41] op_sel:[0,0,0] op_sel_hi:[0,1,1]
    v_lshlrev_b32 v22, 16, v195
    v_and_b32 v23, 0xffff0000, v195
    v_pk_mul_f32 v[24:25], v[22:23], v[238:239]
    v_pk_mul_f32 v[26:27], v[22:23], v[114:115]
    v_cvt_pk_bf16_f32 v24, v24, v25
    v_cvt_pk_bf16_f32 v26, v26, v27
    v_lshlrev_b32 v22, 16, v24
    v_and_b32 v23, 0xffff0000, v24
    v_lshlrev_b32 v28, 16, v26
    v_and_b32 v29, 0xffff0000, v26
    v_pk_mul_f32 v[42:43], v[224:225], v[22:23] op_sel:[0,0] op_sel_hi:[0,1]
    v_pk_fma_f32 v[42:43], v[226:227], v[28:29], v[42:43] op_sel:[0,0,0] op_sel_hi:[0,1,1]
    v_pk_fma_f32 v[42:43], v[226:227], v[154:155], v[42:43] op_sel:[0,0,0] op_sel_hi:[0,1,1]
    s_waitcnt vmcnt(0)
    s_mov_b64 s[56:57], exec
    s_mov_b64 exec, 1
    buffer_store_dword v15, v30, s[44:47], s25 offen sc1
    s_mov_b64 exec, s[56:57]
    v_lshlrev_b32 v22, 16, v202
    v_and_b32 v23, 0xffff0000, v202
    v_pk_mul_f32 v[24:25], v[22:23], v[236:237]
    v_pk_mul_f32 v[26:27], v[22:23], v[112:113]
    v_cvt_pk_bf16_f32 v24, v24, v25
    v_cvt_pk_bf16_f32 v26, v26, v27
    v_lshlrev_b32 v22, 16, v24
    v_and_b32 v23, 0xffff0000, v24
    v_lshlrev_b32 v28, 16, v26
    v_and_b32 v29, 0xffff0000, v26
    v_pk_mul_f32 v[44:45], v[228:229], v[22:23] op_sel:[0,0] op_sel_hi:[0,1]
    v_pk_fma_f32 v[44:45], v[230:231], v[28:29], v[44:45] op_sel:[0,0,0] op_sel_hi:[0,1,1]
    v_pk_fma_f32 v[44:45], v[230:231], v[156:157], v[44:45] op_sel:[0,0,0] op_sel_hi:[0,1,1]
    v_lshlrev_b32 v22, 16, v203
    v_and_b32 v23, 0xffff0000, v203
    v_pk_mul_f32 v[24:25], v[22:23], v[238:239]
    v_pk_mul_f32 v[26:27], v[22:23], v[114:115]
    v_cvt_pk_bf16_f32 v24, v24, v25
    v_cvt_pk_bf16_f32 v26, v26, v27
    v_lshlrev_b32 v22, 16, v24
    v_and_b32 v23, 0xffff0000, v24
    v_lshlrev_b32 v28, 16, v26
    v_and_b32 v29, 0xffff0000, v26
    v_pk_mul_f32 v[46:47], v[228:229], v[22:23] op_sel:[0,0] op_sel_hi:[0,1]
    v_pk_fma_f32 v[46:47], v[230:231], v[28:29], v[46:47] op_sel:[0,0,0] op_sel_hi:[0,1,1]
    v_pk_fma_f32 v[46:47], v[230:231], v[158:159], v[46:47] op_sel:[0,0,0] op_sel_hi:[0,1,1]
    v_lshlrev_b32 v22, 16, v196
    v_and_b32 v23, 0xffff0000, v196
    v_pk_mul_f32 v[24:25], v[22:23], v[240:241]
    v_pk_mul_f32 v[26:27], v[22:23], v[116:117]
    v_cvt_pk_bf16_f32 v24, v24, v25
    v_cvt_pk_bf16_f32 v26, v26, v27
    v_lshlrev_b32 v22, 16, v24
    v_and_b32 v23, 0xffff0000, v24
    v_lshlrev_b32 v28, 16, v26
    v_and_b32 v29, 0xffff0000, v26
    v_pk_mul_f32 v[48:49], v[224:225], v[22:23] op_sel:[0,0] op_sel_hi:[0,1]
    v_pk_fma_f32 v[48:49], v[226:227], v[28:29], v[48:49] op_sel:[0,0,0] op_sel_hi:[0,1,1]
    v_pk_fma_f32 v[48:49], v[226:227], v[168:169], v[48:49] op_sel:[0,0,0] op_sel_hi:[0,1,1]
    v_lshlrev_b32 v22, 16, v197
    v_and_b32 v23, 0xffff0000, v197
    v_pk_mul_f32 v[24:25], v[22:23], v[242:243]
    v_pk_mul_f32 v[26:27], v[22:23], v[118:119]
    v_cvt_pk_bf16_f32 v24, v24, v25
    v_cvt_pk_bf16_f32 v26, v26, v27
    v_lshlrev_b32 v22, 16, v24
    v_and_b32 v23, 0xffff0000, v24
    v_lshlrev_b32 v28, 16, v26
    v_and_b32 v29, 0xffff0000, v26
    v_pk_mul_f32 v[50:51], v[224:225], v[22:23] op_sel:[0,0] op_sel_hi:[0,1]
    v_pk_fma_f32 v[50:51], v[226:227], v[28:29], v[50:51] op_sel:[0,0,0] op_sel_hi:[0,1,1]
    v_pk_fma_f32 v[50:51], v[226:227], v[170:171], v[50:51] op_sel:[0,0,0] op_sel_hi:[0,1,1]
    v_lshlrev_b32 v22, 16, v204
    v_and_b32 v23, 0xffff0000, v204
    v_pk_mul_f32 v[24:25], v[22:23], v[240:241]
    v_pk_mul_f32 v[26:27], v[22:23], v[116:117]
    v_cvt_pk_bf16_f32 v24, v24, v25
    v_cvt_pk_bf16_f32 v26, v26, v27
    v_lshlrev_b32 v22, 16, v24
    v_and_b32 v23, 0xffff0000, v24
    v_lshlrev_b32 v28, 16, v26
    v_and_b32 v29, 0xffff0000, v26
    v_pk_mul_f32 v[52:53], v[228:229], v[22:23] op_sel:[0,0] op_sel_hi:[0,1]
    v_pk_fma_f32 v[52:53], v[230:231], v[28:29], v[52:53] op_sel:[0,0,0] op_sel_hi:[0,1,1]
    v_pk_fma_f32 v[52:53], v[230:231], v[172:173], v[52:53] op_sel:[0,0,0] op_sel_hi:[0,1,1]
    v_lshlrev_b32 v22, 16, v205
    v_and_b32 v23, 0xffff0000, v205
    v_pk_mul_f32 v[24:25], v[22:23], v[242:243]
    v_pk_mul_f32 v[26:27], v[22:23], v[118:119]
    v_cvt_pk_bf16_f32 v24, v24, v25
    v_cvt_pk_bf16_f32 v26, v26, v27
    v_lshlrev_b32 v22, 16, v24
    v_and_b32 v23, 0xffff0000, v24
    v_lshlrev_b32 v28, 16, v26
    v_and_b32 v29, 0xffff0000, v26
    v_pk_mul_f32 v[54:55], v[228:229], v[22:23] op_sel:[0,0] op_sel_hi:[0,1]
    v_pk_fma_f32 v[54:55], v[230:231], v[28:29], v[54:55] op_sel:[0,0,0] op_sel_hi:[0,1,1]
    v_pk_fma_f32 v[54:55], v[230:231], v[174:175], v[54:55] op_sel:[0,0,0] op_sel_hi:[0,1,1]
    v_lshlrev_b32 v22, 16, v198
    v_and_b32 v23, 0xffff0000, v198
    v_pk_mul_f32 v[24:25], v[22:23], v[244:245]
    v_pk_mul_f32 v[26:27], v[22:23], v[120:121]
    v_cvt_pk_bf16_f32 v24, v24, v25
    v_cvt_pk_bf16_f32 v26, v26, v27
    v_lshlrev_b32 v22, 16, v24
    v_and_b32 v23, 0xffff0000, v24
    v_lshlrev_b32 v28, 16, v26
    v_and_b32 v29, 0xffff0000, v26
    v_pk_mul_f32 v[56:57], v[224:225], v[22:23] op_sel:[0,0] op_sel_hi:[0,1]
    v_pk_fma_f32 v[56:57], v[226:227], v[28:29], v[56:57] op_sel:[0,0,0] op_sel_hi:[0,1,1]
    v_pk_fma_f32 v[56:57], v[226:227], v[184:185], v[56:57] op_sel:[0,0,0] op_sel_hi:[0,1,1]
    v_lshlrev_b32 v22, 16, v199
    v_and_b32 v23, 0xffff0000, v199
    v_pk_mul_f32 v[24:25], v[22:23], v[246:247]
    v_pk_mul_f32 v[26:27], v[22:23], v[122:123]
    v_cvt_pk_bf16_f32 v24, v24, v25
    v_cvt_pk_bf16_f32 v26, v26, v27
    v_lshlrev_b32 v22, 16, v24
    v_and_b32 v23, 0xffff0000, v24
    v_lshlrev_b32 v28, 16, v26
    v_and_b32 v29, 0xffff0000, v26
    v_pk_mul_f32 v[58:59], v[224:225], v[22:23] op_sel:[0,0] op_sel_hi:[0,1]
    v_pk_fma_f32 v[58:59], v[226:227], v[28:29], v[58:59] op_sel:[0,0,0] op_sel_hi:[0,1,1]
    v_pk_fma_f32 v[58:59], v[226:227], v[186:187], v[58:59] op_sel:[0,0,0] op_sel_hi:[0,1,1]
    v_lshlrev_b32 v22, 16, v206
    v_and_b32 v23, 0xffff0000, v206
    v_pk_mul_f32 v[24:25], v[22:23], v[244:245]
    v_pk_mul_f32 v[26:27], v[22:23], v[120:121]
    v_cvt_pk_bf16_f32 v24, v24, v25
    v_cvt_pk_bf16_f32 v26, v26, v27
    v_lshlrev_b32 v22, 16, v24
    v_and_b32 v23, 0xffff0000, v24
    v_lshlrev_b32 v28, 16, v26
    v_and_b32 v29, 0xffff0000, v26
    v_pk_mul_f32 v[60:61], v[228:229], v[22:23] op_sel:[0,0] op_sel_hi:[0,1]
    v_pk_fma_f32 v[60:61], v[230:231], v[28:29], v[60:61] op_sel:[0,0,0] op_sel_hi:[0,1,1]
    v_pk_fma_f32 v[60:61], v[230:231], v[188:189], v[60:61] op_sel:[0,0,0] op_sel_hi:[0,1,1]
    v_lshlrev_b32 v22, 16, v207
    v_and_b32 v23, 0xffff0000, v207
    v_pk_mul_f32 v[24:25], v[22:23], v[246:247]
    v_pk_mul_f32 v[26:27], v[22:23], v[122:123]
    v_cvt_pk_bf16_f32 v24, v24, v25
    v_cvt_pk_bf16_f32 v26, v26, v27
    v_lshlrev_b32 v22, 16, v24
    v_and_b32 v23, 0xffff0000, v24
    v_lshlrev_b32 v28, 16, v26
    v_and_b32 v29, 0xffff0000, v26
    v_pk_mul_f32 v[62:63], v[228:229], v[22:23] op_sel:[0,0] op_sel_hi:[0,1]
    v_pk_fma_f32 v[62:63], v[230:231], v[28:29], v[62:63] op_sel:[0,0,0] op_sel_hi:[0,1,1]
    v_pk_fma_f32 v[62:63], v[230:231], v[190:191], v[62:63] op_sel:[0,0,0] op_sel_hi:[0,1,1]
    buffer_load_dword v18, v30, s[44:47], s24 offen sc1
    s_mov_b32 s98, 0
LT1_p:
    s_add_u32 s98, s98, 1
    s_cmp_gt_u32 s98, 262144
    s_cbranch_scc1 L_end
    s_waitcnt vmcnt(0)
    v_cmp_ne_u32 vcc, v18, v15
    s_nop 4
    s_cbranch_vccz LT1_got
    s_sleep 2
    buffer_load_dword v18, v30, s[44:47], s24 offen sc1
    s_branch LT1_p
LT1_got:
    buffer_load_dword v19, v31, s[44:47], s23 offen sc1
    buffer_load_dwordx4 v[64:67], v12, s[44:47], s23 offen offset:0 sc1
    buffer_load_dwordx4 v[68:71], v12, s[44:47], s23 offen offset:1024 sc1
    buffer_load_dwordx4 v[72:75], v12, s[44:47], s23 offen offset:2048 sc1
    buffer_load_dwordx4 v[76:79], v12, s[44:47], s23 offen offset:3072 sc1
    s_waitcnt vmcnt(4)
    v_mul_f32 v26, v224, v19
    v_mul_f32 v26, 0x38000100, v26
    v_mul_f32 v28, v228, v19
    v_mul_f32 v28, 0x38000100, v28
    s_waitcnt vmcnt(3)
    v_cvt_f32_i32_sdwa v22, sext(v64) dst_sel:DWORD dst_unused:UNUSED_PAD src0_sel:WORD_0
    v_cvt_f32_i32_sdwa v23, sext(v64) dst_sel:DWORD dst_unused:UNUSED_PAD src0_sel:WORD_1
    s_nop 0
    v_pk_fma_f32 v[32:33], v[26:27], v[22:23], v[32:33] op_sel:[0,0,0] op_sel_hi:[0,1,1]
    v_cvt_f32_i32_sdwa v22, sext(v65) dst_sel:DWORD dst_unused:UNUSED_PAD src0_sel:WORD_0
    v_cvt_f32_i32_sdwa v23, sext(v65) dst_sel:DWORD dst_unused:UNUSED_PAD src0_sel:WORD_1
    s_nop 0
    v_pk_fma_f32 v[34:35], v[26:27], v[22:23], v[34:35] op_sel:[0,0,0] op_sel_hi:[0,1,1]
    global_store_dwordx4 v10, v[32:35], s[40:41] offset:0
    v_cvt_f32_i32_sdwa v22, sext(v66) dst_sel:DWORD dst_unused:UNUSED_PAD src0_sel:WORD_0
    v_cvt_f32_i32_sdwa v23, sext(v66) dst_sel:DWORD dst_unused:UNUSED_PAD src0_sel:WORD_1
    s_nop 0
    v_pk_fma_f32 v[36:37], v[28:29], v[22:23], v[36:37] op_sel:[0,0,0] op_sel_hi:[0,1,1]
    v_cvt_f32_i32_sdwa v22, sext(v67) dst_sel:DWORD dst_unused:UNUSED_PAD src0_sel:WORD_0
    v_cvt_f32_i32_sdwa v23, sext(v67) dst_sel:DWORD dst_unused:UNUSED_PAD src0_sel:WORD_1
    s_nop 0
    v_pk_fma_f32 v[38:39], v[28:29], v[22:23], v[38:39] op_sel:[0,0,0] op_sel_hi:[0,1,1]
    global_store_dwordx4 v11, v[36:39], s[40:41] offset:0
    s_waitcnt vmcnt(4)
    v_cvt_f32_i32_sdwa v22, sext(v68) dst_sel:DWORD dst_unused:UNUSED_PAD src0_sel:WORD_0
    v_cvt_f32_i32_sdwa v23, sext(v68) dst_sel:DWORD dst_unused:UNUSED_PAD src0_sel:WORD_1
    s_nop 0
    v_pk_fma_f32 v[40:41], v[26:27], v[22:23], v[40:41] op_sel:[0,0,0] op_sel_hi:[0,1,1]
    v_cvt_f32_i32_sdwa v22, sext(v69) dst_sel:DWORD dst_unused:UNUSED_PAD src0_sel:WORD_0
    v_cvt_f32_i32_sdwa v23, sext(v69) dst_sel:DWORD dst_unused:UNUSED_PAD src0_sel:WORD_1
    s_nop 0
    v_pk_fma_f32 v[42:43], v[26:27], v[22:23], v[42:43] op_sel:[0,0,0] op_sel_hi:[0,1,1]
    global_store_dwordx4 v10, v[40:43], s[40:41] offset:64
    v_cvt_f32_i32_sdwa v22, sext(v70) dst_sel:DWORD dst_unused:UNUSED_PAD src0_sel:WORD_0
    v_cvt_f32_i32_sdwa v23, sext(v70) dst_sel:DWORD dst_unused:UNUSED_PAD src0_sel:WORD_1
    s_nop 0
    v_pk_fma_f32 v[44:45], v[28:29], v[22:23], v[44:45] op_sel:[0,0,0] op_sel_hi:[0,1,1]
    v_cvt_f32_i32_sdwa v22, sext(v71) dst_sel:DWORD dst_unused:UNUSED_PAD src0_sel:WORD_0
    v_cvt_f32_i32_sdwa v23, sext(v71) dst_sel:DWORD dst_unused:UNUSED_PAD src0_sel:WORD_1
    s_nop 0
    v_pk_fma_f32 v[46:47], v[28:29], v[22:23], v[46:47] op_sel:[0,0,0] op_sel_hi:[0,1,1]
    global_store_dwordx4 v11, v[44:47], s[40:41] offset:64
    s_waitcnt vmcnt(5)
    v_cvt_f32_i32_sdwa v22, sext(v72) dst_sel:DWORD dst_unused:UNUSED_PAD src0_sel:WORD_0
    v_cvt_f32_i32_sdwa v23, sext(v72) dst_sel:DWORD dst_unused:UNUSED_PAD src0_sel:WORD_1
    s_nop 0
    v_pk_fma_f32 v[48:49], v[26:27], v[22:23], v[48:49] op_sel:[0,0,0] op_sel_hi:[0,1,1]
    v_cvt_f32_i32_sdwa v22, sext(v73) dst_sel:DWORD dst_unused:UNUSED_PAD src0_sel:WORD_0
    v_cvt_f32_i32_sdwa v23, sext(v73) dst_sel:DWORD dst_unused:UNUSED_PAD src0_sel:WORD_1
    s_nop 0
    v_pk_fma_f32 v[50:51], v[26:27], v[22:23], v[50:51] op_sel:[0,0,0] op_sel_hi:[0,1,1]
    global_store_dwordx4 v10, v[48:51], s[40:41] offset:128
    v_cvt_f32_i32_sdwa v22, sext(v74) dst_sel:DWORD dst_unused:UNUSED_PAD src0_sel:WORD_0
    v_cvt_f32_i32_sdwa v23, sext(v74) dst_sel:DWORD dst_unused:UNUSED_PAD src0_sel:WORD_1
    s_nop 0
    v_pk_fma_f32 v[52:53], v[28:29], v[22:23], v[52:53] op_sel:[0,0,0] op_sel_hi:[0,1,1]
    v_cvt_f32_i32_sdwa v22, sext(v75) dst_sel:DWORD dst_unused:UNUSED_PAD src0_sel:WORD_0
    v_cvt_f32_i32_sdwa v23, sext(v75) dst_sel:DWORD dst_unused:UNUSED_PAD src0_sel:WORD_1
    s_nop 0
    v_pk_fma_f32 v[54:55], v[28:29], v[22:23], v[54:55] op_sel:[0,0,0] op_sel_hi:[0,1,1]
    global_store_dwordx4 v11, v[52:55], s[40:41] offset:128
    s_waitcnt vmcnt(6)
    v_cvt_f32_i32_sdwa v22, sext(v76) dst_sel:DWORD dst_unused:UNUSED_PAD src0_sel:WORD_0
    v_cvt_f32_i32_sdwa v23, sext(v76) dst_sel:DWORD dst_unused:UNUSED_PAD src0_sel:WORD_1
    s_nop 0
    v_pk_fma_f32 v[56:57], v[26:27], v[22:23], v[56:57] op_sel:[0,0,0] op_sel_hi:[0,1,1]
    v_cvt_f32_i32_sdwa v22, sext(v77) dst_sel:DWORD dst_unused:UNUSED_PAD src0_sel:WORD_0
    v_cvt_f32_i32_sdwa v23, sext(v77) dst_sel:DWORD dst_unused:UNUSED_PAD src0_sel:WORD_1
    s_nop 0
    v_pk_fma_f32 v[58:59], v[26:27], v[22:23], v[58:59] op_sel:[0,0,0] op_sel_hi:[0,1,1]
    global_store_dwordx4 v10, v[56:59], s[40:41] offset:192
    v_cvt_f32_i32_sdwa v22, sext(v78) dst_sel:DWORD dst_unused:UNUSED_PAD src0_sel:WORD_0
    v_cvt_f32_i32_sdwa v23, sext(v78) dst_sel:DWORD dst_unused:UNUSED_PAD src0_sel:WORD_1
    s_nop 0
    v_pk_fma_f32 v[60:61], v[28:29], v[22:23], v[60:61] op_sel:[0,0,0] op_sel_hi:[0,1,1]
    v_cvt_f32_i32_sdwa v22, sext(v79) dst_sel:DWORD dst_unused:UNUSED_PAD src0_sel:WORD_0
    v_cvt_f32_i32_sdwa v23, sext(v79) dst_sel:DWORD dst_unused:UNUSED_PAD src0_sel:WORD_1
    s_nop 0
    v_pk_fma_f32 v[62:63], v[28:29], v[22:23], v[62:63] op_sel:[0,0,0] op_sel_hi:[0,1,1]
    global_store_dwordx4 v11, v[60:63], s[40:41] offset:192
LT_done:
L_end:
    s_endpgm
.section .rodata,"a"
.p2align 6
.amdhsa_kernel gated_mix__ssm_conv_s5__ssm_conv_s5__prompt_kernel
  .amdhsa_next_free_vgpr 256
  .amdhsa_next_free_sgpr 102
  .amdhsa_accum_offset 256
  .amdhsa_group_segment_fixed_size 0
  .amdhsa_kernarg_size 176
  .amdhsa_user_sgpr_count 2
  .amdhsa_user_sgpr_kernarg_segment_ptr 1
  .amdhsa_system_sgpr_workgroup_id_x 1
  .amdhsa_float_denorm_mode_32 3
.end_amdhsa_kernel
```
